```python
import torch

def _softmax(x, axis=-1):
    return torch.softmax(x, dim=axis)
def _gelu(x):
    return torch.nn.functional.gelu(x, approximate="tanh")
def _silu(x):
    return torch.nn.functional.silu(x)
def _sigmoid(x):
    return torch.sigmoid(x)
def _layernorm(x, axis=-1, eps=1e-5):
    m = x.mean(dim=axis, keepdim=True)
    v = x.var(dim=axis, keepdim=True, unbiased=False)
    return (x - m) / torch.sqrt(v + eps)
def _scatter_add(tgt, idx, src, axis=0):
    return tgt.clone().index_add_(axis, idx, src)
def _segment_sum(src, seg, n):
    out = torch.zeros((n,) + src.shape[1:], dtype=src.dtype)
    return out.index_add_(0, seg, src)
def _pad(x, pw):
    flat = tuple(v for pair in reversed(pw) for v in pair)
    return torch.nn.functional.pad(x, flat)

kernel_name = 'recurrent_scan__grouped_kv_mqa__dense_activation_relu__prompt'

def setup_inputs():

    _w = (lambda a: (lambda t: t.to(torch.bfloat16) if t.is_floating_point() else t)(torch.as_tensor(a)))
    def _A_setup():
        B, S, D, H = 1, 2048, 512, 32
        Dh = D // H
        return {
            "x": _w((lambda *s: torch.randn(*s, dtype=torch.bfloat16) * 0.05)(B, S, D)),
            "wq": _w((lambda *s: torch.randn(*s, dtype=torch.bfloat16) * 0.05)(D, H * Dh)),
            "wk": _w((lambda *s: torch.randn(*s, dtype=torch.bfloat16) * 0.05)(D, Dh)),
            "wv": _w((lambda *s: torch.randn(*s, dtype=torch.bfloat16) * 0.05)(D, Dh)),
            "wo": _w((lambda *s: torch.randn(*s, dtype=torch.bfloat16) * 0.05)(H * Dh, D)),
        }
    _A_in = _A_setup()

    def _B_setup():
        B, S, D, Dff = 1, 2048, 512, 1792
        return {
            "x": _w((lambda *s: torch.randn(*s, dtype=torch.bfloat16) * 0.05)(B, S, D)),
            "w1": _w((lambda *s: torch.randn(*s, dtype=torch.bfloat16) * 0.05)(D, Dff)),
            "w2": _w((lambda *s: torch.randn(*s, dtype=torch.bfloat16) * 0.05)(Dff, D)),
        }
    _B_in = _B_setup()

    return {
        "A_x": _A_in["x"],
        "A_wq": _A_in["wq"],
        "A_wk": _A_in["wk"],
        "A_wv": _A_in["wv"],
        "A_wo": _A_in["wo"],
        "B_x": _B_in["x"],
        "B_w1": _B_in["w1"],
        "B_w2": _B_in["w2"],
    }

def reference(A_x, A_wq, A_wk, A_wv, A_wo, B_x, B_w1, B_w2):
    def _A_ref(x, wq, wk, wv, wo):
        B, S, D = x.shape
        H = 32
        Dh = D // H
        q = (lambda x, *d: x.permute(*d))((x @ wq).reshape(B, S, H, Dh), 0, 2, 1, 3)
        k = x @ wk
        v = x @ wv
        scores = torch.einsum("bhqd,bkd->bhqk", q, k) * (Dh ** -0.5)
        p = _softmax(scores, axis=-1)
        o = torch.einsum("bhqk,bkd->bhqd", p, v)
        return (lambda x, *d: x.permute(*d))(o, 0, 2, 1, 3).reshape(B, S, H * Dh) @ wo

    def _B_ref(x, w1, w2):
        h = torch.einsum("bsd,df->bsf", x, w1)
        zero = torch.zeros_like(h)
        h = torch.maximum(h, zero)
        return torch.einsum("bsf,fd->bsd", h, w2)

    x = A_x
    xn = _layernorm(x, axis=-1)
    s = _A_ref(xn, A_wq, A_wk, A_wv, A_wo)
    g = _silu(_B_ref(xn, B_w1, B_w2))
    return x + s * g
```

```asm
; @launch grid=(256,1,1) block=(512,1,1) lds=163328
.amdgcn_target "amdgcn-amd-amdhsa--gfx950"
.text
.globl recurrent_scan__grouped_kv_mqa__dense_activation_relu__prompt_kernel
.p2align 8
.type recurrent_scan__grouped_kv_mqa__dense_activation_relu__prompt_kernel,@function
recurrent_scan__grouped_kv_mqa__dense_activation_relu__prompt_kernel:
    s_cmp_ge_u32 s2, 256
    s_cbranch_scc1 L_end
    s_load_dwordx16 s[48:63], s[0:1], 0
    s_load_dwordx2 s[64:65], s[0:1], 64
    s_load_dwordx2 s[68:69], s[0:1], 80
    v_lshrrev_b32 v2, 6, v0
    v_and_b32 v1, 63, v0
    v_readfirstlane_b32 s70, v2
    s_cmp_lg_u32 s70, 4
    s_cbranch_scc1 L_no_ct
    s_getpc_b64 s[16:17]
L_pc:
    s_mov_b32 s18, L_code_end-L_pc
    s_mov_b32 s19, 0x20000
    s_lshr_b32 s73, s2, 3
    s_lshl_b32 s73, s73, 7
    v_lshlrev_b32 v104, 12, v1
    s_mov_b64 exec, 0xffff
    buffer_load_dword v106, v104, s[16:19], s73 offen
    s_mov_b64 exec, -1
L_no_ct:
    s_and_b32 s73, s2, 7
    s_lshr_b32 s74, s2, 3
    s_and_b32 s72, s74, 3
    s_lshl_b32 s72, s72, 1
    s_and_b32 s71, s73, 1
    s_add_u32 s72, s72, s71
    s_lshr_b32 s74, s74, 2
    s_lshr_b32 s71, s73, 1
    s_lshl_b32 s71, s71, 3
    s_add_u32 s71, s71, s74
    s_mov_b32 s44, 0xffff0000
    s_and_b32 s45, s70, 3
    s_and_b32 s3, s72, 6
    s_add_u32 s3, s3, s70
    s_add_u32 s3, s3, 3
    s_and_b32 s3, s3, 7
    v_lshrrev_b32 v2, 3, v1
    v_and_b32 v3, 7, v1
    v_lshlrev_b32 v4, 10, v2
    v_lshl_add_u32 v4, v3, 4, v4
    s_lshl_b32 s76, s71, 3
    s_add_u32 s76, s76, s3
    s_lshl_b32 s76, s76, 13
    s_mov_b32 s10, 0x200000
    s_mov_b32 s11, 0x20000
    s_mov_b32 s14, 0x80000
    s_mov_b32 s15, 0x20000
    s_mov_b32 s18, 0x4000
    s_mov_b32 s19, 0x20000
    s_mov_b32 s22, 0x80000
    s_mov_b32 s23, 0x20000
    s_mov_b32 s26, 0x1c0000
    s_mov_b32 s27, 0x20000
    s_mov_b32 s30, 0x1c0000
    s_mov_b32 s31, 0x20000
    s_mov_b32 s34, 0x200000
    s_mov_b32 s35, 0x20000
    s_mov_b32 s42, 0x10000000
    s_mov_b32 s43, 0x20000
    v_mov_b32 v6, 163072
    v_mov_b32 v7, 1
    v_mov_b64 v[108:109], 0
    v_and_b32 v105, 15, v1
    v_lshl_add_u32 v105, v105, 3, v6
    ds_write_b64 v105, v[108:109]
    s_mov_b32 s79, 0
    s_cmp_eq_u32 s70, 7
    s_cbranch_scc1 L_pre_7
    s_waitcnt lgkmcnt(0)
    s_mov_b64 s[8:9], s[48:49]
    s_cmp_eq_u32 s70, 4
    s_cbranch_scc1 L_pre_4
    s_cmp_ge_u32 s70, 0
    s_cbranch_scc1 L_pre_first
    s_barrier
L_pre_first:
    buffer_load_dwordx4 v[8:11], v4, s[8:11], s76 offen offset:0
    buffer_load_dwordx4 v[12:15], v4, s[8:11], s76 offen offset:128
    buffer_load_dwordx4 v[16:19], v4, s[8:11], s76 offen offset:256
    buffer_load_dwordx4 v[20:23], v4, s[8:11], s76 offen offset:384
    buffer_load_dwordx4 v[24:27], v4, s[8:11], s76 offen offset:512
    buffer_load_dwordx4 v[28:31], v4, s[8:11], s76 offen offset:640
    buffer_load_dwordx4 v[32:35], v4, s[8:11], s76 offen offset:768
    buffer_load_dwordx4 v[36:39], v4, s[8:11], s76 offen offset:896
    s_cbranch_scc0 L_pre_second
    s_barrier
L_pre_second:
    s_cmp_eq_u32 s70, 0
    s_cbranch_scc1 L_pre_dbl
    s_cmp_lg_u32 s70, 3
    s_cbranch_scc1 L_pre_n3
L_pre_dbl:
    s_xor_b32 s76, s76, 0x8000
    buffer_load_dwordx4 v[128:131], v4, s[8:11], s76 offen offset:0
    buffer_load_dwordx4 v[132:135], v4, s[8:11], s76 offen offset:128
    buffer_load_dwordx4 v[136:139], v4, s[8:11], s76 offen offset:256
    buffer_load_dwordx4 v[140:143], v4, s[8:11], s76 offen offset:384
    buffer_load_dwordx4 v[144:147], v4, s[8:11], s76 offen offset:512
    buffer_load_dwordx4 v[148:151], v4, s[8:11], s76 offen offset:640
    buffer_load_dwordx4 v[152:155], v4, s[8:11], s76 offen offset:768
    buffer_load_dwordx4 v[156:159], v4, s[8:11], s76 offen offset:896
    s_mov_b32 s79, 1
L_pre_n3:
    s_mov_b64 exec, 1
    ds_add_u32 v6, v7 offset:76
    s_mov_b64 exec, -1
    s_mov_b64 s[12:13], s[50:51]
    s_mov_b64 s[20:21], s[56:57]
    s_mov_b64 s[24:25], s[60:61]
    s_mov_b64 s[28:29], s[62:63]
    s_mov_b64 s[32:33], s[64:65]
    s_mov_b64 s[40:41], s[68:69]
    s_lshl_b32 s47, s71, 10
    s_add_u32 s47, s47, 0x40000
    s_mul_i32 s37, s45, 6144
    s_add_u32 s37, s37, 134144
    s_lshl_b32 s73, s71, 5
    s_lshl_b32 s74, s72, 2
    s_add_u32 s73, s73, s74
    s_and_b32 s74, s45, 1
    s_lshl_b32 s63, s74, 6
    s_lshl_b32 s74, s74, 1
    s_add_u32 s73, s73, s74
    s_lshl_b32 s73, s73, 1
    s_lshr_b32 s74, s45, 1
    s_add_u32 s73, s73, s74
    s_lshl_b32 s73, s73, 10
    s_add_u32 s6, s73, 1048576
    s_lshl_b32 s73, s71, 1
    s_add_u32 s73, s73, s74
    s_lshl_b32 s73, s73, 15
    s_add_u32 s63, s63, s73
    s_lshl_b32 s73, s72, 7
    s_add_u32 s63, s63, s73
    v_lshrrev_b32 v5, 2, v1
    v_and_b32 v5, 4, v5
    v_xor_b32 v5, v5, v3
    v_lshlrev_b32 v5, 4, v5
    v_lshl_add_u32 v219, v2, 10, v5
    v_mul_u32_u24 v220, 3584, v2
    v_add_u32 v220, v220, v5
    v_lshlrev_b32 v221, 4, v1
    v_lshrrev_b32 v212, 5, v1
    v_bfe_u32 v213, v1, 4, 1
    v_bfe_u32 v214, v1, 2, 2
    v_and_b32 v215, 3, v1
    v_lshrrev_b32 v4, 1, v215
    v_lshl_add_u32 v4, v213, 1, v4
    v_lshlrev_b32 v5, 1, v214
    v_and_b32 v5, 4, v5
    v_xor_b32 v4, v4, v5
    v_lshlrev_b32 v216, 7, v214
    v_lshl_add_u32 v216, v4, 4, v216
    v_and_b32 v5, 1, v215
    v_lshl_add_u32 v216, v5, 3, v216
    v_and_b32 v5, 31, v1
    v_mul_u32_u24 v217, 528, v212
    v_lshl_add_u32 v217, v5, 4, v217
    v_add_u32 v217, 66560, v217
    v_add_u32 v218, 33792, v217
    v_lshlrev_b32 v205, 10, v5
    v_lshl_add_u32 v205, v212, 3, v205
    v_mul_u32_u24 v224, 2080, v5
    v_lshl_add_u32 v224, v212, 4, v224
    v_subrev_u32 v228, 1, v212
    v_and_b32 v228, 0x3f803f80, v228
    v_mov_b32 v229, v228
    v_mov_b32 v230, v228
    v_mov_b32 v231, v228
    v_and_b32 v4, 15, v1
    v_lshl_add_u32 v4, v212, 4, v4
    v_lshlrev_b32 v203, 4, v4
    v_lshl_add_u32 v222, v212, 10, v216
    s_cmp_ge_u32 s70, 4
    s_cbranch_scc1 L_pre_56
    s_setprio 1
    s_and_b32 s74, s70, 1
    s_lshl_b32 s75, s74, 6
    v_xor_b32 v222, s75, v222
    s_lshr_b32 s74, s70, 1
    s_mul_i32 s74, s74, 33792
    v_add_u32 v217, s74, v217
    v_add_u32 v200, 152576, v221
    v_and_b32 v5, 11, v1
    v_cmp_ne_u32 vcc, 0, v5
    v_mov_b32 v4, 154624
    v_mov_b32 v5, 154640
    v_add_u32 v201, 153600, v203
    v_cndmask_b32 v4, v4, v5, vcc
    v_cmp_eq_u32 vcc, 0, v213
    v_add_u32 v202, 154112, v203
    v_mov_b32 v207, 0xdddddddd
    s_nop 0
    v_cndmask_b32 v201, v4, v201, vcc
    v_cndmask_b32 v202, v4, v202, vcc
    s_cmp_eq_u32 s79, 1
    s_cbranch_scc1 L_pre_w8
    s_waitcnt vmcnt(0)
    s_branch L_ln
L_pre_w8:
    s_waitcnt vmcnt(8)
    s_branch L_ln2
L_pre_4:
    s_mov_b64 s[12:13], s[50:51]
    s_mov_b64 s[20:21], s[56:57]
    s_mov_b64 s[24:25], s[60:61]
    s_mov_b64 s[28:29], s[62:63]
    s_mov_b64 s[32:33], s[64:65]
    s_mov_b64 s[40:41], s[68:69]
    s_lshl_b32 s47, s71, 10
    s_add_u32 s47, s47, 0x40000
    s_mul_i32 s37, s45, 6144
    s_add_u32 s37, s37, 134144
    s_lshl_b32 s73, s71, 5
    s_lshl_b32 s74, s72, 2
    s_add_u32 s73, s73, s74
    s_and_b32 s74, s45, 1
    s_lshl_b32 s63, s74, 6
    s_lshl_b32 s74, s74, 1
    s_add_u32 s73, s73, s74
    s_lshl_b32 s73, s73, 1
    s_lshr_b32 s74, s45, 1
    s_add_u32 s73, s73, s74
    s_lshl_b32 s73, s73, 10
    s_add_u32 s6, s73, 1048576
    s_lshl_b32 s73, s71, 1
    s_add_u32 s73, s73, s74
    s_lshl_b32 s73, s73, 15
    s_add_u32 s63, s63, s73
    s_lshl_b32 s73, s72, 7
    s_add_u32 s63, s63, s73
    v_lshrrev_b32 v5, 2, v1
    v_and_b32 v5, 4, v5
    v_xor_b32 v5, v5, v3
    v_lshlrev_b32 v5, 4, v5
    v_lshl_add_u32 v219, v2, 10, v5
    v_mul_u32_u24 v220, 3584, v2
    v_add_u32 v220, v220, v5
    v_lshlrev_b32 v221, 4, v1
    v_lshrrev_b32 v212, 5, v1
    v_bfe_u32 v213, v1, 4, 1
    v_bfe_u32 v214, v1, 2, 2
    v_and_b32 v215, 3, v1
    v_lshrrev_b32 v4, 1, v215
    v_lshl_add_u32 v4, v213, 1, v4
    v_lshlrev_b32 v5, 1, v214
    v_and_b32 v5, 4, v5
    v_xor_b32 v4, v4, v5
    v_lshlrev_b32 v216, 7, v214
    v_lshl_add_u32 v216, v4, 4, v216
    v_and_b32 v5, 1, v215
    v_lshl_add_u32 v216, v5, 3, v216
    v_and_b32 v5, 31, v1
    v_mul_u32_u24 v217, 528, v212
    v_lshl_add_u32 v217, v5, 4, v217
    v_add_u32 v217, 66560, v217
    v_add_u32 v218, 33792, v217
    v_lshlrev_b32 v205, 10, v5
    v_lshl_add_u32 v205, v212, 3, v205
    v_mul_u32_u24 v224, 2080, v5
    v_lshl_add_u32 v224, v212, 4, v224
    v_subrev_u32 v228, 1, v212
    v_and_b32 v228, 0x3f803f80, v228
    v_mov_b32 v229, v228
    v_mov_b32 v230, v228
    v_mov_b32 v231, v228
    v_and_b32 v4, 15, v1
    v_lshl_add_u32 v4, v212, 4, v4
    v_lshlrev_b32 v203, 4, v4
    v_lshl_add_u32 v222, v212, 10, v216
    s_and_b32 s36, s72, 1
    s_lshl_b32 s74, s45, 1
    s_add_u32 s36, s36, s74
    v_add_u32 v222, s37, v222
    v_xor_b32 v223, 64, v222
    s_lshl_b32 s76, s72, 7
    s_mov_b32 s74, 0
    s_mov_b32 s78, 7
    v_lshrrev_b32 v105, 2, v1
    v_mul_u32_u24 v105, 3584, v105
    v_lshl_add_u32 v105, v215, 7, v105
    s_and_b32 s75, s71, 7
    s_mul_i32 s75, s75, 57344
    s_mul_i32 s73, s72, 448
    s_add_u32 s75, s75, s73
    v_lshrrev_b32 v104, 2, v1
    v_lshlrev_b32 v104, 10, v104
    v_lshl_add_u32 v104, v215, 8, v104
    s_lshr_b32 s73, s2, 3
    s_lshl_b32 s73, s73, 14
    s_and_b32 s39, s72, 1
    s_lshl_b32 s39, s39, 7
    s_add_u32 s73, s73, s39
    s_barrier
    buffer_load_dword v106, v104, s[12:15], s73 offen
    s_mov_b32 s46, 0x2000000
L_lp_1:
    ds_read_b32 v5, v6 offset:76
    s_waitcnt lgkmcnt(0)
    v_readfirstlane_b32 s73, v5
    s_cmp_ge_u32 s73, 6
    s_cbranch_scc1 L_lpd_2
    s_sub_u32 s46, s46, 1
    s_cbranch_scc1 L_lpd_2
    s_branch L_lp_1
L_lpd_2:
L_wq_loop:
    s_mov_b32 m0, s74
    s_add_u32 s74, s74, 1024
    buffer_load_dwordx4 v219, s[12:15], s76 offen lds
    s_add_u32 s76, s76, 8192
    s_mov_b32 m0, s74
    s_add_u32 s74, s74, 1024
    buffer_load_dwordx4 v219, s[12:15], s76 offen lds
    s_add_u32 s76, s76, 8192
    s_mov_b32 m0, s74
    s_add_u32 s74, s74, 1024
    buffer_load_dwordx4 v219, s[12:15], s76 offen lds
    s_add_u32 s76, s76, 8192
    s_mov_b32 m0, s74
    s_add_u32 s74, s74, 1024
    buffer_load_dwordx4 v219, s[12:15], s76 offen lds
    s_add_u32 s76, s76, 8192
    s_mov_b32 m0, s74
    s_add_u32 s74, s74, 1024
    buffer_load_dwordx4 v219, s[12:15], s76 offen lds
    s_add_u32 s76, s76, 8192
    s_mov_b32 m0, s74
    s_add_u32 s74, s74, 1024
    buffer_load_dwordx4 v219, s[12:15], s76 offen lds
    s_add_u32 s76, s76, 8192
    s_mov_b32 m0, s74
    s_add_u32 s74, s74, 1024
    buffer_load_dwordx4 v219, s[12:15], s76 offen lds
    s_add_u32 s76, s76, 8192
    s_mov_b32 m0, s74
    s_add_u32 s74, s74, 1024
    buffer_load_dwordx4 v219, s[12:15], s76 offen lds
    s_add_u32 s76, s76, 8192
    s_and_b32 s76, s76, 0x7ffff
    s_and_b32 s74, s74, 0xffff
    s_waitcnt vmcnt(16)
    s_sub_u32 s78, s78, 1
    s_cbranch_scc0 L_wq_loop
    s_mov_b64 exec, 1
    ds_add_u32 v6, v7 offset:96
    s_mov_b64 exec, -1
    s_waitcnt vmcnt(24)
    s_mov_b64 exec, 1
    ds_add_u32 v6, v7 offset:8
    s_mov_b64 exec, -1
    s_waitcnt vmcnt(0)
    s_mov_b64 exec, 1
    ds_add_u32 v6, v7 offset:8
    s_mov_b64 exec, -1
    s_branch L_ffn
L_pre_56:
    s_and_b32 s36, s72, 1
    s_lshl_b32 s74, s45, 1
    s_add_u32 s36, s36, s74
    v_add_u32 v222, s37, v222
    v_xor_b32 v223, 64, v222
    s_setprio 3
    s_waitcnt vmcnt(0)
L_ln:
    s_lshr_b32 s73, s3, 2
    s_mul_i32 s73, s73, 33792
    s_and_b32 s74, s3, 3
    s_lshl_b32 s74, s74, 7
    s_add_u32 s73, s73, s74
    s_add_u32 s73, s73, 66560
    v_mul_u32_u24 v122, 528, v3
    v_lshl_add_u32 v122, v2, 4, v122
    v_add_u32 v122, s73, v122
    s_cmp_lt_u32 s70, 5
    s_cbranch_scc1 L_ln_a
    ds_write_b128 v122, v[8:11] offset:0
    ds_write_b128 v122, v[12:15] offset:4224
    ds_write_b128 v122, v[16:19] offset:8448
    ds_write_b128 v122, v[20:23] offset:12672
    ds_write_b128 v122, v[24:27] offset:16896
    ds_write_b128 v122, v[28:31] offset:21120
    ds_write_b128 v122, v[32:35] offset:25344
    ds_write_b128 v122, v[36:39] offset:29568
    s_mov_b64 exec, 1
    ds_add_u32 v6, v7 offset:68
    s_mov_b64 exec, -1
L_ln_a:
    v_mov_b32 v110, 0x3f803f80
    v_mov_b64 v[112:113], 0
    v_mov_b32 v108, 0x3f80
    v_mov_b32 v109, 0x3f800000
    v_dot2c_f32_bf16 v112, v8, v110
    v_dot2c_f32_bf16 v113, v9, v110
    v_dot2c_f32_bf16 v112, v10, v110
    v_dot2c_f32_bf16 v113, v11, v110
    v_dot2c_f32_bf16 v112, v12, v110
    v_dot2c_f32_bf16 v113, v13, v110
    v_dot2c_f32_bf16 v112, v14, v110
    v_dot2c_f32_bf16 v113, v15, v110
    v_dot2c_f32_bf16 v112, v16, v110
    v_dot2c_f32_bf16 v113, v17, v110
    v_dot2c_f32_bf16 v112, v18, v110
    v_dot2c_f32_bf16 v113, v19, v110
    v_dot2c_f32_bf16 v112, v20, v110
    v_dot2c_f32_bf16 v113, v21, v110
    v_dot2c_f32_bf16 v112, v22, v110
    v_dot2c_f32_bf16 v113, v23, v110
    v_dot2c_f32_bf16 v112, v24, v110
    v_dot2c_f32_bf16 v113, v25, v110
    v_dot2c_f32_bf16 v112, v26, v110
    v_dot2c_f32_bf16 v113, v27, v110
    v_dot2c_f32_bf16 v112, v28, v110
    v_dot2c_f32_bf16 v113, v29, v110
    v_dot2c_f32_bf16 v112, v30, v110
    v_dot2c_f32_bf16 v113, v31, v110
    v_dot2c_f32_bf16 v112, v32, v110
    v_dot2c_f32_bf16 v113, v33, v110
    v_dot2c_f32_bf16 v112, v34, v110
    v_dot2c_f32_bf16 v113, v35, v110
    v_dot2c_f32_bf16 v112, v36, v110
    v_dot2c_f32_bf16 v113, v37, v110
    v_dot2c_f32_bf16 v112, v38, v110
    v_dot2c_f32_bf16 v113, v39, v110
    s_nop 2
    v_add_f32 v112, v112, v113
    s_nop 1
    v_add_f32_dpp v112, v112, v112 quad_perm:[1,0,3,2] row_mask:0xf bank_mask:0xf
    s_nop 1
    v_add_f32_dpp v112, v112, v112 quad_perm:[2,3,0,1] row_mask:0xf bank_mask:0xf
    s_nop 1
    v_add_f32_dpp v112, v112, v112 row_half_mirror row_mask:0xf bank_mask:0xf
    v_mul_f32 v121, 0xbb000000, v112
    v_cvt_pk_bf16_f32 v120, v121, v121
    v_and_b32 v120, s44, v120
    v_sub_f32 v121, v121, v120
    v_dot2_f32_bf16 v40, v8, v108, v120
    v_dot2_f32_bf16 v41, v8, v109, v120
    v_dot2_f32_bf16 v42, v9, v108, v120
    v_dot2_f32_bf16 v43, v9, v109, v120
    v_dot2_f32_bf16 v44, v10, v108, v120
    v_dot2_f32_bf16 v45, v10, v109, v120
    v_dot2_f32_bf16 v46, v11, v108, v120
    v_dot2_f32_bf16 v47, v11, v109, v120
    v_dot2_f32_bf16 v48, v12, v108, v120
    v_dot2_f32_bf16 v49, v12, v109, v120
    v_dot2_f32_bf16 v50, v13, v108, v120
    v_dot2_f32_bf16 v51, v13, v109, v120
    v_dot2_f32_bf16 v52, v14, v108, v120
    v_dot2_f32_bf16 v53, v14, v109, v120
    v_dot2_f32_bf16 v54, v15, v108, v120
    v_dot2_f32_bf16 v55, v15, v109, v120
    v_dot2_f32_bf16 v56, v16, v108, v120
    v_dot2_f32_bf16 v57, v16, v109, v120
    v_dot2_f32_bf16 v58, v17, v108, v120
    v_dot2_f32_bf16 v59, v17, v109, v120
    v_dot2_f32_bf16 v60, v18, v108, v120
    v_dot2_f32_bf16 v61, v18, v109, v120
    v_dot2_f32_bf16 v62, v19, v108, v120
    v_dot2_f32_bf16 v63, v19, v109, v120
    v_dot2_f32_bf16 v64, v20, v108, v120
    v_dot2_f32_bf16 v65, v20, v109, v120
    v_dot2_f32_bf16 v66, v21, v108, v120
    v_dot2_f32_bf16 v67, v21, v109, v120
    v_dot2_f32_bf16 v68, v22, v108, v120
    v_dot2_f32_bf16 v69, v22, v109, v120
    v_dot2_f32_bf16 v70, v23, v108, v120
    v_dot2_f32_bf16 v71, v23, v109, v120
    v_dot2_f32_bf16 v72, v24, v108, v120
    v_dot2_f32_bf16 v73, v24, v109, v120
    v_dot2_f32_bf16 v74, v25, v108, v120
    v_dot2_f32_bf16 v75, v25, v109, v120
    v_dot2_f32_bf16 v76, v26, v108, v120
    v_dot2_f32_bf16 v77, v26, v109, v120
    v_dot2_f32_bf16 v78, v27, v108, v120
    v_dot2_f32_bf16 v79, v27, v109, v120
    v_dot2_f32_bf16 v80, v28, v108, v120
    v_dot2_f32_bf16 v81, v28, v109, v120
    v_dot2_f32_bf16 v82, v29, v108, v120
    v_dot2_f32_bf16 v83, v29, v109, v120
    v_dot2_f32_bf16 v84, v30, v108, v120
    v_dot2_f32_bf16 v85, v30, v109, v120
    v_dot2_f32_bf16 v86, v31, v108, v120
    v_dot2_f32_bf16 v87, v31, v109, v120
    v_dot2_f32_bf16 v88, v32, v108, v120
    v_dot2_f32_bf16 v89, v32, v109, v120
    v_dot2_f32_bf16 v90, v33, v108, v120
    v_dot2_f32_bf16 v91, v33, v109, v120
    v_dot2_f32_bf16 v92, v34, v108, v120
    v_dot2_f32_bf16 v93, v34, v109, v120
    v_dot2_f32_bf16 v94, v35, v108, v120
    v_dot2_f32_bf16 v95, v35, v109, v120
    v_dot2_f32_bf16 v96, v36, v108, v120
    v_dot2_f32_bf16 v97, v36, v109, v120
    v_dot2_f32_bf16 v98, v37, v108, v120
    v_dot2_f32_bf16 v99, v37, v109, v120
    v_dot2_f32_bf16 v100, v38, v108, v120
    v_dot2_f32_bf16 v101, v38, v109, v120
    v_dot2_f32_bf16 v102, v39, v108, v120
    v_dot2_f32_bf16 v103, v39, v109, v120
    v_pk_mul_f32 v[112:113], v[40:41], v[40:41]
    v_pk_mul_f32 v[114:115], v[42:43], v[42:43]
    v_pk_mul_f32 v[116:117], v[44:45], v[44:45]
    v_pk_mul_f32 v[118:119], v[46:47], v[46:47]
    v_pk_fma_f32 v[112:113], v[48:49], v[48:49], v[112:113]
    v_pk_fma_f32 v[114:115], v[50:51], v[50:51], v[114:115]
    v_pk_fma_f32 v[116:117], v[52:53], v[52:53], v[116:117]
    v_pk_fma_f32 v[118:119], v[54:55], v[54:55], v[118:119]
    v_pk_fma_f32 v[112:113], v[56:57], v[56:57], v[112:113]
    v_pk_fma_f32 v[114:115], v[58:59], v[58:59], v[114:115]
    v_pk_fma_f32 v[116:117], v[60:61], v[60:61], v[116:117]
    v_pk_fma_f32 v[118:119], v[62:63], v[62:63], v[118:119]
    v_pk_fma_f32 v[112:113], v[64:65], v[64:65], v[112:113]
    v_pk_fma_f32 v[114:115], v[66:67], v[66:67], v[114:115]
    v_pk_fma_f32 v[116:117], v[68:69], v[68:69], v[116:117]
    v_pk_fma_f32 v[118:119], v[70:71], v[70:71], v[118:119]
    v_pk_fma_f32 v[112:113], v[72:73], v[72:73], v[112:113]
    v_pk_fma_f32 v[114:115], v[74:75], v[74:75], v[114:115]
    v_pk_fma_f32 v[116:117], v[76:77], v[76:77], v[116:117]
    v_pk_fma_f32 v[118:119], v[78:79], v[78:79], v[118:119]
    v_pk_fma_f32 v[112:113], v[80:81], v[80:81], v[112:113]
    v_pk_fma_f32 v[114:115], v[82:83], v[82:83], v[114:115]
    v_pk_fma_f32 v[116:117], v[84:85], v[84:85], v[116:117]
    v_pk_fma_f32 v[118:119], v[86:87], v[86:87], v[118:119]
    v_pk_fma_f32 v[112:113], v[88:89], v[88:89], v[112:113]
    v_pk_fma_f32 v[114:115], v[90:91], v[90:91], v[114:115]
    v_pk_fma_f32 v[116:117], v[92:93], v[92:93], v[116:117]
    v_pk_fma_f32 v[118:119], v[94:95], v[94:95], v[118:119]
    v_pk_fma_f32 v[112:113], v[96:97], v[96:97], v[112:113]
    v_pk_fma_f32 v[114:115], v[98:99], v[98:99], v[114:115]
    v_pk_fma_f32 v[116:117], v[100:101], v[100:101], v[116:117]
    v_pk_fma_f32 v[118:119], v[102:103], v[102:103], v[118:119]
    v_pk_add_f32 v[112:113], v[112:113], v[114:115]
    v_pk_add_f32 v[116:117], v[116:117], v[118:119]
    v_pk_add_f32 v[112:113], v[112:113], v[116:117]
    v_add_f32 v112, v112, v113
    s_nop 1
    v_add_f32_dpp v112, v112, v112 quad_perm:[1,0,3,2] row_mask:0xf bank_mask:0xf
    s_nop 1
    v_add_f32_dpp v112, v112, v112 quad_perm:[2,3,0,1] row_mask:0xf bank_mask:0xf
    s_nop 1
    v_add_f32_dpp v112, v112, v112 row_half_mirror row_mask:0xf bank_mask:0xf
    v_mul_f32 v119, 0x3b000000, v112
    v_fma_f32 v119, -v121, v121, v119
    v_max_f32 v119, 0, v119
    v_cvt_pk_bf16_f32 v119, v119, v119
    v_and_b32 v119, s44, v119
    v_add_f32 v119, 0x3727c5ac, v119
    v_cvt_pk_bf16_f32 v119, v119, v119
    v_and_b32 v119, s44, v119
    v_sqrt_f32 v119, v119
    s_nop 0
    v_cvt_pk_bf16_f32 v119, v119, v119
    v_and_b32 v119, s44, v119
    v_rcp_f32 v118, v119
    s_cmp_lt_u32 s70, 5
    s_cbranch_scc1 L_ln_b
    s_lshl_b32 s73, s70, 5
    s_add_u32 s73, s73, 163040
    v_lshl_add_u32 v111, v2, 2, s73
    ds_write2_b32 v111, v120, v118 offset1:16
    s_mov_b64 exec, 1
    ds_add_u32 v6, v7 offset:4
    s_mov_b64 exec, -1
    s_mov_b32 s46, 0x2000000
L_lp_3:
    ds_read_b32 v5, v6 offset:72
    s_waitcnt lgkmcnt(0)
    v_readfirstlane_b32 s73, v5
    s_cmp_ge_u32 s73, 1
    s_cbranch_scc1 L_lpd_4
    s_sub_u32 s46, s46, 1
    s_cbranch_scc1 L_lpd_4
    s_branch L_lp_3
L_lpd_4:
L_ln_b:
    v_pk_mul_f32 v[40:41], v[40:41], v[118:119] op_sel_hi:[1,0]
    v_pk_mul_f32 v[42:43], v[42:43], v[118:119] op_sel_hi:[1,0]
    v_pk_mul_f32 v[44:45], v[44:45], v[118:119] op_sel_hi:[1,0]
    v_pk_mul_f32 v[46:47], v[46:47], v[118:119] op_sel_hi:[1,0]
    v_cvt_pk_bf16_f32 v8, v40, v41
    v_cvt_pk_bf16_f32 v9, v42, v43
    v_cvt_pk_bf16_f32 v10, v44, v45
    v_cvt_pk_bf16_f32 v11, v46, v47
    ds_write_b128 v122, v[8:11] offset:0
    v_pk_mul_f32 v[48:49], v[48:49], v[118:119] op_sel_hi:[1,0]
    v_pk_mul_f32 v[50:51], v[50:51], v[118:119] op_sel_hi:[1,0]
    v_pk_mul_f32 v[52:53], v[52:53], v[118:119] op_sel_hi:[1,0]
    v_pk_mul_f32 v[54:55], v[54:55], v[118:119] op_sel_hi:[1,0]
    v_cvt_pk_bf16_f32 v12, v48, v49
    v_cvt_pk_bf16_f32 v13, v50, v51
    v_cvt_pk_bf16_f32 v14, v52, v53
    v_cvt_pk_bf16_f32 v15, v54, v55
    ds_write_b128 v122, v[12:15] offset:4224
    v_pk_mul_f32 v[56:57], v[56:57], v[118:119] op_sel_hi:[1,0]
    v_pk_mul_f32 v[58:59], v[58:59], v[118:119] op_sel_hi:[1,0]
    v_pk_mul_f32 v[60:61], v[60:61], v[118:119] op_sel_hi:[1,0]
    v_pk_mul_f32 v[62:63], v[62:63], v[118:119] op_sel_hi:[1,0]
    v_cvt_pk_bf16_f32 v16, v56, v57
    v_cvt_pk_bf16_f32 v17, v58, v59
    v_cvt_pk_bf16_f32 v18, v60, v61
    v_cvt_pk_bf16_f32 v19, v62, v63
    ds_write_b128 v122, v[16:19] offset:8448
    v_pk_mul_f32 v[64:65], v[64:65], v[118:119] op_sel_hi:[1,0]
    v_pk_mul_f32 v[66:67], v[66:67], v[118:119] op_sel_hi:[1,0]
    v_pk_mul_f32 v[68:69], v[68:69], v[118:119] op_sel_hi:[1,0]
    v_pk_mul_f32 v[70:71], v[70:71], v[118:119] op_sel_hi:[1,0]
    v_cvt_pk_bf16_f32 v20, v64, v65
    v_cvt_pk_bf16_f32 v21, v66, v67
    v_cvt_pk_bf16_f32 v22, v68, v69
    v_cvt_pk_bf16_f32 v23, v70, v71
    ds_write_b128 v122, v[20:23] offset:12672
    v_pk_mul_f32 v[72:73], v[72:73], v[118:119] op_sel_hi:[1,0]
    v_pk_mul_f32 v[74:75], v[74:75], v[118:119] op_sel_hi:[1,0]
    v_pk_mul_f32 v[76:77], v[76:77], v[118:119] op_sel_hi:[1,0]
    v_pk_mul_f32 v[78:79], v[78:79], v[118:119] op_sel_hi:[1,0]
    v_cvt_pk_bf16_f32 v24, v72, v73
    v_cvt_pk_bf16_f32 v25, v74, v75
    v_cvt_pk_bf16_f32 v26, v76, v77
    v_cvt_pk_bf16_f32 v27, v78, v79
    ds_write_b128 v122, v[24:27] offset:16896
    v_pk_mul_f32 v[80:81], v[80:81], v[118:119] op_sel_hi:[1,0]
    v_pk_mul_f32 v[82:83], v[82:83], v[118:119] op_sel_hi:[1,0]
    v_pk_mul_f32 v[84:85], v[84:85], v[118:119] op_sel_hi:[1,0]
    v_pk_mul_f32 v[86:87], v[86:87], v[118:119] op_sel_hi:[1,0]
    v_cvt_pk_bf16_f32 v28, v80, v81
    v_cvt_pk_bf16_f32 v29, v82, v83
    v_cvt_pk_bf16_f32 v30, v84, v85
    v_cvt_pk_bf16_f32 v31, v86, v87
    ds_write_b128 v122, v[28:31] offset:21120
    v_pk_mul_f32 v[88:89], v[88:89], v[118:119] op_sel_hi:[1,0]
    v_pk_mul_f32 v[90:91], v[90:91], v[118:119] op_sel_hi:[1,0]
    v_pk_mul_f32 v[92:93], v[92:93], v[118:119] op_sel_hi:[1,0]
    v_pk_mul_f32 v[94:95], v[94:95], v[118:119] op_sel_hi:[1,0]
    v_cvt_pk_bf16_f32 v32, v88, v89
    v_cvt_pk_bf16_f32 v33, v90, v91
    v_cvt_pk_bf16_f32 v34, v92, v93
    v_cvt_pk_bf16_f32 v35, v94, v95
    ds_write_b128 v122, v[32:35] offset:25344
    v_pk_mul_f32 v[96:97], v[96:97], v[118:119] op_sel_hi:[1,0]
    v_pk_mul_f32 v[98:99], v[98:99], v[118:119] op_sel_hi:[1,0]
    v_pk_mul_f32 v[100:101], v[100:101], v[118:119] op_sel_hi:[1,0]
    v_pk_mul_f32 v[102:103], v[102:103], v[118:119] op_sel_hi:[1,0]
    v_cvt_pk_bf16_f32 v36, v96, v97
    v_cvt_pk_bf16_f32 v37, v98, v99
    v_cvt_pk_bf16_f32 v38, v100, v101
    v_cvt_pk_bf16_f32 v39, v102, v103
    ds_write_b128 v122, v[36:39] offset:29568
    s_mov_b64 exec, 1
    ds_add_u32 v6, v7 offset:0
    s_mov_b64 exec, -1
    s_cmp_eq_u32 s79, 0
    s_cbranch_scc1 L_ln_done
    s_mov_b32 s79, 0
    s_xor_b32 s3, s3, 4
    s_waitcnt vmcnt(0)
    v_mov_b64 v[8:9], v[128:129]
    v_mov_b64 v[10:11], v[130:131]
    v_mov_b64 v[12:13], v[132:133]
    v_mov_b64 v[14:15], v[134:135]
    v_mov_b64 v[16:17], v[136:137]
    v_mov_b64 v[18:19], v[138:139]
    v_mov_b64 v[20:21], v[140:141]
    v_mov_b64 v[22:23], v[142:143]
    v_mov_b64 v[24:25], v[144:145]
    v_mov_b64 v[26:27], v[146:147]
    v_mov_b64 v[28:29], v[148:149]
    v_mov_b64 v[30:31], v[150:151]
    v_mov_b64 v[32:33], v[152:153]
    v_mov_b64 v[34:35], v[154:155]
    v_mov_b64 v[36:37], v[156:157]
    v_mov_b64 v[38:39], v[158:159]
    s_branch L_ln
L_ln_done:
    s_cmp_ge_u32 s70, 4
    s_cbranch_scc1 L_ffn
    v_mov_b64 v[80:81], 0
    v_mov_b64 v[82:83], 0
    v_mov_b64 v[84:85], 0
    v_mov_b64 v[86:87], 0
    v_mov_b64 v[88:89], 0
    v_mov_b64 v[90:91], 0
    v_mov_b64 v[92:93], 0
    v_mov_b64 v[94:95], 0
    v_mov_b64 v[96:97], 0
    v_mov_b64 v[98:99], 0
    v_mov_b64 v[100:101], 0
    v_mov_b64 v[102:103], 0
    v_mov_b64 v[104:105], 0
    v_mov_b64 v[106:107], 0
    v_mov_b64 v[108:109], 0
    v_mov_b64 v[110:111], 0
    s_mov_b32 s46, 0x2000000
L_lp_5:
    ds_read_b32 v5, v6 offset:8
    s_waitcnt lgkmcnt(0)
    v_readfirstlane_b32 s73, v5
    s_cmp_ge_u32 s73, 1
    s_cbranch_scc1 L_lpd_6
    s_sub_u32 s46, s46, 1
    s_cbranch_scc1 L_lpd_6
    s_branch L_lp_5
L_lpd_6:
    buffer_load_dwordx2 v[232:233], v205, s[8:11], s63 offen offset:0
    buffer_load_dwordx2 v[234:235], v205, s[8:11], s63 offen offset:16
    buffer_load_dwordx2 v[236:237], v205, s[8:11], s63 offen offset:32
    buffer_load_dwordx2 v[238:239], v205, s[8:11], s63 offen offset:48
    s_mov_b32 s46, 0x2000000
L_lp_7:
    ds_read_b32 v5, v6 offset:0
    s_waitcnt lgkmcnt(0)
    v_readfirstlane_b32 s73, v5
    s_cmp_ge_u32 s73, 9
    s_cbranch_scc1 L_lpd_8
    s_sub_u32 s46, s46, 1
    s_cbranch_scc1 L_lpd_8
    s_branch L_lp_7
L_lpd_8:
L_q:
    ds_read_b64_tr_b16 v[32:33], v222 offset:0
    ds_read_b64_tr_b16 v[34:35], v222 offset:512
    ds_read_b128 v[36:39], v217 offset:0
    ds_read_b64_tr_b16 v[40:41], v222 offset:2048
    ds_read_b64_tr_b16 v[42:43], v222 offset:2560
    ds_read_b128 v[44:47], v217 offset:1056
    ds_read_b64_tr_b16 v[48:49], v222 offset:4096
    ds_read_b64_tr_b16 v[50:51], v222 offset:4608
    ds_read_b128 v[52:55], v217 offset:2112
    ds_read_b64_tr_b16 v[56:57], v222 offset:6144
    ds_read_b64_tr_b16 v[58:59], v222 offset:6656
    ds_read_b128 v[60:63], v217 offset:3168
    s_waitcnt lgkmcnt(9)
    v_mfma_f32_32x32x16_bf16 v[8:23], v[32:35], v[36:39], 0
    ds_read_b64_tr_b16 v[32:33], v222 offset:8192
    ds_read_b64_tr_b16 v[34:35], v222 offset:8704
    ds_read_b128 v[36:39], v217 offset:4224
    s_waitcnt lgkmcnt(9)
    v_mfma_f32_32x32x16_bf16 v[8:23], v[40:43], v[44:47], v[8:23]
    ds_read_b64_tr_b16 v[40:41], v222 offset:10240
    ds_read_b64_tr_b16 v[42:43], v222 offset:10752
    ds_read_b128 v[44:47], v217 offset:5280
    s_waitcnt lgkmcnt(9)
    v_mfma_f32_32x32x16_bf16 v[8:23], v[48:51], v[52:55], v[8:23]
    ds_read_b64_tr_b16 v[48:49], v222 offset:12288
    ds_read_b64_tr_b16 v[50:51], v222 offset:12800
    ds_read_b128 v[52:55], v217 offset:6336
    s_waitcnt lgkmcnt(9)
    v_mfma_f32_32x32x16_bf16 v[8:23], v[56:59], v[60:63], v[8:23]
    ds_read_b64_tr_b16 v[56:57], v222 offset:14336
    ds_read_b64_tr_b16 v[58:59], v222 offset:14848
    ds_read_b128 v[60:63], v217 offset:7392
    s_waitcnt lgkmcnt(9)
    v_mfma_f32_32x32x16_bf16 v[8:23], v[32:35], v[36:39], v[8:23]
    ds_read_b64_tr_b16 v[32:33], v222 offset:16384
    ds_read_b64_tr_b16 v[34:35], v222 offset:16896
    ds_read_b128 v[36:39], v217 offset:8448
    s_waitcnt lgkmcnt(9)
    v_mfma_f32_32x32x16_bf16 v[8:23], v[40:43], v[44:47], v[8:23]
    ds_read_b64_tr_b16 v[40:41], v222 offset:18432
    ds_read_b64_tr_b16 v[42:43], v222 offset:18944
    ds_read_b128 v[44:47], v217 offset:9504
    s_waitcnt lgkmcnt(9)
    v_mfma_f32_32x32x16_bf16 v[8:23], v[48:51], v[52:55], v[8:23]
    ds_read_b64_tr_b16 v[48:49], v222 offset:20480
    ds_read_b64_tr_b16 v[50:51], v222 offset:20992
    ds_read_b128 v[52:55], v217 offset:10560
    s_waitcnt lgkmcnt(9)
    v_mfma_f32_32x32x16_bf16 v[8:23], v[56:59], v[60:63], v[8:23]
    ds_read_b64_tr_b16 v[56:57], v222 offset:22528
    ds_read_b64_tr_b16 v[58:59], v222 offset:23040
    ds_read_b128 v[60:63], v217 offset:11616
    s_waitcnt lgkmcnt(9)
    v_mfma_f32_32x32x16_bf16 v[8:23], v[32:35], v[36:39], v[8:23]
    ds_read_b64_tr_b16 v[32:33], v222 offset:24576
    ds_read_b64_tr_b16 v[34:35], v222 offset:25088
    ds_read_b128 v[36:39], v217 offset:12672
    s_waitcnt lgkmcnt(9)
    v_mfma_f32_32x32x16_bf16 v[8:23], v[40:43], v[44:47], v[8:23]
    ds_read_b64_tr_b16 v[40:41], v222 offset:26624
    ds_read_b64_tr_b16 v[42:43], v222 offset:27136
    ds_read_b128 v[44:47], v217 offset:13728
    s_waitcnt lgkmcnt(9)
    v_mfma_f32_32x32x16_bf16 v[8:23], v[48:51], v[52:55], v[8:23]
    ds_read_b64_tr_b16 v[48:49], v222 offset:28672
    ds_read_b64_tr_b16 v[50:51], v222 offset:29184
    ds_read_b128 v[52:55], v217 offset:14784
    s_waitcnt lgkmcnt(9)
    v_mfma_f32_32x32x16_bf16 v[8:23], v[56:59], v[60:63], v[8:23]
    ds_read_b64_tr_b16 v[56:57], v222 offset:30720
    ds_read_b64_tr_b16 v[58:59], v222 offset:31232
    ds_read_b128 v[60:63], v217 offset:15840
    s_waitcnt lgkmcnt(9)
    v_mfma_f32_32x32x16_bf16 v[8:23], v[32:35], v[36:39], v[8:23]
    ds_read_b32 v5, v6 offset:8
    ds_read_b64_tr_b16 v[32:33], v222 offset:32768
    ds_read_b64_tr_b16 v[34:35], v222 offset:33280
    ds_read_b128 v[36:39], v217 offset:16896
    s_waitcnt lgkmcnt(10)
    v_mfma_f32_32x32x16_bf16 v[8:23], v[40:43], v[44:47], v[8:23]
    ds_read_b64_tr_b16 v[40:41], v222 offset:34816
    ds_read_b64_tr_b16 v[42:43], v222 offset:35328
    ds_read_b128 v[44:47], v217 offset:17952
    s_waitcnt lgkmcnt(10)
    v_mfma_f32_32x32x16_bf16 v[8:23], v[48:51], v[52:55], v[8:23]
    ds_read_b64_tr_b16 v[48:49], v222 offset:36864
    ds_read_b64_tr_b16 v[50:51], v222 offset:37376
    ds_read_b128 v[52:55], v217 offset:19008
    s_waitcnt lgkmcnt(10)
    v_mfma_f32_32x32x16_bf16 v[8:23], v[56:59], v[60:63], v[8:23]
    ds_read_b64_tr_b16 v[56:57], v222 offset:38912
    ds_read_b64_tr_b16 v[58:59], v222 offset:39424
    ds_read_b128 v[60:63], v217 offset:20064
    s_waitcnt lgkmcnt(9)
    v_mfma_f32_32x32x16_bf16 v[8:23], v[32:35], v[36:39], v[8:23]
    v_readfirstlane_b32 s73, v5
    s_cmp_ge_u32 s73, 2
    s_cbranch_scc0 L_slow_wq
L_back_wq:
    ds_read_b64_tr_b16 v[32:33], v222 offset:40960
    ds_read_b64_tr_b16 v[34:35], v222 offset:41472
    ds_read_b128 v[36:39], v217 offset:21120
    s_waitcnt lgkmcnt(9)
    v_mfma_f32_32x32x16_bf16 v[8:23], v[40:43], v[44:47], v[8:23]
    ds_read_b64_tr_b16 v[40:41], v222 offset:43008
    ds_read_b64_tr_b16 v[42:43], v222 offset:43520
    ds_read_b128 v[44:47], v217 offset:22176
    s_waitcnt lgkmcnt(9)
    v_mfma_f32_32x32x16_bf16 v[8:23], v[48:51], v[52:55], v[8:23]
    ds_read_b64_tr_b16 v[48:49], v222 offset:45056
    ds_read_b64_tr_b16 v[50:51], v222 offset:45568
    ds_read_b128 v[52:55], v217 offset:23232
    s_waitcnt lgkmcnt(9)
    v_mfma_f32_32x32x16_bf16 v[8:23], v[56:59], v[60:63], v[8:23]
    ds_read_b64_tr_b16 v[56:57], v222 offset:47104
    ds_read_b64_tr_b16 v[58:59], v222 offset:47616
    ds_read_b128 v[60:63], v217 offset:24288
    s_waitcnt lgkmcnt(9)
    v_mfma_f32_32x32x16_bf16 v[8:23], v[32:35], v[36:39], v[8:23]
    ds_read_b64_tr_b16 v[32:33], v222 offset:49152
    ds_read_b64_tr_b16 v[34:35], v222 offset:49664
    ds_read_b128 v[36:39], v217 offset:25344
    s_waitcnt lgkmcnt(9)
    v_mfma_f32_32x32x16_bf16 v[8:23], v[40:43], v[44:47], v[8:23]
    ds_read_b64_tr_b16 v[40:41], v222 offset:51200
    ds_read_b64_tr_b16 v[42:43], v222 offset:51712
    ds_read_b128 v[44:47], v217 offset:26400
    s_waitcnt lgkmcnt(9)
    v_mfma_f32_32x32x16_bf16 v[8:23], v[48:51], v[52:55], v[8:23]
    ds_read_b64_tr_b16 v[48:49], v222 offset:53248
    ds_read_b64_tr_b16 v[50:51], v222 offset:53760
    ds_read_b128 v[52:55], v217 offset:27456
    s_waitcnt lgkmcnt(9)
    v_mfma_f32_32x32x16_bf16 v[8:23], v[56:59], v[60:63], v[8:23]
    ds_read_b64_tr_b16 v[56:57], v222 offset:55296
    ds_read_b64_tr_b16 v[58:59], v222 offset:55808
    ds_read_b128 v[60:63], v217 offset:28512
    s_waitcnt lgkmcnt(9)
    v_mfma_f32_32x32x16_bf16 v[8:23], v[32:35], v[36:39], v[8:23]
    ds_read_b64_tr_b16 v[32:33], v222 offset:57344
    ds_read_b64_tr_b16 v[34:35], v222 offset:57856
    ds_read_b128 v[36:39], v217 offset:29568
    s_waitcnt lgkmcnt(9)
    v_mfma_f32_32x32x16_bf16 v[8:23], v[40:43], v[44:47], v[8:23]
    ds_read_b64_tr_b16 v[40:41], v222 offset:59392
    ds_read_b64_tr_b16 v[42:43], v222 offset:59904
    ds_read_b128 v[44:47], v217 offset:30624
    s_waitcnt lgkmcnt(9)
    v_mfma_f32_32x32x16_bf16 v[8:23], v[48:51], v[52:55], v[8:23]
    ds_read_b64_tr_b16 v[48:49], v222 offset:61440
    ds_read_b64_tr_b16 v[50:51], v222 offset:61952
    ds_read_b128 v[52:55], v217 offset:31680
    s_waitcnt lgkmcnt(9)
    v_mfma_f32_32x32x16_bf16 v[8:23], v[56:59], v[60:63], v[8:23]
    ds_read_b64_tr_b16 v[56:57], v222 offset:63488
    ds_read_b64_tr_b16 v[58:59], v222 offset:64000
    ds_read_b128 v[60:63], v217 offset:32736
    s_mov_b64 exec, 1
    ds_add_u32 v6, v7 offset:12
    s_mov_b64 exec, -1
    s_waitcnt lgkmcnt(10)
    v_mfma_f32_32x32x16_bf16 v[8:23], v[32:35], v[36:39], v[8:23]
    s_waitcnt lgkmcnt(7)
    v_mfma_f32_32x32x16_bf16 v[8:23], v[40:43], v[44:47], v[8:23]
    s_waitcnt lgkmcnt(4)
    v_mfma_f32_32x32x16_bf16 v[8:23], v[48:51], v[52:55], v[8:23]
    s_waitcnt lgkmcnt(1)
    v_mfma_f32_32x32x16_bf16 v[8:23], v[56:59], v[60:63], v[8:23]
    v_mov_b32 v28, 0x3eb8aa3b
    s_nop 10
    v_pk_mul_f32 v[8:9], v[8:9], v[28:29] op_sel_hi:[1,0]
    v_pk_mul_f32 v[10:11], v[10:11], v[28:29] op_sel_hi:[1,0]
    v_pk_mul_f32 v[12:13], v[12:13], v[28:29] op_sel_hi:[1,0]
    v_pk_mul_f32 v[14:15], v[14:15], v[28:29] op_sel_hi:[1,0]
    v_pk_mul_f32 v[16:17], v[16:17], v[28:29] op_sel_hi:[1,0]
    v_pk_mul_f32 v[18:19], v[18:19], v[28:29] op_sel_hi:[1,0]
    v_pk_mul_f32 v[20:21], v[20:21], v[28:29] op_sel_hi:[1,0]
    v_pk_mul_f32 v[22:23], v[22:23], v[28:29] op_sel_hi:[1,0]
    v_pk_mul_f32 v[30:31], v[8:9], v[8:9]
    v_pk_mul_f32 v[32:33], v[16:17], v[16:17]
    v_pk_fma_f32 v[30:31], v[10:11], v[10:11], v[30:31]
    v_pk_fma_f32 v[32:33], v[18:19], v[18:19], v[32:33]
    v_pk_fma_f32 v[30:31], v[12:13], v[12:13], v[30:31]
    v_pk_fma_f32 v[32:33], v[20:21], v[20:21], v[32:33]
    v_pk_fma_f32 v[30:31], v[14:15], v[14:15], v[30:31]
    v_pk_fma_f32 v[32:33], v[22:23], v[22:23], v[32:33]
    v_add_f32 v24, v30, v31
    v_add_f32 v25, v32, v33
    v_mov_b32 v26, v24
    v_mov_b32 v27, v25
    v_cvt_pk_bf16_f32 v144, v8, v9
    v_cvt_pk_bf16_f32 v145, v10, v11
    v_cvt_pk_bf16_f32 v146, v12, v13
    v_cvt_pk_bf16_f32 v147, v14, v15
    v_cvt_pk_bf16_f32 v148, v16, v17
    v_cvt_pk_bf16_f32 v149, v18, v19
    v_cvt_pk_bf16_f32 v150, v20, v21
    v_cvt_pk_bf16_f32 v151, v22, v23
    v_permlane32_swap_b32 v24, v26
    v_permlane32_swap_b32 v25, v27
    v_add_f32 v24, v24, v26
    v_add_f32 v25, v25, v27
    s_mov_b32 s46, 0x2000000
L_lp_9:
    ds_read_b32 v5, v6 offset:16
    s_waitcnt lgkmcnt(0)
    v_readfirstlane_b32 s73, v5
    s_cmp_ge_u32 s73, 2
    s_cbranch_scc1 L_lpd_10
    s_sub_u32 s46, s46, 1
    s_cbranch_scc1 L_lpd_10
    s_branch L_lp_9
L_lpd_10:
    ds_read_b32 v206, v6 offset:24
    ds_read_b32 v30, v6 offset:20
    s_waitcnt lgkmcnt(0)
    v_mul_f32 v24, v24, v30
    v_mul_f32 v25, v25, v30
    v_sqrt_f32 v24, v24
    v_sqrt_f32 v25, v25
    s_mov_b32 s74, 0x42200000
    v_max_f32 v26, v24, v25
    v_cmp_nge_f32 vcc, s74, v26
    v_cmp_u_f32 s[4:5], v24, v25
    s_or_b64 s[4:5], s[4:5], vcc
    s_cbranch_scc1 L_fallback
L_att_start:
    v_sub_f32 v112, 0, v24
    v_sub_f32 v113, 0, v24
    v_sub_f32 v128, 0, v25
    v_sub_f32 v129, 0, v25
    v_mov_b64 v[114:115], v[112:113]
    v_mov_b64 v[130:131], v[128:129]
    v_mov_b64 v[116:117], v[112:113]
    v_mov_b64 v[132:133], v[128:129]
    v_mov_b64 v[118:119], v[112:113]
    v_mov_b64 v[134:135], v[128:129]
    v_mov_b64 v[120:121], v[112:113]
    v_mov_b64 v[136:137], v[128:129]
    v_mov_b64 v[122:123], v[112:113]
    v_mov_b64 v[138:139], v[128:129]
    v_mov_b64 v[124:125], v[112:113]
    v_mov_b64 v[140:141], v[128:129]
    v_mov_b64 v[126:127], v[112:113]
    v_mov_b64 v[142:143], v[128:129]
    s_lshl_b32 s73, s72, 7
    s_lshl_b32 s74, s45, 2
    s_add_u32 s73, s73, s74
    s_add_u32 s61, s47, 0x10000
    s_add_u32 s62, s73, s61
    s_mov_b32 s46, 0x2000000
L_lp_11:
    ds_read_b32 v5, v6 offset:116
    s_waitcnt lgkmcnt(0)
    v_readfirstlane_b32 s73, v5
    s_cmp_ge_u32 s73, 1
    s_cbranch_scc1 L_lpd_12
    s_sub_u32 s46, s46, 1
    s_cbranch_scc1 L_lpd_12
    s_branch L_lp_11
L_lpd_12:
    ds_read_b128 v[152:155], v200 offset:0
    ds_read_b128 v[168:171], v201 offset:0
    ds_read_b128 v[172:175], v202 offset:0
    ds_read_b128 v[156:159], v200 offset:2080
    ds_read_b128 v[176:179], v201 offset:2080
    ds_read_b128 v[180:183], v202 offset:2080
    ds_read_b128 v[160:163], v200 offset:4160
    ds_read_b128 v[184:187], v201 offset:4160
    ds_read_b128 v[188:191], v202 offset:4160
    s_waitcnt lgkmcnt(8)
    v_mfma_f32_32x32x16_bf16 v[32:47], v[152:155], v[144:147], v[112:127]
    s_nop 10
    s_waitcnt lgkmcnt(0)
    v_exp_f32 v32, v32
    v_exp_f32 v33, v33
    ds_read_b128 v[164:167], v200 offset:6240
    v_exp_f32 v34, v34
    v_exp_f32 v35, v35
    v_mfma_f32_32x32x16_bf16 v[48:63], v[152:155], v[148:151], v[128:143]
    v_exp_f32 v36, v36
    v_exp_f32 v37, v37
    v_exp_f32 v38, v38
    v_exp_f32 v39, v39
    v_exp_f32 v40, v40
    v_exp_f32 v41, v41
    v_smfmac_f32_32x32x32_bf16 v[80:95], v[168:171], v[32:39], v207
    ds_read_b128 v[192:195], v201 offset:6240
    v_exp_f32 v42, v42
    v_exp_f32 v43, v43
    v_exp_f32 v44, v44
    v_exp_f32 v45, v45
    v_exp_f32 v46, v46
    v_exp_f32 v47, v47
    v_exp_f32 v48, v48
    v_exp_f32 v49, v49
    v_smfmac_f32_32x32x32_bf16 v[80:95], v[172:175], v[40:47], v207
    ds_read_b128 v[196:199], v202 offset:6240
    v_exp_f32 v50, v50
    v_exp_f32 v51, v51
    v_mfma_f32_32x32x16_bf16 v[32:47], v[156:159], v[144:147], v[112:127]
    v_exp_f32 v52, v52
    v_exp_f32 v53, v53
    v_exp_f32 v54, v54
    v_exp_f32 v55, v55
    v_exp_f32 v56, v56
    v_exp_f32 v57, v57
    v_smfmac_f32_32x32x32_bf16 v[96:111], v[168:171], v[48:55], v207
    s_waitcnt lgkmcnt(5)
    v_exp_f32 v58, v58
    v_exp_f32 v59, v59
    v_exp_f32 v60, v60
    v_exp_f32 v61, v61
    v_exp_f32 v62, v62
    v_exp_f32 v63, v63
    v_exp_f32 v32, v32
    v_exp_f32 v33, v33
    v_smfmac_f32_32x32x32_bf16 v[96:111], v[172:175], v[56:63], v207
    ds_read_b128 v[152:155], v200 offset:8320
    v_exp_f32 v34, v34
    v_exp_f32 v35, v35
    v_mfma_f32_32x32x16_bf16 v[48:63], v[156:159], v[148:151], v[128:143]
    ds_read_b32 v5, v6 offset:28
    v_exp_f32 v36, v36
    v_exp_f32 v37, v37
    v_exp_f32 v38, v38
    v_exp_f32 v39, v39
    v_exp_f32 v40, v40
    v_exp_f32 v41, v41
    v_smfmac_f32_32x32x32_bf16 v[80:95], v[176:179], v[32:39], v207
    ds_read_b128 v[168:171], v201 offset:8320
    v_exp_f32 v42, v42
    v_exp_f32 v43, v43
    v_exp_f32 v44, v44
    v_exp_f32 v45, v45
    v_exp_f32 v46, v46
    v_exp_f32 v47, v47
    v_exp_f32 v48, v48
    v_exp_f32 v49, v49
    v_smfmac_f32_32x32x32_bf16 v[80:95], v[180:183], v[40:47], v207
    ds_read_b128 v[172:175], v202 offset:8320
    v_exp_f32 v50, v50
    v_exp_f32 v51, v51
    v_mfma_f32_32x32x16_bf16 v[32:47], v[160:163], v[144:147], v[112:127]
    v_exp_f32 v52, v52
    v_exp_f32 v53, v53
    v_exp_f32 v54, v54
    v_exp_f32 v55, v55
    v_exp_f32 v56, v56
    v_exp_f32 v57, v57
    v_smfmac_f32_32x32x32_bf16 v[96:111], v[176:179], v[48:55], v207
    s_waitcnt lgkmcnt(2)
    v_readfirstlane_b32 s73, v5
    s_cmp_ge_u32 s73, 1
    s_cbranch_scc0 L_slow_a
L_back_a:
    s_mov_b64 exec, 1
    ds_add_u32 v6, v7 offset:88
    s_mov_b64 exec, -1
    v_add_u32 v200, 0xfffdac00, v200
    v_add_u32 v201, 0xfffdac00, v201
    v_add_u32 v202, 0xfffdac00, v202
    v_exp_f32 v58, v58
    v_exp_f32 v59, v59
    v_exp_f32 v60, v60
    v_exp_f32 v61, v61
    v_exp_f32 v62, v62
    v_exp_f32 v63, v63
    v_exp_f32 v32, v32
    v_exp_f32 v33, v33
    v_smfmac_f32_32x32x32_bf16 v[96:111], v[180:183], v[56:63], v207
    ds_read_b128 v[156:159], v200 offset:0
    v_exp_f32 v34, v34
    v_exp_f32 v35, v35
    v_mfma_f32_32x32x16_bf16 v[48:63], v[160:163], v[148:151], v[128:143]
    v_exp_f32 v36, v36
    v_exp_f32 v37, v37
    v_exp_f32 v38, v38
    v_exp_f32 v39, v39
    v_exp_f32 v40, v40
    v_exp_f32 v41, v41
    v_smfmac_f32_32x32x32_bf16 v[80:95], v[184:187], v[32:39], v207
    ds_read_b128 v[176:179], v201 offset:0
    v_exp_f32 v42, v42
    v_exp_f32 v43, v43
    v_exp_f32 v44, v44
    v_exp_f32 v45, v45
    v_exp_f32 v46, v46
    v_exp_f32 v47, v47
    v_exp_f32 v48, v48
    v_exp_f32 v49, v49
    v_smfmac_f32_32x32x32_bf16 v[80:95], v[188:191], v[40:47], v207
    ds_read_b128 v[180:183], v202 offset:0
    v_exp_f32 v50, v50
    v_exp_f32 v51, v51
    v_mfma_f32_32x32x16_bf16 v[32:47], v[164:167], v[144:147], v[112:127]
    v_exp_f32 v52, v52
    v_exp_f32 v53, v53
    v_exp_f32 v54, v54
    v_exp_f32 v55, v55
    v_exp_f32 v56, v56
    v_exp_f32 v57, v57
    v_smfmac_f32_32x32x32_bf16 v[96:111], v[184:187], v[48:55], v207
    s_waitcnt lgkmcnt(5)
    v_exp_f32 v58, v58
    v_exp_f32 v59, v59
    v_exp_f32 v60, v60
    v_exp_f32 v61, v61
    v_exp_f32 v62, v62
    v_exp_f32 v63, v63
    v_exp_f32 v32, v32
    v_exp_f32 v33, v33
    v_smfmac_f32_32x32x32_bf16 v[96:111], v[188:191], v[56:63], v207
    ds_read_b128 v[160:163], v200 offset:2080
    v_exp_f32 v34, v34
    v_exp_f32 v35, v35
    v_mfma_f32_32x32x16_bf16 v[48:63], v[164:167], v[148:151], v[128:143]
    v_exp_f32 v36, v36
    v_exp_f32 v37, v37
    v_exp_f32 v38, v38
    v_exp_f32 v39, v39
    v_exp_f32 v40, v40
    v_exp_f32 v41, v41
    v_smfmac_f32_32x32x32_bf16 v[80:95], v[192:195], v[32:39], v207
    ds_read_b128 v[184:187], v201 offset:2080
    v_exp_f32 v42, v42
    v_exp_f32 v43, v43
    v_exp_f32 v44, v44
    v_exp_f32 v45, v45
    v_exp_f32 v46, v46
    v_exp_f32 v47, v47
    v_exp_f32 v48, v48
    v_exp_f32 v49, v49
    v_smfmac_f32_32x32x32_bf16 v[80:95], v[196:199], v[40:47], v207
    ds_read_b128 v[188:191], v202 offset:2080
    v_exp_f32 v50, v50
    v_exp_f32 v51, v51
    v_mfma_f32_32x32x16_bf16 v[32:47], v[152:155], v[144:147], v[112:127]
    v_exp_f32 v52, v52
    v_exp_f32 v53, v53
    v_exp_f32 v54, v54
    v_exp_f32 v55, v55
    v_exp_f32 v56, v56
    v_exp_f32 v57, v57
    v_smfmac_f32_32x32x32_bf16 v[96:111], v[192:195], v[48:55], v207
    s_waitcnt lgkmcnt(5)
    v_exp_f32 v58, v58
    v_exp_f32 v59, v59
    v_exp_f32 v60, v60
    v_exp_f32 v61, v61
    v_exp_f32 v62, v62
    v_exp_f32 v63, v63
    v_exp_f32 v32, v32
    v_exp_f32 v33, v33
    v_smfmac_f32_32x32x32_bf16 v[96:111], v[196:199], v[56:63], v207
    ds_read_b128 v[164:167], v200 offset:4160
    v_exp_f32 v34, v34
    v_exp_f32 v35, v35
    v_mfma_f32_32x32x16_bf16 v[48:63], v[152:155], v[148:151], v[128:143]
    v_exp_f32 v36, v36
    v_exp_f32 v37, v37
    v_exp_f32 v38, v38
    v_exp_f32 v39, v39
    v_exp_f32 v40, v40
    v_exp_f32 v41, v41
    v_smfmac_f32_32x32x32_bf16 v[80:95], v[168:171], v[32:39], v207
    ds_read_b128 v[192:195], v201 offset:4160
    v_exp_f32 v42, v42
    v_exp_f32 v43, v43
    v_exp_f32 v44, v44
    v_exp_f32 v45, v45
    v_exp_f32 v46, v46
    v_exp_f32 v47, v47
    v_exp_f32 v48, v48
    v_exp_f32 v49, v49
    v_smfmac_f32_32x32x32_bf16 v[80:95], v[172:175], v[40:47], v207
    ds_read_b128 v[196:199], v202 offset:4160
    v_exp_f32 v50, v50
    v_exp_f32 v51, v51
    v_mfma_f32_32x32x16_bf16 v[32:47], v[156:159], v[144:147], v[112:127]
    v_exp_f32 v52, v52
    v_exp_f32 v53, v53
    v_exp_f32 v54, v54
    v_exp_f32 v55, v55
    v_exp_f32 v56, v56
    v_exp_f32 v57, v57
    v_smfmac_f32_32x32x32_bf16 v[96:111], v[168:171], v[48:55], v207
    s_waitcnt lgkmcnt(5)
    v_exp_f32 v58, v58
    v_exp_f32 v59, v59
    v_exp_f32 v60, v60
    v_exp_f32 v61, v61
    v_exp_f32 v62, v62
    v_exp_f32 v63, v63
    v_exp_f32 v32, v32
    v_exp_f32 v33, v33
    v_smfmac_f32_32x32x32_bf16 v[96:111], v[172:175], v[56:63], v207
    ds_read_b128 v[152:155], v200 offset:6240
    v_exp_f32 v34, v34
    v_exp_f32 v35, v35
    v_mfma_f32_32x32x16_bf16 v[48:63], v[156:159], v[148:151], v[128:143]
    v_exp_f32 v36, v36
    v_exp_f32 v37, v37
    v_exp_f32 v38, v38
    v_exp_f32 v39, v39
    v_exp_f32 v40, v40
    v_exp_f32 v41, v41
    v_smfmac_f32_32x32x32_bf16 v[80:95], v[176:179], v[32:39], v207
    ds_read_b128 v[168:171], v201 offset:6240
    v_exp_f32 v42, v42
    v_exp_f32 v43, v43
    v_exp_f32 v44, v44
    v_exp_f32 v45, v45
    v_exp_f32 v46, v46
    v_exp_f32 v47, v47
    v_exp_f32 v48, v48
    v_exp_f32 v49, v49
    v_smfmac_f32_32x32x32_bf16 v[80:95], v[180:183], v[40:47], v207
    ds_read_b128 v[172:175], v202 offset:6240
    v_exp_f32 v50, v50
    v_exp_f32 v51, v51
    v_mfma_f32_32x32x16_bf16 v[32:47], v[160:163], v[144:147], v[112:127]
    v_exp_f32 v52, v52
    v_exp_f32 v53, v53
    v_exp_f32 v54, v54
    v_exp_f32 v55, v55
    v_exp_f32 v56, v56
    v_exp_f32 v57, v57
    v_smfmac_f32_32x32x32_bf16 v[96:111], v[176:179], v[48:55], v207
    s_waitcnt lgkmcnt(5)
    v_exp_f32 v58, v58
    v_exp_f32 v59, v59
    v_exp_f32 v60, v60
    v_exp_f32 v61, v61
    v_exp_f32 v62, v62
    v_exp_f32 v63, v63
    v_exp_f32 v32, v32
    v_exp_f32 v33, v33
    v_smfmac_f32_32x32x32_bf16 v[96:111], v[180:183], v[56:63], v207
    ds_read_b128 v[156:159], v200 offset:8320
    v_exp_f32 v34, v34
    v_exp_f32 v35, v35
    v_mfma_f32_32x32x16_bf16 v[48:63], v[160:163], v[148:151], v[128:143]
    v_exp_f32 v36, v36
    v_exp_f32 v37, v37
    v_exp_f32 v38, v38
    v_exp_f32 v39, v39
    v_exp_f32 v40, v40
    v_exp_f32 v41, v41
    v_smfmac_f32_32x32x32_bf16 v[80:95], v[184:187], v[32:39], v207
    ds_read_b128 v[176:179], v201 offset:8320
    v_exp_f32 v42, v42
    v_exp_f32 v43, v43
    v_exp_f32 v44, v44
    v_exp_f32 v45, v45
    v_exp_f32 v46, v46
    v_exp_f32 v47, v47
    v_exp_f32 v48, v48
    v_exp_f32 v49, v49
    v_smfmac_f32_32x32x32_bf16 v[80:95], v[188:191], v[40:47], v207
    ds_read_b128 v[180:183], v202 offset:8320
    v_exp_f32 v50, v50
    v_exp_f32 v51, v51
    v_mfma_f32_32x32x16_bf16 v[32:47], v[164:167], v[144:147], v[112:127]
    v_exp_f32 v52, v52
    v_exp_f32 v53, v53
    v_exp_f32 v54, v54
    v_exp_f32 v55, v55
    v_exp_f32 v56, v56
    v_exp_f32 v57, v57
    v_smfmac_f32_32x32x32_bf16 v[96:111], v[184:187], v[48:55], v207
    s_waitcnt lgkmcnt(5)
    v_exp_f32 v58, v58
    v_exp_f32 v59, v59
    v_exp_f32 v60, v60
    v_exp_f32 v61, v61
    v_exp_f32 v62, v62
    v_exp_f32 v63, v63
    v_exp_f32 v32, v32
    v_exp_f32 v33, v33
    v_smfmac_f32_32x32x32_bf16 v[96:111], v[188:191], v[56:63], v207
    ds_read_b128 v[160:163], v200 offset:10400
    v_exp_f32 v34, v34
    v_exp_f32 v35, v35
    v_mfma_f32_32x32x16_bf16 v[48:63], v[164:167], v[148:151], v[128:143]
    v_exp_f32 v36, v36
    v_exp_f32 v37, v37
    v_exp_f32 v38, v38
    v_exp_f32 v39, v39
    v_exp_f32 v40, v40
    v_exp_f32 v41, v41
    v_smfmac_f32_32x32x32_bf16 v[80:95], v[192:195], v[32:39], v207
    ds_read_b128 v[184:187], v201 offset:10400
    v_exp_f32 v42, v42
    v_exp_f32 v43, v43
    v_exp_f32 v44, v44
    v_exp_f32 v45, v45
    v_exp_f32 v46, v46
    v_exp_f32 v47, v47
    v_exp_f32 v48, v48
    v_exp_f32 v49, v49
    v_smfmac_f32_32x32x32_bf16 v[80:95], v[196:199], v[40:47], v207
    ds_read_b128 v[188:191], v202 offset:10400
    v_exp_f32 v50, v50
    v_exp_f32 v51, v51
    v_mfma_f32_32x32x16_bf16 v[32:47], v[152:155], v[144:147], v[112:127]
    v_exp_f32 v52, v52
    v_exp_f32 v53, v53
    v_exp_f32 v54, v54
    v_exp_f32 v55, v55
    v_exp_f32 v56, v56
    v_exp_f32 v57, v57
    v_smfmac_f32_32x32x32_bf16 v[96:111], v[192:195], v[48:55], v207
    s_waitcnt lgkmcnt(5)
    v_exp_f32 v58, v58
    v_exp_f32 v59, v59
    v_exp_f32 v60, v60
    v_exp_f32 v61, v61
    v_exp_f32 v62, v62
    v_exp_f32 v63, v63
    v_exp_f32 v32, v32
    v_exp_f32 v33, v33
    v_smfmac_f32_32x32x32_bf16 v[96:111], v[196:199], v[56:63], v207
    ds_read_b128 v[164:167], v200 offset:12480
    v_exp_f32 v34, v34
    v_exp_f32 v35, v35
    v_mfma_f32_32x32x16_bf16 v[48:63], v[152:155], v[148:151], v[128:143]
    v_exp_f32 v36, v36
    v_exp_f32 v37, v37
    v_exp_f32 v38, v38
    v_exp_f32 v39, v39
    v_exp_f32 v40, v40
    v_exp_f32 v41, v41
    v_smfmac_f32_32x32x32_bf16 v[80:95], v[168:171], v[32:39], v207
    ds_read_b128 v[192:195], v201 offset:12480
    v_exp_f32 v42, v42
    v_exp_f32 v43, v43
    v_exp_f32 v44, v44
    v_exp_f32 v45, v45
    v_exp_f32 v46, v46
    v_exp_f32 v47, v47
    v_exp_f32 v48, v48
    v_exp_f32 v49, v49
    v_smfmac_f32_32x32x32_bf16 v[80:95], v[172:175], v[40:47], v207
    ds_read_b128 v[196:199], v202 offset:12480
    v_exp_f32 v50, v50
    v_exp_f32 v51, v51
    v_mfma_f32_32x32x16_bf16 v[32:47], v[156:159], v[144:147], v[112:127]
    v_exp_f32 v52, v52
    v_exp_f32 v53, v53
    v_exp_f32 v54, v54
    v_exp_f32 v55, v55
    v_exp_f32 v56, v56
    v_exp_f32 v57, v57
    v_smfmac_f32_32x32x32_bf16 v[96:111], v[168:171], v[48:55], v207
    s_waitcnt lgkmcnt(5)
    v_exp_f32 v58, v58
    v_exp_f32 v59, v59
    v_exp_f32 v60, v60
    v_exp_f32 v61, v61
    v_exp_f32 v62, v62
    v_exp_f32 v63, v63
    v_exp_f32 v32, v32
    v_exp_f32 v33, v33
    v_smfmac_f32_32x32x32_bf16 v[96:111], v[172:175], v[56:63], v207
    ds_read_b128 v[152:155], v200 offset:14560
    v_exp_f32 v34, v34
    v_exp_f32 v35, v35
    v_mfma_f32_32x32x16_bf16 v[48:63], v[156:159], v[148:151], v[128:143]
    ds_read_b32 v5, v6 offset:28
    v_exp_f32 v36, v36
    v_exp_f32 v37, v37
    v_exp_f32 v38, v38
    v_exp_f32 v39, v39
    v_exp_f32 v40, v40
    v_exp_f32 v41, v41
    v_smfmac_f32_32x32x32_bf16 v[80:95], v[176:179], v[32:39], v207
    ds_read_b128 v[168:171], v201 offset:14560
    v_exp_f32 v42, v42
    v_exp_f32 v43, v43
    v_exp_f32 v44, v44
    v_exp_f32 v45, v45
    v_exp_f32 v46, v46
    v_exp_f32 v47, v47
    v_exp_f32 v48, v48
    v_exp_f32 v49, v49
    v_smfmac_f32_32x32x32_bf16 v[80:95], v[180:183], v[40:47], v207
    ds_read_b128 v[172:175], v202 offset:14560
    v_exp_f32 v50, v50
    v_exp_f32 v51, v51
    v_mfma_f32_32x32x16_bf16 v[32:47], v[160:163], v[144:147], v[112:127]
    v_exp_f32 v52, v52
    v_exp_f32 v53, v53
    v_exp_f32 v54, v54
    v_exp_f32 v55, v55
    v_exp_f32 v56, v56
    v_exp_f32 v57, v57
    v_smfmac_f32_32x32x32_bf16 v[96:111], v[176:179], v[48:55], v207
    s_waitcnt lgkmcnt(2)
    v_readfirstlane_b32 s73, v5
    s_cmp_ge_u32 s73, 2
    s_cbranch_scc0 L_slow_a9
L_back_a9:
    v_exp_f32 v58, v58
    v_exp_f32 v59, v59
    v_exp_f32 v60, v60
    v_exp_f32 v61, v61
    v_exp_f32 v62, v62
    v_exp_f32 v63, v63
    v_exp_f32 v32, v32
    v_exp_f32 v33, v33
    v_smfmac_f32_32x32x32_bf16 v[96:111], v[180:183], v[56:63], v207
    ds_read_b128 v[156:159], v200 offset:16640
    v_exp_f32 v34, v34
    v_exp_f32 v35, v35
    v_mfma_f32_32x32x16_bf16 v[48:63], v[160:163], v[148:151], v[128:143]
    v_exp_f32 v36, v36
    v_exp_f32 v37, v37
    v_exp_f32 v38, v38
    v_exp_f32 v39, v39
    v_exp_f32 v40, v40
    v_exp_f32 v41, v41
    v_smfmac_f32_32x32x32_bf16 v[80:95], v[184:187], v[32:39], v207
    ds_read_b128 v[176:179], v201 offset:16640
    v_exp_f32 v42, v42
    v_exp_f32 v43, v43
    v_exp_f32 v44, v44
    v_exp_f32 v45, v45
    v_exp_f32 v46, v46
    v_exp_f32 v47, v47
    v_exp_f32 v48, v48
    v_exp_f32 v49, v49
    v_smfmac_f32_32x32x32_bf16 v[80:95], v[188:191], v[40:47], v207
    ds_read_b128 v[180:183], v202 offset:16640
    v_exp_f32 v50, v50
    v_exp_f32 v51, v51
    v_mfma_f32_32x32x16_bf16 v[32:47], v[164:167], v[144:147], v[112:127]
    v_exp_f32 v52, v52
    v_exp_f32 v53, v53
    v_exp_f32 v54, v54
    v_exp_f32 v55, v55
    v_exp_f32 v56, v56
    v_exp_f32 v57, v57
    v_smfmac_f32_32x32x32_bf16 v[96:111], v[184:187], v[48:55], v207
    s_waitcnt lgkmcnt(5)
    v_exp_f32 v58, v58
    v_exp_f32 v59, v59
    v_exp_f32 v60, v60
    v_exp_f32 v61, v61
    v_exp_f32 v62, v62
    v_exp_f32 v63, v63
    v_exp_f32 v32, v32
    v_exp_f32 v33, v33
    v_smfmac_f32_32x32x32_bf16 v[96:111], v[188:191], v[56:63], v207
    ds_read_b128 v[160:163], v200 offset:18720
    v_exp_f32 v34, v34
    v_exp_f32 v35, v35
    v_mfma_f32_32x32x16_bf16 v[48:63], v[164:167], v[148:151], v[128:143]
    v_exp_f32 v36, v36
    v_exp_f32 v37, v37
    v_exp_f32 v38, v38
    v_exp_f32 v39, v39
    v_exp_f32 v40, v40
    v_exp_f32 v41, v41
    v_smfmac_f32_32x32x32_bf16 v[80:95], v[192:195], v[32:39], v207
    ds_read_b128 v[184:187], v201 offset:18720
    v_exp_f32 v42, v42
    v_exp_f32 v43, v43
    v_exp_f32 v44, v44
    v_exp_f32 v45, v45
    v_exp_f32 v46, v46
    v_exp_f32 v47, v47
    v_exp_f32 v48, v48
    v_exp_f32 v49, v49
    v_smfmac_f32_32x32x32_bf16 v[80:95], v[196:199], v[40:47], v207
    ds_read_b128 v[188:191], v202 offset:18720
    v_exp_f32 v50, v50
    v_exp_f32 v51, v51
    v_mfma_f32_32x32x16_bf16 v[32:47], v[152:155], v[144:147], v[112:127]
    v_exp_f32 v52, v52
    v_exp_f32 v53, v53
    v_exp_f32 v54, v54
    v_exp_f32 v55, v55
    v_exp_f32 v56, v56
    v_exp_f32 v57, v57
    v_smfmac_f32_32x32x32_bf16 v[96:111], v[192:195], v[48:55], v207
    s_waitcnt lgkmcnt(5)
    v_exp_f32 v58, v58
    v_exp_f32 v59, v59
    v_exp_f32 v60, v60
    v_exp_f32 v61, v61
    v_exp_f32 v62, v62
    v_exp_f32 v63, v63
    v_exp_f32 v32, v32
    v_exp_f32 v33, v33
    v_smfmac_f32_32x32x32_bf16 v[96:111], v[196:199], v[56:63], v207
    ds_read_b128 v[164:167], v200 offset:20800
    v_exp_f32 v34, v34
    v_exp_f32 v35, v35
    v_mfma_f32_32x32x16_bf16 v[48:63], v[152:155], v[148:151], v[128:143]
    v_exp_f32 v36, v36
    v_exp_f32 v37, v37
    v_exp_f32 v38, v38
    v_exp_f32 v39, v39
    v_exp_f32 v40, v40
    v_exp_f32 v41, v41
    v_smfmac_f32_32x32x32_bf16 v[80:95], v[168:171], v[32:39], v207
    ds_read_b128 v[192:195], v201 offset:20800
    v_exp_f32 v42, v42
    v_exp_f32 v43, v43
    v_exp_f32 v44, v44
    v_exp_f32 v45, v45
    v_exp_f32 v46, v46
    v_exp_f32 v47, v47
    v_exp_f32 v48, v48
    v_exp_f32 v49, v49
    v_smfmac_f32_32x32x32_bf16 v[80:95], v[172:175], v[40:47], v207
    ds_read_b128 v[196:199], v202 offset:20800
    v_exp_f32 v50, v50
    v_exp_f32 v51, v51
    v_mfma_f32_32x32x16_bf16 v[32:47], v[156:159], v[144:147], v[112:127]
    v_exp_f32 v52, v52
    v_exp_f32 v53, v53
    v_exp_f32 v54, v54
    v_exp_f32 v55, v55
    v_exp_f32 v56, v56
    v_exp_f32 v57, v57
    v_smfmac_f32_32x32x32_bf16 v[96:111], v[168:171], v[48:55], v207
    s_waitcnt lgkmcnt(5)
    v_exp_f32 v58, v58
    v_exp_f32 v59, v59
    v_exp_f32 v60, v60
    v_exp_f32 v61, v61
    v_exp_f32 v62, v62
    v_exp_f32 v63, v63
    v_exp_f32 v32, v32
    v_exp_f32 v33, v33
    v_smfmac_f32_32x32x32_bf16 v[96:111], v[172:175], v[56:63], v207
    ds_read_b128 v[152:155], v200 offset:22880
    v_exp_f32 v34, v34
    v_exp_f32 v35, v35
    v_mfma_f32_32x32x16_bf16 v[48:63], v[156:159], v[148:151], v[128:143]
    v_exp_f32 v36, v36
    v_exp_f32 v37, v37
    v_exp_f32 v38, v38
    v_exp_f32 v39, v39
    v_exp_f32 v40, v40
    v_exp_f32 v41, v41
    v_smfmac_f32_32x32x32_bf16 v[80:95], v[176:179], v[32:39], v207
    ds_read_b128 v[168:171], v201 offset:22880
    v_exp_f32 v42, v42
    v_exp_f32 v43, v43
    v_exp_f32 v44, v44
    v_exp_f32 v45, v45
    v_exp_f32 v46, v46
    v_exp_f32 v47, v47
    v_exp_f32 v48, v48
    v_exp_f32 v49, v49
    v_smfmac_f32_32x32x32_bf16 v[80:95], v[180:183], v[40:47], v207
    ds_read_b128 v[172:175], v202 offset:22880
    v_exp_f32 v50, v50
    v_exp_f32 v51, v51
    v_mfma_f32_32x32x16_bf16 v[32:47], v[160:163], v[144:147], v[112:127]
    v_exp_f32 v52, v52
    v_exp_f32 v53, v53
    v_exp_f32 v54, v54
    v_exp_f32 v55, v55
    v_exp_f32 v56, v56
    v_exp_f32 v57, v57
    v_smfmac_f32_32x32x32_bf16 v[96:111], v[176:179], v[48:55], v207
    s_waitcnt lgkmcnt(5)
    v_exp_f32 v58, v58
    v_exp_f32 v59, v59
    v_exp_f32 v60, v60
    v_exp_f32 v61, v61
    v_exp_f32 v62, v62
    v_exp_f32 v63, v63
    v_exp_f32 v32, v32
    v_exp_f32 v33, v33
    v_smfmac_f32_32x32x32_bf16 v[96:111], v[180:183], v[56:63], v207
    ds_read_b128 v[156:159], v200 offset:24960
    v_exp_f32 v34, v34
    v_exp_f32 v35, v35
    v_mfma_f32_32x32x16_bf16 v[48:63], v[160:163], v[148:151], v[128:143]
    v_exp_f32 v36, v36
    v_exp_f32 v37, v37
    v_exp_f32 v38, v38
    v_exp_f32 v39, v39
    v_exp_f32 v40, v40
    v_exp_f32 v41, v41
    v_smfmac_f32_32x32x32_bf16 v[80:95], v[184:187], v[32:39], v207
    ds_read_b128 v[176:179], v201 offset:24960
    v_exp_f32 v42, v42
    v_exp_f32 v43, v43
    v_exp_f32 v44, v44
    v_exp_f32 v45, v45
    v_exp_f32 v46, v46
    v_exp_f32 v47, v47
    v_exp_f32 v48, v48
    v_exp_f32 v49, v49
    v_smfmac_f32_32x32x32_bf16 v[80:95], v[188:191], v[40:47], v207
    ds_read_b128 v[180:183], v202 offset:24960
    v_exp_f32 v50, v50
    v_exp_f32 v51, v51
    v_mfma_f32_32x32x16_bf16 v[32:47], v[164:167], v[144:147], v[112:127]
    v_exp_f32 v52, v52
    v_exp_f32 v53, v53
    v_exp_f32 v54, v54
    v_exp_f32 v55, v55
    v_exp_f32 v56, v56
    v_exp_f32 v57, v57
    v_smfmac_f32_32x32x32_bf16 v[96:111], v[184:187], v[48:55], v207
    s_waitcnt lgkmcnt(5)
    v_exp_f32 v58, v58
    v_exp_f32 v59, v59
    v_exp_f32 v60, v60
    v_exp_f32 v61, v61
    v_exp_f32 v62, v62
    v_exp_f32 v63, v63
    v_exp_f32 v32, v32
    v_exp_f32 v33, v33
    v_smfmac_f32_32x32x32_bf16 v[96:111], v[188:191], v[56:63], v207
    ds_read_b128 v[160:163], v200 offset:27040
    v_exp_f32 v34, v34
    v_exp_f32 v35, v35
    v_mfma_f32_32x32x16_bf16 v[48:63], v[164:167], v[148:151], v[128:143]
    v_exp_f32 v36, v36
    v_exp_f32 v37, v37
    v_exp_f32 v38, v38
    v_exp_f32 v39, v39
    v_exp_f32 v40, v40
    v_exp_f32 v41, v41
    v_smfmac_f32_32x32x32_bf16 v[80:95], v[192:195], v[32:39], v207
    ds_read_b128 v[184:187], v201 offset:27040
    v_exp_f32 v42, v42
    v_exp_f32 v43, v43
    v_exp_f32 v44, v44
    v_exp_f32 v45, v45
    v_exp_f32 v46, v46
    v_exp_f32 v47, v47
    v_exp_f32 v48, v48
    v_exp_f32 v49, v49
    v_smfmac_f32_32x32x32_bf16 v[80:95], v[196:199], v[40:47], v207
    ds_read_b128 v[188:191], v202 offset:27040
    v_exp_f32 v50, v50
    v_exp_f32 v51, v51
    v_mfma_f32_32x32x16_bf16 v[32:47], v[152:155], v[144:147], v[112:127]
    v_exp_f32 v52, v52
    v_exp_f32 v53, v53
    v_exp_f32 v54, v54
    v_exp_f32 v55, v55
    v_exp_f32 v56, v56
    v_exp_f32 v57, v57
    v_smfmac_f32_32x32x32_bf16 v[96:111], v[192:195], v[48:55], v207
    s_waitcnt lgkmcnt(5)
    v_exp_f32 v58, v58
    v_exp_f32 v59, v59
    v_exp_f32 v60, v60
    v_exp_f32 v61, v61
    v_exp_f32 v62, v62
    v_exp_f32 v63, v63
    v_exp_f32 v32, v32
    v_exp_f32 v33, v33
    v_smfmac_f32_32x32x32_bf16 v[96:111], v[196:199], v[56:63], v207
    ds_read_b128 v[164:167], v200 offset:29120
    v_exp_f32 v34, v34
    v_exp_f32 v35, v35
    v_mfma_f32_32x32x16_bf16 v[48:63], v[152:155], v[148:151], v[128:143]
    v_exp_f32 v36, v36
    v_exp_f32 v37, v37
    v_exp_f32 v38, v38
    v_exp_f32 v39, v39
    v_exp_f32 v40, v40
    v_exp_f32 v41, v41
    v_smfmac_f32_32x32x32_bf16 v[80:95], v[168:171], v[32:39], v207
    ds_read_b128 v[192:195], v201 offset:29120
    v_exp_f32 v42, v42
    v_exp_f32 v43, v43
    v_exp_f32 v44, v44
    v_exp_f32 v45, v45
    v_exp_f32 v46, v46
    v_exp_f32 v47, v47
    v_exp_f32 v48, v48
    v_exp_f32 v49, v49
    v_smfmac_f32_32x32x32_bf16 v[80:95], v[172:175], v[40:47], v207
    ds_read_b128 v[196:199], v202 offset:29120
    v_exp_f32 v50, v50
    v_exp_f32 v51, v51
    v_mfma_f32_32x32x16_bf16 v[32:47], v[156:159], v[144:147], v[112:127]
    v_exp_f32 v52, v52
    v_exp_f32 v53, v53
    v_exp_f32 v54, v54
    v_exp_f32 v55, v55
    v_exp_f32 v56, v56
    v_exp_f32 v57, v57
    v_smfmac_f32_32x32x32_bf16 v[96:111], v[168:171], v[48:55], v207
    s_waitcnt lgkmcnt(5)
    v_exp_f32 v58, v58
    v_exp_f32 v59, v59
    v_exp_f32 v60, v60
    v_exp_f32 v61, v61
    v_exp_f32 v62, v62
    v_exp_f32 v63, v63
    v_exp_f32 v32, v32
    v_exp_f32 v33, v33
    v_smfmac_f32_32x32x32_bf16 v[96:111], v[172:175], v[56:63], v207
    ds_read_b128 v[152:155], v200 offset:31200
    v_exp_f32 v34, v34
    v_exp_f32 v35, v35
    v_mfma_f32_32x32x16_bf16 v[48:63], v[156:159], v[148:151], v[128:143]
    ds_read_b32 v5, v6 offset:28
    v_exp_f32 v36, v36
    v_exp_f32 v37, v37
    v_exp_f32 v38, v38
    v_exp_f32 v39, v39
    v_exp_f32 v40, v40
    v_exp_f32 v41, v41
    v_smfmac_f32_32x32x32_bf16 v[80:95], v[176:179], v[32:39], v207
    ds_read_b128 v[168:171], v201 offset:31200
    v_exp_f32 v42, v42
    v_exp_f32 v43, v43
    v_exp_f32 v44, v44
    v_exp_f32 v45, v45
    v_exp_f32 v46, v46
    v_exp_f32 v47, v47
    v_exp_f32 v48, v48
    v_exp_f32 v49, v49
    v_smfmac_f32_32x32x32_bf16 v[80:95], v[180:183], v[40:47], v207
    ds_read_b128 v[172:175], v202 offset:31200
    v_exp_f32 v50, v50
    v_exp_f32 v51, v51
    v_mfma_f32_32x32x16_bf16 v[32:47], v[160:163], v[144:147], v[112:127]
    v_exp_f32 v52, v52
    v_exp_f32 v53, v53
    v_exp_f32 v54, v54
    v_exp_f32 v55, v55
    v_exp_f32 v56, v56
    v_exp_f32 v57, v57
    v_smfmac_f32_32x32x32_bf16 v[96:111], v[176:179], v[48:55], v207
    s_waitcnt lgkmcnt(2)
    v_readfirstlane_b32 s73, v5
    s_cmp_ge_u32 s73, 3
    s_cbranch_scc0 L_slow_a17
L_back_a17:
    s_mov_b64 exec, 1
    ds_add_u32 v6, v7 offset:80
    s_mov_b64 exec, -1
    v_exp_f32 v58, v58
    v_exp_f32 v59, v59
    v_exp_f32 v60, v60
    v_exp_f32 v61, v61
    v_exp_f32 v62, v62
    v_exp_f32 v63, v63
    v_exp_f32 v32, v32
    v_exp_f32 v33, v33
    v_smfmac_f32_32x32x32_bf16 v[96:111], v[180:183], v[56:63], v207
    ds_read_b128 v[156:159], v200 offset:33280
    v_exp_f32 v34, v34
    v_exp_f32 v35, v35
    v_mfma_f32_32x32x16_bf16 v[48:63], v[160:163], v[148:151], v[128:143]
    v_exp_f32 v36, v36
    v_exp_f32 v37, v37
    v_exp_f32 v38, v38
    v_exp_f32 v39, v39
    v_exp_f32 v40, v40
    v_exp_f32 v41, v41
    v_smfmac_f32_32x32x32_bf16 v[80:95], v[184:187], v[32:39], v207
    ds_read_b128 v[176:179], v201 offset:33280
    v_exp_f32 v42, v42
    v_exp_f32 v43, v43
    v_exp_f32 v44, v44
    v_exp_f32 v45, v45
    v_exp_f32 v46, v46
    v_exp_f32 v47, v47
    v_exp_f32 v48, v48
    v_exp_f32 v49, v49
    v_smfmac_f32_32x32x32_bf16 v[80:95], v[188:191], v[40:47], v207
    ds_read_b128 v[180:183], v202 offset:33280
    v_exp_f32 v50, v50
    v_exp_f32 v51, v51
    v_mfma_f32_32x32x16_bf16 v[32:47], v[164:167], v[144:147], v[112:127]
    v_exp_f32 v52, v52
    v_exp_f32 v53, v53
    v_exp_f32 v54, v54
    v_exp_f32 v55, v55
    v_exp_f32 v56, v56
    v_exp_f32 v57, v57
    v_smfmac_f32_32x32x32_bf16 v[96:111], v[184:187], v[48:55], v207
    s_waitcnt lgkmcnt(5)
    v_exp_f32 v58, v58
    v_exp_f32 v59, v59
    v_exp_f32 v60, v60
    v_exp_f32 v61, v61
    v_exp_f32 v62, v62
    v_exp_f32 v63, v63
    v_exp_f32 v32, v32
    v_exp_f32 v33, v33
    v_smfmac_f32_32x32x32_bf16 v[96:111], v[188:191], v[56:63], v207
    ds_read_b128 v[160:163], v200 offset:35360
    v_exp_f32 v34, v34
    v_exp_f32 v35, v35
    v_mfma_f32_32x32x16_bf16 v[48:63], v[164:167], v[148:151], v[128:143]
    v_exp_f32 v36, v36
    v_exp_f32 v37, v37
    v_exp_f32 v38, v38
    v_exp_f32 v39, v39
    v_exp_f32 v40, v40
    v_exp_f32 v41, v41
    v_smfmac_f32_32x32x32_bf16 v[80:95], v[192:195], v[32:39], v207
    ds_read_b128 v[184:187], v201 offset:35360
    v_exp_f32 v42, v42
    v_exp_f32 v43, v43
    v_exp_f32 v44, v44
    v_exp_f32 v45, v45
    v_exp_f32 v46, v46
    v_exp_f32 v47, v47
    v_exp_f32 v48, v48
    v_exp_f32 v49, v49
    v_smfmac_f32_32x32x32_bf16 v[80:95], v[196:199], v[40:47], v207
    ds_read_b128 v[188:191], v202 offset:35360
    v_exp_f32 v50, v50
    v_exp_f32 v51, v51
    v_mfma_f32_32x32x16_bf16 v[32:47], v[152:155], v[144:147], v[112:127]
    v_exp_f32 v52, v52
    v_exp_f32 v53, v53
    v_exp_f32 v54, v54
    v_exp_f32 v55, v55
    v_exp_f32 v56, v56
    v_exp_f32 v57, v57
    v_smfmac_f32_32x32x32_bf16 v[96:111], v[192:195], v[48:55], v207
    s_waitcnt lgkmcnt(5)
    v_exp_f32 v58, v58
    v_exp_f32 v59, v59
    v_exp_f32 v60, v60
    v_exp_f32 v61, v61
    v_exp_f32 v62, v62
    v_exp_f32 v63, v63
    v_exp_f32 v32, v32
    v_exp_f32 v33, v33
    v_smfmac_f32_32x32x32_bf16 v[96:111], v[196:199], v[56:63], v207
    ds_read_b128 v[164:167], v200 offset:37440
    v_exp_f32 v34, v34
    v_exp_f32 v35, v35
    v_mfma_f32_32x32x16_bf16 v[48:63], v[152:155], v[148:151], v[128:143]
    v_exp_f32 v36, v36
    v_exp_f32 v37, v37
    v_exp_f32 v38, v38
    v_exp_f32 v39, v39
    v_exp_f32 v40, v40
    v_exp_f32 v41, v41
    v_smfmac_f32_32x32x32_bf16 v[80:95], v[168:171], v[32:39], v207
    ds_read_b128 v[192:195], v201 offset:37440
    v_exp_f32 v42, v42
    v_exp_f32 v43, v43
    v_exp_f32 v44, v44
    v_exp_f32 v45, v45
    v_exp_f32 v46, v46
    v_exp_f32 v47, v47
    v_exp_f32 v48, v48
    v_exp_f32 v49, v49
    v_smfmac_f32_32x32x32_bf16 v[80:95], v[172:175], v[40:47], v207
    ds_read_b128 v[196:199], v202 offset:37440
    v_exp_f32 v50, v50
    v_exp_f32 v51, v51
    v_mfma_f32_32x32x16_bf16 v[32:47], v[156:159], v[144:147], v[112:127]
    v_exp_f32 v52, v52
    v_exp_f32 v53, v53
    v_exp_f32 v54, v54
    v_exp_f32 v55, v55
    v_exp_f32 v56, v56
    v_exp_f32 v57, v57
    v_smfmac_f32_32x32x32_bf16 v[96:111], v[168:171], v[48:55], v207
    s_waitcnt lgkmcnt(5)
    v_exp_f32 v58, v58
    v_exp_f32 v59, v59
    v_exp_f32 v60, v60
    v_exp_f32 v61, v61
    v_exp_f32 v62, v62
    v_exp_f32 v63, v63
    v_exp_f32 v32, v32
    v_exp_f32 v33, v33
    v_smfmac_f32_32x32x32_bf16 v[96:111], v[172:175], v[56:63], v207
    ds_read_b128 v[152:155], v200 offset:39520
    v_exp_f32 v34, v34
    v_exp_f32 v35, v35
    v_mfma_f32_32x32x16_bf16 v[48:63], v[156:159], v[148:151], v[128:143]
    v_exp_f32 v36, v36
    v_exp_f32 v37, v37
    v_exp_f32 v38, v38
    v_exp_f32 v39, v39
    v_exp_f32 v40, v40
    v_exp_f32 v41, v41
    v_smfmac_f32_32x32x32_bf16 v[80:95], v[176:179], v[32:39], v207
    ds_read_b128 v[168:171], v201 offset:39520
    v_exp_f32 v42, v42
    v_exp_f32 v43, v43
    v_exp_f32 v44, v44
    v_exp_f32 v45, v45
    v_exp_f32 v46, v46
    v_exp_f32 v47, v47
    v_exp_f32 v48, v48
    v_exp_f32 v49, v49
    v_smfmac_f32_32x32x32_bf16 v[80:95], v[180:183], v[40:47], v207
    ds_read_b128 v[172:175], v202 offset:39520
    v_exp_f32 v50, v50
    v_exp_f32 v51, v51
    v_mfma_f32_32x32x16_bf16 v[32:47], v[160:163], v[144:147], v[112:127]
    v_exp_f32 v52, v52
    v_exp_f32 v53, v53
    v_exp_f32 v54, v54
    v_exp_f32 v55, v55
    v_exp_f32 v56, v56
    v_exp_f32 v57, v57
    v_smfmac_f32_32x32x32_bf16 v[96:111], v[176:179], v[48:55], v207
    s_waitcnt lgkmcnt(5)
    v_exp_f32 v58, v58
    v_exp_f32 v59, v59
    v_exp_f32 v60, v60
    v_exp_f32 v61, v61
    v_exp_f32 v62, v62
    v_exp_f32 v63, v63
    v_exp_f32 v32, v32
    v_exp_f32 v33, v33
    v_smfmac_f32_32x32x32_bf16 v[96:111], v[180:183], v[56:63], v207
    ds_read_b128 v[156:159], v200 offset:41600
    v_exp_f32 v34, v34
    v_exp_f32 v35, v35
    v_mfma_f32_32x32x16_bf16 v[48:63], v[160:163], v[148:151], v[128:143]
    v_exp_f32 v36, v36
    v_exp_f32 v37, v37
    v_exp_f32 v38, v38
    v_exp_f32 v39, v39
    v_exp_f32 v40, v40
    v_exp_f32 v41, v41
    v_smfmac_f32_32x32x32_bf16 v[80:95], v[184:187], v[32:39], v207
    ds_read_b128 v[176:179], v201 offset:41600
    v_exp_f32 v42, v42
    v_exp_f32 v43, v43
    v_exp_f32 v44, v44
    v_exp_f32 v45, v45
    v_exp_f32 v46, v46
    v_exp_f32 v47, v47
    v_exp_f32 v48, v48
    v_exp_f32 v49, v49
    v_smfmac_f32_32x32x32_bf16 v[80:95], v[188:191], v[40:47], v207
    ds_read_b128 v[180:183], v202 offset:41600
    v_exp_f32 v50, v50
    v_exp_f32 v51, v51
    v_mfma_f32_32x32x16_bf16 v[32:47], v[164:167], v[144:147], v[112:127]
    v_exp_f32 v52, v52
    v_exp_f32 v53, v53
    v_exp_f32 v54, v54
    v_exp_f32 v55, v55
    v_exp_f32 v56, v56
    v_exp_f32 v57, v57
    v_smfmac_f32_32x32x32_bf16 v[96:111], v[184:187], v[48:55], v207
    s_waitcnt lgkmcnt(5)
    v_exp_f32 v58, v58
    v_exp_f32 v59, v59
    v_exp_f32 v60, v60
    v_exp_f32 v61, v61
    v_exp_f32 v62, v62
    v_exp_f32 v63, v63
    v_exp_f32 v32, v32
    v_exp_f32 v33, v33
    v_smfmac_f32_32x32x32_bf16 v[96:111], v[188:191], v[56:63], v207
    ds_read_b128 v[160:163], v200 offset:43680
    v_exp_f32 v34, v34
    v_exp_f32 v35, v35
    v_mfma_f32_32x32x16_bf16 v[48:63], v[164:167], v[148:151], v[128:143]
    v_exp_f32 v36, v36
    v_exp_f32 v37, v37
    v_exp_f32 v38, v38
    v_exp_f32 v39, v39
    v_exp_f32 v40, v40
    v_exp_f32 v41, v41
    v_smfmac_f32_32x32x32_bf16 v[80:95], v[192:195], v[32:39], v207
    ds_read_b128 v[184:187], v201 offset:43680
    v_exp_f32 v42, v42
    v_exp_f32 v43, v43
    v_exp_f32 v44, v44
    v_exp_f32 v45, v45
    v_exp_f32 v46, v46
    v_exp_f32 v47, v47
    v_exp_f32 v48, v48
    v_exp_f32 v49, v49
    v_smfmac_f32_32x32x32_bf16 v[80:95], v[196:199], v[40:47], v207
    ds_read_b128 v[188:191], v202 offset:43680
    v_exp_f32 v50, v50
    v_exp_f32 v51, v51
    v_mfma_f32_32x32x16_bf16 v[32:47], v[152:155], v[144:147], v[112:127]
    v_exp_f32 v52, v52
    v_exp_f32 v53, v53
    v_exp_f32 v54, v54
    v_exp_f32 v55, v55
    v_exp_f32 v56, v56
    v_exp_f32 v57, v57
    v_smfmac_f32_32x32x32_bf16 v[96:111], v[192:195], v[48:55], v207
    s_waitcnt lgkmcnt(5)
    v_exp_f32 v58, v58
    v_exp_f32 v59, v59
    v_exp_f32 v60, v60
    v_exp_f32 v61, v61
    v_exp_f32 v62, v62
    v_exp_f32 v63, v63
    v_exp_f32 v32, v32
    v_exp_f32 v33, v33
    v_smfmac_f32_32x32x32_bf16 v[96:111], v[196:199], v[56:63], v207
    ds_read_b128 v[164:167], v200 offset:45760
    v_exp_f32 v34, v34
    v_exp_f32 v35, v35
    v_mfma_f32_32x32x16_bf16 v[48:63], v[152:155], v[148:151], v[128:143]
    v_exp_f32 v36, v36
    v_exp_f32 v37, v37
    v_exp_f32 v38, v38
    v_exp_f32 v39, v39
    v_exp_f32 v40, v40
    v_exp_f32 v41, v41
    v_smfmac_f32_32x32x32_bf16 v[80:95], v[168:171], v[32:39], v207
    ds_read_b128 v[192:195], v201 offset:45760
    v_exp_f32 v42, v42
    v_exp_f32 v43, v43
    v_exp_f32 v44, v44
    v_exp_f32 v45, v45
    v_exp_f32 v46, v46
    v_exp_f32 v47, v47
    v_exp_f32 v48, v48
    v_exp_f32 v49, v49
    v_smfmac_f32_32x32x32_bf16 v[80:95], v[172:175], v[40:47], v207
    ds_read_b128 v[196:199], v202 offset:45760
    v_exp_f32 v50, v50
    v_exp_f32 v51, v51
    v_mfma_f32_32x32x16_bf16 v[32:47], v[156:159], v[144:147], v[112:127]
    v_exp_f32 v52, v52
    v_exp_f32 v53, v53
    v_exp_f32 v54, v54
    v_exp_f32 v55, v55
    v_exp_f32 v56, v56
    v_exp_f32 v57, v57
    v_smfmac_f32_32x32x32_bf16 v[96:111], v[168:171], v[48:55], v207
    s_waitcnt lgkmcnt(5)
    v_exp_f32 v58, v58
    v_exp_f32 v59, v59
    v_exp_f32 v60, v60
    v_exp_f32 v61, v61
    v_exp_f32 v62, v62
    v_exp_f32 v63, v63
    v_exp_f32 v32, v32
    v_exp_f32 v33, v33
    v_smfmac_f32_32x32x32_bf16 v[96:111], v[172:175], v[56:63], v207
    ds_read_b128 v[152:155], v200 offset:47840
    v_exp_f32 v34, v34
    v_exp_f32 v35, v35
    v_mfma_f32_32x32x16_bf16 v[48:63], v[156:159], v[148:151], v[128:143]
    ds_read_b32 v5, v6 offset:28
    v_exp_f32 v36, v36
    v_exp_f32 v37, v37
    v_exp_f32 v38, v38
    v_exp_f32 v39, v39
    v_exp_f32 v40, v40
    v_exp_f32 v41, v41
    v_smfmac_f32_32x32x32_bf16 v[80:95], v[176:179], v[32:39], v207
    ds_read_b128 v[168:171], v201 offset:47840
    v_exp_f32 v42, v42
    v_exp_f32 v43, v43
    v_exp_f32 v44, v44
    v_exp_f32 v45, v45
    v_exp_f32 v46, v46
    v_exp_f32 v47, v47
    v_exp_f32 v48, v48
    v_exp_f32 v49, v49
    v_smfmac_f32_32x32x32_bf16 v[80:95], v[180:183], v[40:47], v207
    ds_read_b128 v[172:175], v202 offset:47840
    v_exp_f32 v50, v50
    v_exp_f32 v51, v51
    v_mfma_f32_32x32x16_bf16 v[32:47], v[160:163], v[144:147], v[112:127]
    v_exp_f32 v52, v52
    v_exp_f32 v53, v53
    v_exp_f32 v54, v54
    v_exp_f32 v55, v55
    v_exp_f32 v56, v56
    v_exp_f32 v57, v57
    v_smfmac_f32_32x32x32_bf16 v[96:111], v[176:179], v[48:55], v207
    s_waitcnt lgkmcnt(2)
    v_readfirstlane_b32 s73, v5
    s_cmp_ge_u32 s73, 4
    s_cbranch_scc0 L_slow_a25
L_back_a25:
    v_exp_f32 v58, v58
    v_exp_f32 v59, v59
    v_exp_f32 v60, v60
    v_exp_f32 v61, v61
    v_exp_f32 v62, v62
    v_exp_f32 v63, v63
    v_exp_f32 v32, v32
    v_exp_f32 v33, v33
    v_smfmac_f32_32x32x32_bf16 v[96:111], v[180:183], v[56:63], v207
    ds_read_b128 v[156:159], v200 offset:49920
    v_exp_f32 v34, v34
    v_exp_f32 v35, v35
    v_mfma_f32_32x32x16_bf16 v[48:63], v[160:163], v[148:151], v[128:143]
    v_exp_f32 v36, v36
    v_exp_f32 v37, v37
    v_exp_f32 v38, v38
    v_exp_f32 v39, v39
    v_exp_f32 v40, v40
    v_exp_f32 v41, v41
    v_smfmac_f32_32x32x32_bf16 v[80:95], v[184:187], v[32:39], v207
    ds_read_b128 v[176:179], v201 offset:49920
    v_exp_f32 v42, v42
    v_exp_f32 v43, v43
    v_exp_f32 v44, v44
    v_exp_f32 v45, v45
    v_exp_f32 v46, v46
    v_exp_f32 v47, v47
    v_exp_f32 v48, v48
    v_exp_f32 v49, v49
    v_smfmac_f32_32x32x32_bf16 v[80:95], v[188:191], v[40:47], v207
    ds_read_b128 v[180:183], v202 offset:49920
    v_exp_f32 v50, v50
    v_exp_f32 v51, v51
    v_mfma_f32_32x32x16_bf16 v[32:47], v[164:167], v[144:147], v[112:127]
    v_exp_f32 v52, v52
    v_exp_f32 v53, v53
    v_exp_f32 v54, v54
    v_exp_f32 v55, v55
    v_exp_f32 v56, v56
    v_exp_f32 v57, v57
    v_smfmac_f32_32x32x32_bf16 v[96:111], v[184:187], v[48:55], v207
    s_waitcnt lgkmcnt(5)
    v_exp_f32 v58, v58
    v_exp_f32 v59, v59
    v_exp_f32 v60, v60
    v_exp_f32 v61, v61
    v_exp_f32 v62, v62
    v_exp_f32 v63, v63
    v_exp_f32 v32, v32
    v_exp_f32 v33, v33
    v_smfmac_f32_32x32x32_bf16 v[96:111], v[188:191], v[56:63], v207
    ds_read_b128 v[160:163], v200 offset:52000
    v_exp_f32 v34, v34
    v_exp_f32 v35, v35
    v_mfma_f32_32x32x16_bf16 v[48:63], v[164:167], v[148:151], v[128:143]
    v_exp_f32 v36, v36
    v_exp_f32 v37, v37
    v_exp_f32 v38, v38
    v_exp_f32 v39, v39
    v_exp_f32 v40, v40
    v_exp_f32 v41, v41
    v_smfmac_f32_32x32x32_bf16 v[80:95], v[192:195], v[32:39], v207
    ds_read_b128 v[184:187], v201 offset:52000
    v_exp_f32 v42, v42
    v_exp_f32 v43, v43
    v_exp_f32 v44, v44
    v_exp_f32 v45, v45
    v_exp_f32 v46, v46
    v_exp_f32 v47, v47
    v_exp_f32 v48, v48
    v_exp_f32 v49, v49
    v_smfmac_f32_32x32x32_bf16 v[80:95], v[196:199], v[40:47], v207
    ds_read_b128 v[188:191], v202 offset:52000
    v_exp_f32 v50, v50
    v_exp_f32 v51, v51
    v_mfma_f32_32x32x16_bf16 v[32:47], v[152:155], v[144:147], v[112:127]
    v_exp_f32 v52, v52
    v_exp_f32 v53, v53
    v_exp_f32 v54, v54
    v_exp_f32 v55, v55
    v_exp_f32 v56, v56
    v_exp_f32 v57, v57
    v_smfmac_f32_32x32x32_bf16 v[96:111], v[192:195], v[48:55], v207
    s_waitcnt lgkmcnt(5)
    v_exp_f32 v58, v58
    v_exp_f32 v59, v59
    v_exp_f32 v60, v60
    v_exp_f32 v61, v61
    v_exp_f32 v62, v62
    v_exp_f32 v63, v63
    v_exp_f32 v32, v32
    v_exp_f32 v33, v33
    v_smfmac_f32_32x32x32_bf16 v[96:111], v[196:199], v[56:63], v207
    ds_read_b128 v[164:167], v200 offset:54080
    v_exp_f32 v34, v34
    v_exp_f32 v35, v35
    v_mfma_f32_32x32x16_bf16 v[48:63], v[152:155], v[148:151], v[128:143]
    v_exp_f32 v36, v36
    v_exp_f32 v37, v37
    v_exp_f32 v38, v38
    v_exp_f32 v39, v39
    v_exp_f32 v40, v40
    v_exp_f32 v41, v41
    v_smfmac_f32_32x32x32_bf16 v[80:95], v[168:171], v[32:39], v207
    ds_read_b128 v[192:195], v201 offset:54080
    v_exp_f32 v42, v42
    v_exp_f32 v43, v43
    v_exp_f32 v44, v44
    v_exp_f32 v45, v45
    v_exp_f32 v46, v46
    v_exp_f32 v47, v47
    v_exp_f32 v48, v48
    v_exp_f32 v49, v49
    v_smfmac_f32_32x32x32_bf16 v[80:95], v[172:175], v[40:47], v207
    ds_read_b128 v[196:199], v202 offset:54080
    v_exp_f32 v50, v50
    v_exp_f32 v51, v51
    v_mfma_f32_32x32x16_bf16 v[32:47], v[156:159], v[144:147], v[112:127]
    v_exp_f32 v52, v52
    v_exp_f32 v53, v53
    v_exp_f32 v54, v54
    v_exp_f32 v55, v55
    v_exp_f32 v56, v56
    v_exp_f32 v57, v57
    v_smfmac_f32_32x32x32_bf16 v[96:111], v[168:171], v[48:55], v207
    s_waitcnt lgkmcnt(5)
    v_exp_f32 v58, v58
    v_exp_f32 v59, v59
    v_exp_f32 v60, v60
    v_exp_f32 v61, v61
    v_exp_f32 v62, v62
    v_exp_f32 v63, v63
    v_exp_f32 v32, v32
    v_exp_f32 v33, v33
    v_smfmac_f32_32x32x32_bf16 v[96:111], v[172:175], v[56:63], v207
    ds_read_b128 v[152:155], v200 offset:56160
    v_exp_f32 v34, v34
    v_exp_f32 v35, v35
    v_mfma_f32_32x32x16_bf16 v[48:63], v[156:159], v[148:151], v[128:143]
    v_exp_f32 v36, v36
    v_exp_f32 v37, v37
    v_exp_f32 v38, v38
    v_exp_f32 v39, v39
    v_exp_f32 v40, v40
    v_exp_f32 v41, v41
    v_smfmac_f32_32x32x32_bf16 v[80:95], v[176:179], v[32:39], v207
    ds_read_b128 v[168:171], v201 offset:56160
    v_exp_f32 v42, v42
    v_exp_f32 v43, v43
    v_exp_f32 v44, v44
    v_exp_f32 v45, v45
    v_exp_f32 v46, v46
    v_exp_f32 v47, v47
    v_exp_f32 v48, v48
    v_exp_f32 v49, v49
    v_smfmac_f32_32x32x32_bf16 v[80:95], v[180:183], v[40:47], v207
    ds_read_b128 v[172:175], v202 offset:56160
    v_exp_f32 v50, v50
    v_exp_f32 v51, v51
    v_mfma_f32_32x32x16_bf16 v[32:47], v[160:163], v[144:147], v[112:127]
    v_exp_f32 v52, v52
    v_exp_f32 v53, v53
    v_exp_f32 v54, v54
    v_exp_f32 v55, v55
    v_exp_f32 v56, v56
    v_exp_f32 v57, v57
    v_smfmac_f32_32x32x32_bf16 v[96:111], v[176:179], v[48:55], v207
    s_waitcnt lgkmcnt(5)
    v_exp_f32 v58, v58
    v_exp_f32 v59, v59
    v_exp_f32 v60, v60
    v_exp_f32 v61, v61
    v_exp_f32 v62, v62
    v_exp_f32 v63, v63
    v_exp_f32 v32, v32
    v_exp_f32 v33, v33
    v_smfmac_f32_32x32x32_bf16 v[96:111], v[180:183], v[56:63], v207
    ds_read_b128 v[156:159], v200 offset:58240
    v_exp_f32 v34, v34
    v_exp_f32 v35, v35
    v_mfma_f32_32x32x16_bf16 v[48:63], v[160:163], v[148:151], v[128:143]
    v_exp_f32 v36, v36
    v_exp_f32 v37, v37
    v_exp_f32 v38, v38
    v_exp_f32 v39, v39
    v_exp_f32 v40, v40
    v_exp_f32 v41, v41
    v_smfmac_f32_32x32x32_bf16 v[80:95], v[184:187], v[32:39], v207
    ds_read_b128 v[176:179], v201 offset:58240
    v_exp_f32 v42, v42
    v_exp_f32 v43, v43
    v_exp_f32 v44, v44
    v_exp_f32 v45, v45
    v_exp_f32 v46, v46
    v_exp_f32 v47, v47
    v_exp_f32 v48, v48
    v_exp_f32 v49, v49
    v_smfmac_f32_32x32x32_bf16 v[80:95], v[188:191], v[40:47], v207
    ds_read_b128 v[180:183], v202 offset:58240
    v_exp_f32 v50, v50
    v_exp_f32 v51, v51
    v_mfma_f32_32x32x16_bf16 v[32:47], v[164:167], v[144:147], v[112:127]
    v_exp_f32 v52, v52
    v_exp_f32 v53, v53
    v_exp_f32 v54, v54
    v_exp_f32 v55, v55
    v_exp_f32 v56, v56
    v_exp_f32 v57, v57
    v_smfmac_f32_32x32x32_bf16 v[96:111], v[184:187], v[48:55], v207
    s_waitcnt lgkmcnt(5)
    v_exp_f32 v58, v58
    v_exp_f32 v59, v59
    v_exp_f32 v60, v60
    v_exp_f32 v61, v61
    v_exp_f32 v62, v62
    v_exp_f32 v63, v63
    v_exp_f32 v32, v32
    v_exp_f32 v33, v33
    v_smfmac_f32_32x32x32_bf16 v[96:111], v[188:191], v[56:63], v207
    ds_read_b128 v[160:163], v200 offset:60320
    v_exp_f32 v34, v34
    v_exp_f32 v35, v35
    v_mfma_f32_32x32x16_bf16 v[48:63], v[164:167], v[148:151], v[128:143]
    v_exp_f32 v36, v36
    v_exp_f32 v37, v37
    v_exp_f32 v38, v38
    v_exp_f32 v39, v39
    v_exp_f32 v40, v40
    v_exp_f32 v41, v41
    v_smfmac_f32_32x32x32_bf16 v[80:95], v[192:195], v[32:39], v207
    ds_read_b128 v[184:187], v201 offset:60320
    v_exp_f32 v42, v42
    v_exp_f32 v43, v43
    v_exp_f32 v44, v44
    v_exp_f32 v45, v45
    v_exp_f32 v46, v46
    v_exp_f32 v47, v47
    v_exp_f32 v48, v48
    v_exp_f32 v49, v49
    v_smfmac_f32_32x32x32_bf16 v[80:95], v[196:199], v[40:47], v207
    ds_read_b128 v[188:191], v202 offset:60320
    v_exp_f32 v50, v50
    v_exp_f32 v51, v51
    v_mfma_f32_32x32x16_bf16 v[32:47], v[152:155], v[144:147], v[112:127]
    v_exp_f32 v52, v52
    v_exp_f32 v53, v53
    v_exp_f32 v54, v54
    v_exp_f32 v55, v55
    v_exp_f32 v56, v56
    v_exp_f32 v57, v57
    v_smfmac_f32_32x32x32_bf16 v[96:111], v[192:195], v[48:55], v207
    s_waitcnt lgkmcnt(5)
    v_exp_f32 v58, v58
    v_exp_f32 v59, v59
    v_exp_f32 v60, v60
    v_exp_f32 v61, v61
    v_exp_f32 v62, v62
    v_exp_f32 v63, v63
    v_exp_f32 v32, v32
    v_exp_f32 v33, v33
    v_smfmac_f32_32x32x32_bf16 v[96:111], v[196:199], v[56:63], v207
    ds_read_b128 v[164:167], v200 offset:62400
    v_exp_f32 v34, v34
    v_exp_f32 v35, v35
    v_mfma_f32_32x32x16_bf16 v[48:63], v[152:155], v[148:151], v[128:143]
    v_exp_f32 v36, v36
    v_exp_f32 v37, v37
    v_exp_f32 v38, v38
    v_exp_f32 v39, v39
    v_exp_f32 v40, v40
    v_exp_f32 v41, v41
    v_smfmac_f32_32x32x32_bf16 v[80:95], v[168:171], v[32:39], v207
    ds_read_b128 v[192:195], v201 offset:62400
    v_exp_f32 v42, v42
    v_exp_f32 v43, v43
    v_exp_f32 v44, v44
    v_exp_f32 v45, v45
    v_exp_f32 v46, v46
    v_exp_f32 v47, v47
    v_exp_f32 v48, v48
    v_exp_f32 v49, v49
    v_smfmac_f32_32x32x32_bf16 v[80:95], v[172:175], v[40:47], v207
    ds_read_b128 v[196:199], v202 offset:62400
    v_exp_f32 v50, v50
    v_exp_f32 v51, v51
    v_mfma_f32_32x32x16_bf16 v[32:47], v[156:159], v[144:147], v[112:127]
    v_exp_f32 v52, v52
    v_exp_f32 v53, v53
    v_exp_f32 v54, v54
    v_exp_f32 v55, v55
    v_exp_f32 v56, v56
    v_exp_f32 v57, v57
    v_smfmac_f32_32x32x32_bf16 v[96:111], v[168:171], v[48:55], v207
    s_waitcnt lgkmcnt(5)
    v_exp_f32 v58, v58
    v_exp_f32 v59, v59
    v_exp_f32 v60, v60
    v_exp_f32 v61, v61
    v_exp_f32 v62, v62
    v_exp_f32 v63, v63
    v_exp_f32 v32, v32
    v_exp_f32 v33, v33
    v_smfmac_f32_32x32x32_bf16 v[96:111], v[172:175], v[56:63], v207
    ds_read_b128 v[152:155], v200 offset:64480
    v_exp_f32 v34, v34
    v_exp_f32 v35, v35
    v_mfma_f32_32x32x16_bf16 v[48:63], v[156:159], v[148:151], v[128:143]
    ds_read_b32 v5, v6 offset:84
    v_exp_f32 v36, v36
    v_exp_f32 v37, v37
    v_exp_f32 v38, v38
    v_exp_f32 v39, v39
    v_exp_f32 v40, v40
    v_exp_f32 v41, v41
    v_smfmac_f32_32x32x32_bf16 v[80:95], v[176:179], v[32:39], v207
    ds_read_b128 v[168:171], v201 offset:64480
    v_exp_f32 v42, v42
    v_exp_f32 v43, v43
    v_exp_f32 v44, v44
    v_exp_f32 v45, v45
    v_exp_f32 v46, v46
    v_exp_f32 v47, v47
    v_exp_f32 v48, v48
    v_exp_f32 v49, v49
    v_smfmac_f32_32x32x32_bf16 v[80:95], v[180:183], v[40:47], v207
    ds_read_b128 v[172:175], v202 offset:64480
    v_exp_f32 v50, v50
    v_exp_f32 v51, v51
    v_mfma_f32_32x32x16_bf16 v[32:47], v[160:163], v[144:147], v[112:127]
    v_exp_f32 v52, v52
    v_exp_f32 v53, v53
    v_exp_f32 v54, v54
    v_exp_f32 v55, v55
    v_exp_f32 v56, v56
    v_exp_f32 v57, v57
    v_smfmac_f32_32x32x32_bf16 v[96:111], v[176:179], v[48:55], v207
    s_waitcnt lgkmcnt(2)
    v_readfirstlane_b32 s73, v5
    s_cmp_ge_u32 s73, 4
    s_cbranch_scc0 L_slow_l1
L_back_l1:
    v_exp_f32 v58, v58
    v_exp_f32 v59, v59
    v_exp_f32 v60, v60
    v_exp_f32 v61, v61
    v_exp_f32 v62, v62
    v_exp_f32 v63, v63
    v_exp_f32 v32, v32
    v_exp_f32 v33, v33
    v_smfmac_f32_32x32x32_bf16 v[96:111], v[180:183], v[56:63], v207
    ds_read_b128 v[156:159], v200 offset:0
    v_exp_f32 v34, v34
    v_exp_f32 v35, v35
    v_mfma_f32_32x32x16_bf16 v[48:63], v[160:163], v[148:151], v[128:143]
    v_exp_f32 v36, v36
    v_exp_f32 v37, v37
    v_exp_f32 v38, v38
    v_exp_f32 v39, v39
    v_exp_f32 v40, v40
    v_exp_f32 v41, v41
    v_smfmac_f32_32x32x32_bf16 v[80:95], v[184:187], v[32:39], v207
    ds_read_b128 v[176:179], v201 offset:0
    v_exp_f32 v42, v42
    v_exp_f32 v43, v43
    v_exp_f32 v44, v44
    v_exp_f32 v45, v45
    v_exp_f32 v46, v46
    v_exp_f32 v47, v47
    v_exp_f32 v48, v48
    v_exp_f32 v49, v49
    v_smfmac_f32_32x32x32_bf16 v[80:95], v[188:191], v[40:47], v207
    ds_read_b128 v[180:183], v202 offset:0
    v_exp_f32 v50, v50
    v_exp_f32 v51, v51
    v_mfma_f32_32x32x16_bf16 v[32:47], v[164:167], v[144:147], v[112:127]
    v_exp_f32 v52, v52
    v_exp_f32 v53, v53
    v_exp_f32 v54, v54
    v_exp_f32 v55, v55
    v_exp_f32 v56, v56
    v_exp_f32 v57, v57
    v_smfmac_f32_32x32x32_bf16 v[96:111], v[184:187], v[48:55], v207
    s_waitcnt lgkmcnt(5)
    v_exp_f32 v58, v58
    v_exp_f32 v59, v59
    v_exp_f32 v60, v60
    v_exp_f32 v61, v61
    v_exp_f32 v62, v62
    v_exp_f32 v63, v63
    v_exp_f32 v32, v32
    v_exp_f32 v33, v33
    v_smfmac_f32_32x32x32_bf16 v[96:111], v[188:191], v[56:63], v207
    ds_read_b128 v[160:163], v200 offset:2080
    v_exp_f32 v34, v34
    v_exp_f32 v35, v35
    v_mfma_f32_32x32x16_bf16 v[48:63], v[164:167], v[148:151], v[128:143]
    v_exp_f32 v36, v36
    v_exp_f32 v37, v37
    v_exp_f32 v38, v38
    v_exp_f32 v39, v39
    v_exp_f32 v40, v40
    v_exp_f32 v41, v41
    v_smfmac_f32_32x32x32_bf16 v[80:95], v[192:195], v[32:39], v207
    ds_read_b128 v[184:187], v201 offset:2080
    v_exp_f32 v42, v42
    v_exp_f32 v43, v43
    v_exp_f32 v44, v44
    v_exp_f32 v45, v45
    v_exp_f32 v46, v46
    v_exp_f32 v47, v47
    v_exp_f32 v48, v48
    v_exp_f32 v49, v49
    v_smfmac_f32_32x32x32_bf16 v[80:95], v[196:199], v[40:47], v207
    ds_read_b128 v[188:191], v202 offset:2080
    v_exp_f32 v50, v50
    v_exp_f32 v51, v51
    v_mfma_f32_32x32x16_bf16 v[32:47], v[152:155], v[144:147], v[112:127]
    v_exp_f32 v52, v52
    v_exp_f32 v53, v53
    v_exp_f32 v54, v54
    v_exp_f32 v55, v55
    v_exp_f32 v56, v56
    v_exp_f32 v57, v57
    v_smfmac_f32_32x32x32_bf16 v[96:111], v[192:195], v[48:55], v207
    s_waitcnt lgkmcnt(5)
    v_exp_f32 v58, v58
    v_exp_f32 v59, v59
    v_exp_f32 v60, v60
    v_exp_f32 v61, v61
    v_exp_f32 v62, v62
    v_exp_f32 v63, v63
    v_exp_f32 v32, v32
    v_exp_f32 v33, v33
    v_smfmac_f32_32x32x32_bf16 v[96:111], v[196:199], v[56:63], v207
    ds_read_b128 v[164:167], v200 offset:4160
    v_exp_f32 v34, v34
    v_exp_f32 v35, v35
    v_mfma_f32_32x32x16_bf16 v[48:63], v[152:155], v[148:151], v[128:143]
    v_exp_f32 v36, v36
    v_exp_f32 v37, v37
    v_exp_f32 v38, v38
    v_exp_f32 v39, v39
    v_exp_f32 v40, v40
    v_exp_f32 v41, v41
    v_smfmac_f32_32x32x32_bf16 v[80:95], v[168:171], v[32:39], v207
    ds_read_b128 v[192:195], v201 offset:4160
    v_exp_f32 v42, v42
    v_exp_f32 v43, v43
    v_exp_f32 v44, v44
    v_exp_f32 v45, v45
    v_exp_f32 v46, v46
    v_exp_f32 v47, v47
    v_exp_f32 v48, v48
    v_exp_f32 v49, v49
    v_smfmac_f32_32x32x32_bf16 v[80:95], v[172:175], v[40:47], v207
    ds_read_b128 v[196:199], v202 offset:4160
    v_exp_f32 v50, v50
    v_exp_f32 v51, v51
    v_mfma_f32_32x32x16_bf16 v[32:47], v[156:159], v[144:147], v[112:127]
    v_exp_f32 v52, v52
    v_exp_f32 v53, v53
    v_exp_f32 v54, v54
    v_exp_f32 v55, v55
    v_exp_f32 v56, v56
    v_exp_f32 v57, v57
    v_smfmac_f32_32x32x32_bf16 v[96:111], v[168:171], v[48:55], v207
    s_waitcnt lgkmcnt(5)
    v_exp_f32 v58, v58
    v_exp_f32 v59, v59
    v_exp_f32 v60, v60
    v_exp_f32 v61, v61
    v_exp_f32 v62, v62
    v_exp_f32 v63, v63
    v_exp_f32 v32, v32
    v_exp_f32 v33, v33
    v_smfmac_f32_32x32x32_bf16 v[96:111], v[172:175], v[56:63], v207
    ds_read_b128 v[152:155], v200 offset:6240
    v_exp_f32 v34, v34
    v_exp_f32 v35, v35
    v_mfma_f32_32x32x16_bf16 v[48:63], v[156:159], v[148:151], v[128:143]
    v_exp_f32 v36, v36
    v_exp_f32 v37, v37
    v_exp_f32 v38, v38
    v_exp_f32 v39, v39
    v_exp_f32 v40, v40
    v_exp_f32 v41, v41
    v_smfmac_f32_32x32x32_bf16 v[80:95], v[176:179], v[32:39], v207
    ds_read_b128 v[168:171], v201 offset:6240
    v_exp_f32 v42, v42
    v_exp_f32 v43, v43
    v_exp_f32 v44, v44
    v_exp_f32 v45, v45
    v_exp_f32 v46, v46
    v_exp_f32 v47, v47
    v_exp_f32 v48, v48
    v_exp_f32 v49, v49
    v_smfmac_f32_32x32x32_bf16 v[80:95], v[180:183], v[40:47], v207
    ds_read_b128 v[172:175], v202 offset:6240
    v_exp_f32 v50, v50
    v_exp_f32 v51, v51
    v_mfma_f32_32x32x16_bf16 v[32:47], v[160:163], v[144:147], v[112:127]
    v_exp_f32 v52, v52
    v_exp_f32 v53, v53
    v_exp_f32 v54, v54
    v_exp_f32 v55, v55
    v_exp_f32 v56, v56
    v_exp_f32 v57, v57
    v_smfmac_f32_32x32x32_bf16 v[96:111], v[176:179], v[48:55], v207
    s_waitcnt lgkmcnt(5)
    v_exp_f32 v58, v58
    v_exp_f32 v59, v59
    v_exp_f32 v60, v60
    v_exp_f32 v61, v61
    v_exp_f32 v62, v62
    v_exp_f32 v63, v63
    v_exp_f32 v32, v32
    v_exp_f32 v33, v33
    v_smfmac_f32_32x32x32_bf16 v[96:111], v[180:183], v[56:63], v207
    ds_read_b128 v[156:159], v200 offset:8320
    v_exp_f32 v34, v34
    v_exp_f32 v35, v35
    v_mfma_f32_32x32x16_bf16 v[48:63], v[160:163], v[148:151], v[128:143]
    v_exp_f32 v36, v36
    v_exp_f32 v37, v37
    v_exp_f32 v38, v38
    v_exp_f32 v39, v39
    v_exp_f32 v40, v40
    v_exp_f32 v41, v41
    v_smfmac_f32_32x32x32_bf16 v[80:95], v[184:187], v[32:39], v207
    ds_read_b128 v[176:179], v201 offset:8320
    v_exp_f32 v42, v42
    v_exp_f32 v43, v43
    v_exp_f32 v44, v44
    v_exp_f32 v45, v45
    v_exp_f32 v46, v46
    v_exp_f32 v47, v47
    v_exp_f32 v48, v48
    v_exp_f32 v49, v49
    v_smfmac_f32_32x32x32_bf16 v[80:95], v[188:191], v[40:47], v207
    ds_read_b128 v[180:183], v202 offset:8320
    v_exp_f32 v50, v50
    v_exp_f32 v51, v51
    v_mfma_f32_32x32x16_bf16 v[32:47], v[164:167], v[144:147], v[112:127]
    v_exp_f32 v52, v52
    v_exp_f32 v53, v53
    v_exp_f32 v54, v54
    v_exp_f32 v55, v55
    v_exp_f32 v56, v56
    v_exp_f32 v57, v57
    v_smfmac_f32_32x32x32_bf16 v[96:111], v[184:187], v[48:55], v207
    s_waitcnt lgkmcnt(5)
    v_exp_f32 v58, v58
    v_exp_f32 v59, v59
    v_exp_f32 v60, v60
    v_exp_f32 v61, v61
    v_exp_f32 v62, v62
    v_exp_f32 v63, v63
    v_exp_f32 v32, v32
    v_exp_f32 v33, v33
    v_smfmac_f32_32x32x32_bf16 v[96:111], v[188:191], v[56:63], v207
    ds_read_b128 v[160:163], v200 offset:10400
    v_exp_f32 v34, v34
    v_exp_f32 v35, v35
    v_mfma_f32_32x32x16_bf16 v[48:63], v[164:167], v[148:151], v[128:143]
    v_exp_f32 v36, v36
    v_exp_f32 v37, v37
    v_exp_f32 v38, v38
    v_exp_f32 v39, v39
    v_exp_f32 v40, v40
    v_exp_f32 v41, v41
    v_smfmac_f32_32x32x32_bf16 v[80:95], v[192:195], v[32:39], v207
    ds_read_b128 v[184:187], v201 offset:10400
    v_exp_f32 v42, v42
    v_exp_f32 v43, v43
    v_exp_f32 v44, v44
    v_exp_f32 v45, v45
    v_exp_f32 v46, v46
    v_exp_f32 v47, v47
    v_exp_f32 v48, v48
    v_exp_f32 v49, v49
    v_smfmac_f32_32x32x32_bf16 v[80:95], v[196:199], v[40:47], v207
    ds_read_b128 v[188:191], v202 offset:10400
    v_exp_f32 v50, v50
    v_exp_f32 v51, v51
    v_mfma_f32_32x32x16_bf16 v[32:47], v[152:155], v[144:147], v[112:127]
    v_exp_f32 v52, v52
    v_exp_f32 v53, v53
    v_exp_f32 v54, v54
    v_exp_f32 v55, v55
    v_exp_f32 v56, v56
    v_exp_f32 v57, v57
    v_smfmac_f32_32x32x32_bf16 v[96:111], v[192:195], v[48:55], v207
    s_waitcnt lgkmcnt(5)
    v_exp_f32 v58, v58
    v_exp_f32 v59, v59
    v_exp_f32 v60, v60
    v_exp_f32 v61, v61
    v_exp_f32 v62, v62
    v_exp_f32 v63, v63
    v_exp_f32 v32, v32
    v_exp_f32 v33, v33
    v_smfmac_f32_32x32x32_bf16 v[96:111], v[196:199], v[56:63], v207
    ds_read_b128 v[164:167], v200 offset:12480
    v_exp_f32 v34, v34
    v_exp_f32 v35, v35
    v_mfma_f32_32x32x16_bf16 v[48:63], v[152:155], v[148:151], v[128:143]
    v_exp_f32 v36, v36
    v_exp_f32 v37, v37
    v_exp_f32 v38, v38
    v_exp_f32 v39, v39
    v_exp_f32 v40, v40
    v_exp_f32 v41, v41
    v_smfmac_f32_32x32x32_bf16 v[80:95], v[168:171], v[32:39], v207
    ds_read_b128 v[192:195], v201 offset:12480
    v_exp_f32 v42, v42
    v_exp_f32 v43, v43
    v_exp_f32 v44, v44
    v_exp_f32 v45, v45
    v_exp_f32 v46, v46
    v_exp_f32 v47, v47
    v_exp_f32 v48, v48
    v_exp_f32 v49, v49
    v_smfmac_f32_32x32x32_bf16 v[80:95], v[172:175], v[40:47], v207
    ds_read_b128 v[196:199], v202 offset:12480
    v_exp_f32 v50, v50
    v_exp_f32 v51, v51
    v_mfma_f32_32x32x16_bf16 v[32:47], v[156:159], v[144:147], v[112:127]
    v_exp_f32 v52, v52
    v_exp_f32 v53, v53
    v_exp_f32 v54, v54
    v_exp_f32 v55, v55
    v_exp_f32 v56, v56
    v_exp_f32 v57, v57
    v_smfmac_f32_32x32x32_bf16 v[96:111], v[168:171], v[48:55], v207
    s_waitcnt lgkmcnt(5)
    v_exp_f32 v58, v58
    v_exp_f32 v59, v59
    v_exp_f32 v60, v60
    v_exp_f32 v61, v61
    v_exp_f32 v62, v62
    v_exp_f32 v63, v63
    v_exp_f32 v32, v32
    v_exp_f32 v33, v33
    v_smfmac_f32_32x32x32_bf16 v[96:111], v[172:175], v[56:63], v207
    ds_read_b128 v[152:155], v200 offset:14560
    v_exp_f32 v34, v34
    v_exp_f32 v35, v35
    v_mfma_f32_32x32x16_bf16 v[48:63], v[156:159], v[148:151], v[128:143]
    v_exp_f32 v36, v36
    v_exp_f32 v37, v37
    v_exp_f32 v38, v38
    v_exp_f32 v39, v39
    v_exp_f32 v40, v40
    v_exp_f32 v41, v41
    v_smfmac_f32_32x32x32_bf16 v[80:95], v[176:179], v[32:39], v207
    ds_read_b128 v[168:171], v201 offset:14560
    v_exp_f32 v42, v42
    v_exp_f32 v43, v43
    v_exp_f32 v44, v44
    v_exp_f32 v45, v45
    v_exp_f32 v46, v46
    v_exp_f32 v47, v47
    v_exp_f32 v48, v48
    v_exp_f32 v49, v49
    v_smfmac_f32_32x32x32_bf16 v[80:95], v[180:183], v[40:47], v207
    ds_read_b128 v[172:175], v202 offset:14560
    v_exp_f32 v50, v50
    v_exp_f32 v51, v51
    v_mfma_f32_32x32x16_bf16 v[32:47], v[160:163], v[144:147], v[112:127]
    v_exp_f32 v52, v52
    v_exp_f32 v53, v53
    v_exp_f32 v54, v54
    v_exp_f32 v55, v55
    v_exp_f32 v56, v56
    v_exp_f32 v57, v57
    v_smfmac_f32_32x32x32_bf16 v[96:111], v[176:179], v[48:55], v207
    s_waitcnt lgkmcnt(5)
    v_exp_f32 v58, v58
    v_exp_f32 v59, v59
    v_exp_f32 v60, v60
    v_exp_f32 v61, v61
    v_exp_f32 v62, v62
    v_exp_f32 v63, v63
    v_exp_f32 v32, v32
    v_exp_f32 v33, v33
    v_smfmac_f32_32x32x32_bf16 v[96:111], v[180:183], v[56:63], v207
    ds_read_b128 v[156:159], v200 offset:16640
    v_exp_f32 v34, v34
    v_exp_f32 v35, v35
    v_mfma_f32_32x32x16_bf16 v[48:63], v[160:163], v[148:151], v[128:143]
    v_exp_f32 v36, v36
    v_exp_f32 v37, v37
    v_exp_f32 v38, v38
    v_exp_f32 v39, v39
    v_exp_f32 v40, v40
    v_exp_f32 v41, v41
    v_smfmac_f32_32x32x32_bf16 v[80:95], v[184:187], v[32:39], v207
    ds_read_b128 v[176:179], v201 offset:16640
    v_exp_f32 v42, v42
    v_exp_f32 v43, v43
    v_exp_f32 v44, v44
    v_exp_f32 v45, v45
    v_exp_f32 v46, v46
    v_exp_f32 v47, v47
    v_exp_f32 v48, v48
    v_exp_f32 v49, v49
    v_smfmac_f32_32x32x32_bf16 v[80:95], v[188:191], v[40:47], v207
    ds_read_b128 v[180:183], v202 offset:16640
    v_exp_f32 v50, v50
    v_exp_f32 v51, v51
    v_mfma_f32_32x32x16_bf16 v[32:47], v[164:167], v[144:147], v[112:127]
    v_exp_f32 v52, v52
    v_exp_f32 v53, v53
    v_exp_f32 v54, v54
    v_exp_f32 v55, v55
    v_exp_f32 v56, v56
    v_exp_f32 v57, v57
    v_smfmac_f32_32x32x32_bf16 v[96:111], v[184:187], v[48:55], v207
    s_waitcnt lgkmcnt(5)
    v_exp_f32 v58, v58
    v_exp_f32 v59, v59
    v_exp_f32 v60, v60
    v_exp_f32 v61, v61
    v_exp_f32 v62, v62
    v_exp_f32 v63, v63
    v_exp_f32 v32, v32
    v_exp_f32 v33, v33
    v_smfmac_f32_32x32x32_bf16 v[96:111], v[188:191], v[56:63], v207
    ds_read_b128 v[160:163], v200 offset:18720
    v_exp_f32 v34, v34
    v_exp_f32 v35, v35
    v_mfma_f32_32x32x16_bf16 v[48:63], v[164:167], v[148:151], v[128:143]
    v_exp_f32 v36, v36
    v_exp_f32 v37, v37
    v_exp_f32 v38, v38
    v_exp_f32 v39, v39
    v_exp_f32 v40, v40
    v_exp_f32 v41, v41
    v_smfmac_f32_32x32x32_bf16 v[80:95], v[192:195], v[32:39], v207
    ds_read_b128 v[184:187], v201 offset:18720
    v_exp_f32 v42, v42
    v_exp_f32 v43, v43
    v_exp_f32 v44, v44
    v_exp_f32 v45, v45
    v_exp_f32 v46, v46
    v_exp_f32 v47, v47
    v_exp_f32 v48, v48
    v_exp_f32 v49, v49
    v_smfmac_f32_32x32x32_bf16 v[80:95], v[196:199], v[40:47], v207
    ds_read_b128 v[188:191], v202 offset:18720
    v_exp_f32 v50, v50
    v_exp_f32 v51, v51
    v_mfma_f32_32x32x16_bf16 v[32:47], v[152:155], v[144:147], v[112:127]
    v_exp_f32 v52, v52
    v_exp_f32 v53, v53
    v_exp_f32 v54, v54
    v_exp_f32 v55, v55
    v_exp_f32 v56, v56
    v_exp_f32 v57, v57
    v_smfmac_f32_32x32x32_bf16 v[96:111], v[192:195], v[48:55], v207
    s_waitcnt lgkmcnt(5)
    v_exp_f32 v58, v58
    v_exp_f32 v59, v59
    v_exp_f32 v60, v60
    v_exp_f32 v61, v61
    v_exp_f32 v62, v62
    v_exp_f32 v63, v63
    v_exp_f32 v32, v32
    v_exp_f32 v33, v33
    v_smfmac_f32_32x32x32_bf16 v[96:111], v[196:199], v[56:63], v207
    ds_read_b128 v[164:167], v200 offset:20800
    v_exp_f32 v34, v34
    v_exp_f32 v35, v35
    v_mfma_f32_32x32x16_bf16 v[48:63], v[152:155], v[148:151], v[128:143]
    v_exp_f32 v36, v36
    v_exp_f32 v37, v37
    v_exp_f32 v38, v38
    v_exp_f32 v39, v39
    v_exp_f32 v40, v40
    v_exp_f32 v41, v41
    v_smfmac_f32_32x32x32_bf16 v[80:95], v[168:171], v[32:39], v207
    ds_read_b128 v[192:195], v201 offset:20800
    v_exp_f32 v42, v42
    v_exp_f32 v43, v43
    v_exp_f32 v44, v44
    v_exp_f32 v45, v45
    v_exp_f32 v46, v46
    v_exp_f32 v47, v47
    v_exp_f32 v48, v48
    v_exp_f32 v49, v49
    v_smfmac_f32_32x32x32_bf16 v[80:95], v[172:175], v[40:47], v207
    ds_read_b128 v[196:199], v202 offset:20800
    v_exp_f32 v50, v50
    v_exp_f32 v51, v51
    v_mfma_f32_32x32x16_bf16 v[32:47], v[156:159], v[144:147], v[112:127]
    v_exp_f32 v52, v52
    v_exp_f32 v53, v53
    v_exp_f32 v54, v54
    v_exp_f32 v55, v55
    v_exp_f32 v56, v56
    v_exp_f32 v57, v57
    v_smfmac_f32_32x32x32_bf16 v[96:111], v[168:171], v[48:55], v207
    s_waitcnt lgkmcnt(5)
    v_exp_f32 v58, v58
    v_exp_f32 v59, v59
    v_exp_f32 v60, v60
    v_exp_f32 v61, v61
    v_exp_f32 v62, v62
    v_exp_f32 v63, v63
    v_exp_f32 v32, v32
    v_exp_f32 v33, v33
    v_smfmac_f32_32x32x32_bf16 v[96:111], v[172:175], v[56:63], v207
    ds_read_b128 v[152:155], v200 offset:22880
    v_exp_f32 v34, v34
    v_exp_f32 v35, v35
    v_mfma_f32_32x32x16_bf16 v[48:63], v[156:159], v[148:151], v[128:143]
    v_exp_f32 v36, v36
    v_exp_f32 v37, v37
    v_exp_f32 v38, v38
    v_exp_f32 v39, v39
    v_exp_f32 v40, v40
    v_exp_f32 v41, v41
    v_smfmac_f32_32x32x32_bf16 v[80:95], v[176:179], v[32:39], v207
    ds_read_b128 v[168:171], v201 offset:22880
    v_exp_f32 v42, v42
    v_exp_f32 v43, v43
    v_exp_f32 v44, v44
    v_exp_f32 v45, v45
    v_exp_f32 v46, v46
    v_exp_f32 v47, v47
    v_exp_f32 v48, v48
    v_exp_f32 v49, v49
    v_smfmac_f32_32x32x32_bf16 v[80:95], v[180:183], v[40:47], v207
    ds_read_b128 v[172:175], v202 offset:22880
    v_exp_f32 v50, v50
    v_exp_f32 v51, v51
    v_mfma_f32_32x32x16_bf16 v[32:47], v[160:163], v[144:147], v[112:127]
    v_exp_f32 v52, v52
    v_exp_f32 v53, v53
    v_exp_f32 v54, v54
    v_exp_f32 v55, v55
    v_exp_f32 v56, v56
    v_exp_f32 v57, v57
    v_smfmac_f32_32x32x32_bf16 v[96:111], v[176:179], v[48:55], v207
    s_waitcnt lgkmcnt(5)
    v_exp_f32 v58, v58
    v_exp_f32 v59, v59
    v_exp_f32 v60, v60
    v_exp_f32 v61, v61
    v_exp_f32 v62, v62
    v_exp_f32 v63, v63
    v_exp_f32 v32, v32
    v_exp_f32 v33, v33
    v_smfmac_f32_32x32x32_bf16 v[96:111], v[180:183], v[56:63], v207
    ds_read_b128 v[156:159], v200 offset:24960
    v_exp_f32 v34, v34
    v_exp_f32 v35, v35
    v_mfma_f32_32x32x16_bf16 v[48:63], v[160:163], v[148:151], v[128:143]
    v_exp_f32 v36, v36
    v_exp_f32 v37, v37
    v_exp_f32 v38, v38
    v_exp_f32 v39, v39
    v_exp_f32 v40, v40
    v_exp_f32 v41, v41
    v_smfmac_f32_32x32x32_bf16 v[80:95], v[184:187], v[32:39], v207
    ds_read_b128 v[176:179], v201 offset:24960
    v_exp_f32 v42, v42
    v_exp_f32 v43, v43
    v_exp_f32 v44, v44
    v_exp_f32 v45, v45
    v_exp_f32 v46, v46
    v_exp_f32 v47, v47
    v_exp_f32 v48, v48
    v_exp_f32 v49, v49
    v_smfmac_f32_32x32x32_bf16 v[80:95], v[188:191], v[40:47], v207
    ds_read_b128 v[180:183], v202 offset:24960
    v_exp_f32 v50, v50
    v_exp_f32 v51, v51
    v_mfma_f32_32x32x16_bf16 v[32:47], v[164:167], v[144:147], v[112:127]
    v_exp_f32 v52, v52
    v_exp_f32 v53, v53
    v_exp_f32 v54, v54
    v_exp_f32 v55, v55
    v_exp_f32 v56, v56
    v_exp_f32 v57, v57
    v_smfmac_f32_32x32x32_bf16 v[96:111], v[184:187], v[48:55], v207
    s_waitcnt lgkmcnt(5)
    v_exp_f32 v58, v58
    v_exp_f32 v59, v59
    v_exp_f32 v60, v60
    v_exp_f32 v61, v61
    v_exp_f32 v62, v62
    v_exp_f32 v63, v63
    v_exp_f32 v32, v32
    v_exp_f32 v33, v33
    v_smfmac_f32_32x32x32_bf16 v[96:111], v[188:191], v[56:63], v207
    ds_read_b128 v[160:163], v200 offset:27040
    v_exp_f32 v34, v34
    v_exp_f32 v35, v35
    v_mfma_f32_32x32x16_bf16 v[48:63], v[164:167], v[148:151], v[128:143]
    ds_read_b32 v5, v6 offset:40
    v_exp_f32 v36, v36
    v_exp_f32 v37, v37
    v_exp_f32 v38, v38
    v_exp_f32 v39, v39
    v_exp_f32 v40, v40
    v_exp_f32 v41, v41
    v_smfmac_f32_32x32x32_bf16 v[80:95], v[192:195], v[32:39], v207
    ds_read_b128 v[184:187], v201 offset:27040
    v_exp_f32 v42, v42
    v_exp_f32 v43, v43
    v_exp_f32 v44, v44
    v_exp_f32 v45, v45
    v_exp_f32 v46, v46
    v_exp_f32 v47, v47
    v_exp_f32 v48, v48
    v_exp_f32 v49, v49
    v_smfmac_f32_32x32x32_bf16 v[80:95], v[196:199], v[40:47], v207
    ds_read_b128 v[188:191], v202 offset:27040
    v_exp_f32 v50, v50
    v_exp_f32 v51, v51
    v_mfma_f32_32x32x16_bf16 v[32:47], v[152:155], v[144:147], v[112:127]
    v_exp_f32 v52, v52
    v_exp_f32 v53, v53
    v_exp_f32 v54, v54
    v_exp_f32 v55, v55
    v_exp_f32 v56, v56
    v_exp_f32 v57, v57
    v_smfmac_f32_32x32x32_bf16 v[96:111], v[192:195], v[48:55], v207
    s_waitcnt lgkmcnt(2)
    v_readfirstlane_b32 s73, v5
    s_cmp_ge_u32 s73, 4
    s_cbranch_scc0 L_slow_h2
L_back_h2:
    v_exp_f32 v58, v58
    v_exp_f32 v59, v59
    v_exp_f32 v60, v60
    v_exp_f32 v61, v61
    v_exp_f32 v62, v62
    v_exp_f32 v63, v63
    v_exp_f32 v32, v32
    v_exp_f32 v33, v33
    v_smfmac_f32_32x32x32_bf16 v[96:111], v[196:199], v[56:63], v207
    ds_read_b128 v[164:167], v200 offset:29120
    v_exp_f32 v34, v34
    v_exp_f32 v35, v35
    v_mfma_f32_32x32x16_bf16 v[48:63], v[152:155], v[148:151], v[128:143]
    v_exp_f32 v36, v36
    v_exp_f32 v37, v37
    v_exp_f32 v38, v38
    v_exp_f32 v39, v39
    v_exp_f32 v40, v40
    v_exp_f32 v41, v41
    v_smfmac_f32_32x32x32_bf16 v[80:95], v[168:171], v[32:39], v207
    ds_read_b128 v[192:195], v201 offset:29120
    v_exp_f32 v42, v42
    v_exp_f32 v43, v43
    v_exp_f32 v44, v44
    v_exp_f32 v45, v45
    v_exp_f32 v46, v46
    v_exp_f32 v47, v47
    v_exp_f32 v48, v48
    v_exp_f32 v49, v49
    v_smfmac_f32_32x32x32_bf16 v[80:95], v[172:175], v[40:47], v207
    ds_read_b128 v[196:199], v202 offset:29120
    v_exp_f32 v50, v50
    v_exp_f32 v51, v51
    v_mfma_f32_32x32x16_bf16 v[32:47], v[156:159], v[144:147], v[112:127]
    v_exp_f32 v52, v52
    v_exp_f32 v53, v53
    v_exp_f32 v54, v54
    v_exp_f32 v55, v55
    v_exp_f32 v56, v56
    v_exp_f32 v57, v57
    v_smfmac_f32_32x32x32_bf16 v[96:111], v[168:171], v[48:55], v207
    s_waitcnt lgkmcnt(5)
    s_mov_b64 exec, 1
    ds_add_u32 v6, v7 offset:44
    s_mov_b64 exec, -1
    v_add_u32 v200, 0x10400, v200
    v_add_u32 v201, 0x10400, v201
    v_add_u32 v202, 0x10400, v202
    v_exp_f32 v58, v58
    v_exp_f32 v59, v59
    v_exp_f32 v60, v60
    v_exp_f32 v61, v61
    v_exp_f32 v62, v62
    v_exp_f32 v63, v63
    v_exp_f32 v32, v32
    v_exp_f32 v33, v33
    v_smfmac_f32_32x32x32_bf16 v[96:111], v[172:175], v[56:63], v207
    ds_read_b128 v[152:155], v200 offset:0
    v_exp_f32 v34, v34
    v_exp_f32 v35, v35
    v_mfma_f32_32x32x16_bf16 v[48:63], v[156:159], v[148:151], v[128:143]
    v_exp_f32 v36, v36
    v_exp_f32 v37, v37
    v_exp_f32 v38, v38
    v_exp_f32 v39, v39
    v_exp_f32 v40, v40
    v_exp_f32 v41, v41
    v_smfmac_f32_32x32x32_bf16 v[80:95], v[176:179], v[32:39], v207
    ds_read_b128 v[168:171], v201 offset:0
    v_exp_f32 v42, v42
    v_exp_f32 v43, v43
    v_exp_f32 v44, v44
    v_exp_f32 v45, v45
    v_exp_f32 v46, v46
    v_exp_f32 v47, v47
    v_exp_f32 v48, v48
    v_exp_f32 v49, v49
    v_smfmac_f32_32x32x32_bf16 v[80:95], v[180:183], v[40:47], v207
    ds_read_b128 v[172:175], v202 offset:0
    v_exp_f32 v50, v50
    v_exp_f32 v51, v51
    v_mfma_f32_32x32x16_bf16 v[32:47], v[160:163], v[144:147], v[112:127]
    v_exp_f32 v52, v52
    v_exp_f32 v53, v53
    v_exp_f32 v54, v54
    v_exp_f32 v55, v55
    v_exp_f32 v56, v56
    v_exp_f32 v57, v57
    v_smfmac_f32_32x32x32_bf16 v[96:111], v[176:179], v[48:55], v207
    s_waitcnt lgkmcnt(5)
    v_exp_f32 v58, v58
    v_exp_f32 v59, v59
    v_exp_f32 v60, v60
    v_exp_f32 v61, v61
    v_exp_f32 v62, v62
    v_exp_f32 v63, v63
    v_exp_f32 v32, v32
    v_exp_f32 v33, v33
    v_smfmac_f32_32x32x32_bf16 v[96:111], v[180:183], v[56:63], v207
    ds_read_b128 v[156:159], v200 offset:2080
    v_exp_f32 v34, v34
    v_exp_f32 v35, v35
    v_mfma_f32_32x32x16_bf16 v[48:63], v[160:163], v[148:151], v[128:143]
    v_exp_f32 v36, v36
    v_exp_f32 v37, v37
    v_exp_f32 v38, v38
    v_exp_f32 v39, v39
    v_exp_f32 v40, v40
    v_exp_f32 v41, v41
    v_smfmac_f32_32x32x32_bf16 v[80:95], v[184:187], v[32:39], v207
    ds_read_b128 v[176:179], v201 offset:2080
    v_exp_f32 v42, v42
    v_exp_f32 v43, v43
    v_exp_f32 v44, v44
    v_exp_f32 v45, v45
    v_exp_f32 v46, v46
    v_exp_f32 v47, v47
    v_exp_f32 v48, v48
    v_exp_f32 v49, v49
    v_smfmac_f32_32x32x32_bf16 v[80:95], v[188:191], v[40:47], v207
    ds_read_b128 v[180:183], v202 offset:2080
    v_exp_f32 v50, v50
    v_exp_f32 v51, v51
    v_mfma_f32_32x32x16_bf16 v[32:47], v[164:167], v[144:147], v[112:127]
    v_exp_f32 v52, v52
    v_exp_f32 v53, v53
    v_exp_f32 v54, v54
    v_exp_f32 v55, v55
    v_exp_f32 v56, v56
    v_exp_f32 v57, v57
    v_smfmac_f32_32x32x32_bf16 v[96:111], v[184:187], v[48:55], v207
    s_waitcnt lgkmcnt(5)
    v_exp_f32 v58, v58
    v_exp_f32 v59, v59
    v_exp_f32 v60, v60
    v_exp_f32 v61, v61
    v_exp_f32 v62, v62
    v_exp_f32 v63, v63
    v_exp_f32 v32, v32
    v_exp_f32 v33, v33
    v_smfmac_f32_32x32x32_bf16 v[96:111], v[188:191], v[56:63], v207
    ds_read_b128 v[160:163], v200 offset:4160
    v_exp_f32 v34, v34
    v_exp_f32 v35, v35
    v_mfma_f32_32x32x16_bf16 v[48:63], v[164:167], v[148:151], v[128:143]
    v_exp_f32 v36, v36
    v_exp_f32 v37, v37
    v_exp_f32 v38, v38
    v_exp_f32 v39, v39
    v_exp_f32 v40, v40
    v_exp_f32 v41, v41
    v_smfmac_f32_32x32x32_bf16 v[80:95], v[192:195], v[32:39], v207
    ds_read_b128 v[184:187], v201 offset:4160
    v_exp_f32 v42, v42
    v_exp_f32 v43, v43
    v_exp_f32 v44, v44
    v_exp_f32 v45, v45
    v_exp_f32 v46, v46
    v_exp_f32 v47, v47
    v_exp_f32 v48, v48
    v_exp_f32 v49, v49
    v_smfmac_f32_32x32x32_bf16 v[80:95], v[196:199], v[40:47], v207
    ds_read_b128 v[188:191], v202 offset:4160
    v_exp_f32 v50, v50
    v_exp_f32 v51, v51
    v_mfma_f32_32x32x16_bf16 v[32:47], v[152:155], v[144:147], v[112:127]
    v_exp_f32 v52, v52
    v_exp_f32 v53, v53
    v_exp_f32 v54, v54
    v_exp_f32 v55, v55
    v_exp_f32 v56, v56
    v_exp_f32 v57, v57
    v_smfmac_f32_32x32x32_bf16 v[96:111], v[192:195], v[48:55], v207
    s_waitcnt lgkmcnt(5)
    v_exp_f32 v58, v58
    v_exp_f32 v59, v59
    v_exp_f32 v60, v60
    v_exp_f32 v61, v61
    v_exp_f32 v62, v62
    v_exp_f32 v63, v63
    v_exp_f32 v32, v32
    v_exp_f32 v33, v33
    v_smfmac_f32_32x32x32_bf16 v[96:111], v[196:199], v[56:63], v207
    ds_read_b128 v[164:167], v200 offset:6240
    v_exp_f32 v34, v34
    v_exp_f32 v35, v35
    v_mfma_f32_32x32x16_bf16 v[48:63], v[152:155], v[148:151], v[128:143]
    v_exp_f32 v36, v36
    v_exp_f32 v37, v37
    v_exp_f32 v38, v38
    v_exp_f32 v39, v39
    v_exp_f32 v40, v40
    v_exp_f32 v41, v41
    v_smfmac_f32_32x32x32_bf16 v[80:95], v[168:171], v[32:39], v207
    ds_read_b128 v[192:195], v201 offset:6240
    v_exp_f32 v42, v42
    v_exp_f32 v43, v43
    v_exp_f32 v44, v44
    v_exp_f32 v45, v45
    v_exp_f32 v46, v46
    v_exp_f32 v47, v47
    v_exp_f32 v48, v48
    v_exp_f32 v49, v49
    v_smfmac_f32_32x32x32_bf16 v[80:95], v[172:175], v[40:47], v207
    ds_read_b128 v[196:199], v202 offset:6240
    v_exp_f32 v50, v50
    v_exp_f32 v51, v51
    v_mfma_f32_32x32x16_bf16 v[32:47], v[156:159], v[144:147], v[112:127]
    v_exp_f32 v52, v52
    v_exp_f32 v53, v53
    v_exp_f32 v54, v54
    v_exp_f32 v55, v55
    v_exp_f32 v56, v56
    v_exp_f32 v57, v57
    v_smfmac_f32_32x32x32_bf16 v[96:111], v[168:171], v[48:55], v207
    s_waitcnt lgkmcnt(5)
    v_exp_f32 v58, v58
    v_exp_f32 v59, v59
    v_exp_f32 v60, v60
    v_exp_f32 v61, v61
    v_exp_f32 v62, v62
    v_exp_f32 v63, v63
    v_exp_f32 v32, v32
    v_exp_f32 v33, v33
    v_smfmac_f32_32x32x32_bf16 v[96:111], v[172:175], v[56:63], v207
    ds_read_b128 v[152:155], v200 offset:8320
    v_exp_f32 v34, v34
    v_exp_f32 v35, v35
    v_mfma_f32_32x32x16_bf16 v[48:63], v[156:159], v[148:151], v[128:143]
    v_exp_f32 v36, v36
    v_exp_f32 v37, v37
    v_exp_f32 v38, v38
    v_exp_f32 v39, v39
    v_exp_f32 v40, v40
    v_exp_f32 v41, v41
    v_smfmac_f32_32x32x32_bf16 v[80:95], v[176:179], v[32:39], v207
    ds_read_b128 v[168:171], v201 offset:8320
    v_exp_f32 v42, v42
    v_exp_f32 v43, v43
    v_exp_f32 v44, v44
    v_exp_f32 v45, v45
    v_exp_f32 v46, v46
    v_exp_f32 v47, v47
    v_exp_f32 v48, v48
    v_exp_f32 v49, v49
    v_smfmac_f32_32x32x32_bf16 v[80:95], v[180:183], v[40:47], v207
    ds_read_b128 v[172:175], v202 offset:8320
    v_exp_f32 v50, v50
    v_exp_f32 v51, v51
    v_mfma_f32_32x32x16_bf16 v[32:47], v[160:163], v[144:147], v[112:127]
    v_exp_f32 v52, v52
    v_exp_f32 v53, v53
    v_exp_f32 v54, v54
    v_exp_f32 v55, v55
    v_exp_f32 v56, v56
    v_exp_f32 v57, v57
    v_smfmac_f32_32x32x32_bf16 v[96:111], v[176:179], v[48:55], v207
    s_waitcnt lgkmcnt(5)
    v_exp_f32 v58, v58
    v_exp_f32 v59, v59
    v_exp_f32 v60, v60
    v_exp_f32 v61, v61
    v_exp_f32 v62, v62
    v_exp_f32 v63, v63
    v_exp_f32 v32, v32
    v_exp_f32 v33, v33
    v_smfmac_f32_32x32x32_bf16 v[96:111], v[180:183], v[56:63], v207
    ds_read_b128 v[156:159], v200 offset:10400
    v_exp_f32 v34, v34
    v_exp_f32 v35, v35
    v_mfma_f32_32x32x16_bf16 v[48:63], v[160:163], v[148:151], v[128:143]
    v_exp_f32 v36, v36
    v_exp_f32 v37, v37
    v_exp_f32 v38, v38
    v_exp_f32 v39, v39
    v_exp_f32 v40, v40
    v_exp_f32 v41, v41
    v_smfmac_f32_32x32x32_bf16 v[80:95], v[184:187], v[32:39], v207
    ds_read_b128 v[176:179], v201 offset:10400
    v_exp_f32 v42, v42
    v_exp_f32 v43, v43
    v_exp_f32 v44, v44
    v_exp_f32 v45, v45
    v_exp_f32 v46, v46
    v_exp_f32 v47, v47
    v_exp_f32 v48, v48
    v_exp_f32 v49, v49
    v_smfmac_f32_32x32x32_bf16 v[80:95], v[188:191], v[40:47], v207
    ds_read_b128 v[180:183], v202 offset:10400
    v_exp_f32 v50, v50
    v_exp_f32 v51, v51
    v_mfma_f32_32x32x16_bf16 v[32:47], v[164:167], v[144:147], v[112:127]
    v_exp_f32 v52, v52
    v_exp_f32 v53, v53
    v_exp_f32 v54, v54
    v_exp_f32 v55, v55
    v_exp_f32 v56, v56
    v_exp_f32 v57, v57
    v_smfmac_f32_32x32x32_bf16 v[96:111], v[184:187], v[48:55], v207
    s_waitcnt lgkmcnt(5)
    v_exp_f32 v58, v58
    v_exp_f32 v59, v59
    v_exp_f32 v60, v60
    v_exp_f32 v61, v61
    v_exp_f32 v62, v62
    v_exp_f32 v63, v63
    v_exp_f32 v32, v32
    v_exp_f32 v33, v33
    v_smfmac_f32_32x32x32_bf16 v[96:111], v[188:191], v[56:63], v207
    ds_read_b128 v[160:163], v200 offset:12480
    v_exp_f32 v34, v34
    v_exp_f32 v35, v35
    v_mfma_f32_32x32x16_bf16 v[48:63], v[164:167], v[148:151], v[128:143]
    v_exp_f32 v36, v36
    v_exp_f32 v37, v37
    v_exp_f32 v38, v38
    v_exp_f32 v39, v39
    v_exp_f32 v40, v40
    v_exp_f32 v41, v41
    v_smfmac_f32_32x32x32_bf16 v[80:95], v[192:195], v[32:39], v207
    ds_read_b128 v[184:187], v201 offset:12480
    v_exp_f32 v42, v42
    v_exp_f32 v43, v43
    v_exp_f32 v44, v44
    v_exp_f32 v45, v45
    v_exp_f32 v46, v46
    v_exp_f32 v47, v47
    v_exp_f32 v48, v48
    v_exp_f32 v49, v49
    v_smfmac_f32_32x32x32_bf16 v[80:95], v[196:199], v[40:47], v207
    ds_read_b128 v[188:191], v202 offset:12480
    v_exp_f32 v50, v50
    v_exp_f32 v51, v51
    v_mfma_f32_32x32x16_bf16 v[32:47], v[152:155], v[144:147], v[112:127]
    v_exp_f32 v52, v52
    v_exp_f32 v53, v53
    v_exp_f32 v54, v54
    v_exp_f32 v55, v55
    v_exp_f32 v56, v56
    v_exp_f32 v57, v57
    v_smfmac_f32_32x32x32_bf16 v[96:111], v[192:195], v[48:55], v207
    s_waitcnt lgkmcnt(5)
    v_exp_f32 v58, v58
    v_exp_f32 v59, v59
    v_exp_f32 v60, v60
    v_exp_f32 v61, v61
    v_exp_f32 v62, v62
    v_exp_f32 v63, v63
    v_exp_f32 v32, v32
    v_exp_f32 v33, v33
    v_smfmac_f32_32x32x32_bf16 v[96:111], v[196:199], v[56:63], v207
    ds_read_b128 v[164:167], v200 offset:14560
    s_waitcnt vmcnt(0)
    v_exp_f32 v34, v34
    v_exp_f32 v35, v35
    v_mfma_f32_32x32x16_bf16 v[48:63], v[152:155], v[148:151], v[128:143]
    v_exp_f32 v36, v36
    v_exp_f32 v37, v37
    v_exp_f32 v38, v38
    v_exp_f32 v39, v39
    v_exp_f32 v40, v40
    v_exp_f32 v41, v41
    v_smfmac_f32_32x32x32_bf16 v[80:95], v[168:171], v[32:39], v207
    ds_read_b128 v[192:195], v201 offset:14560
    v_exp_f32 v42, v42
    v_exp_f32 v43, v43
    v_exp_f32 v44, v44
    v_exp_f32 v45, v45
    v_exp_f32 v46, v46
    v_exp_f32 v47, v47
    v_exp_f32 v48, v48
    v_exp_f32 v49, v49
    v_smfmac_f32_32x32x32_bf16 v[80:95], v[172:175], v[40:47], v207
    ds_read_b128 v[196:199], v202 offset:14560
    v_exp_f32 v50, v50
    v_exp_f32 v51, v51
    v_mfma_f32_32x32x16_bf16 v[32:47], v[156:159], v[144:147], v[112:127]
    v_exp_f32 v52, v52
    v_exp_f32 v53, v53
    v_exp_f32 v54, v54
    v_exp_f32 v55, v55
    v_exp_f32 v56, v56
    v_exp_f32 v57, v57
    v_smfmac_f32_32x32x32_bf16 v[96:111], v[168:171], v[48:55], v207
    s_waitcnt lgkmcnt(5)
    v_exp_f32 v58, v58
    v_exp_f32 v59, v59
    v_exp_f32 v60, v60
    v_exp_f32 v61, v61
    v_exp_f32 v62, v62
    v_exp_f32 v63, v63
    v_exp_f32 v32, v32
    v_exp_f32 v33, v33
    v_smfmac_f32_32x32x32_bf16 v[96:111], v[172:175], v[56:63], v207
    ds_read_b128 v[152:155], v200 offset:16640
    v_exp_f32 v34, v34
    v_exp_f32 v35, v35
    v_mfma_f32_32x32x16_bf16 v[48:63], v[156:159], v[148:151], v[128:143]
    v_exp_f32 v36, v36
    v_exp_f32 v37, v37
    v_exp_f32 v38, v38
    v_exp_f32 v39, v39
    v_exp_f32 v40, v40
    v_exp_f32 v41, v41
    v_smfmac_f32_32x32x32_bf16 v[80:95], v[176:179], v[32:39], v207
    ds_read_b128 v[168:171], v201 offset:16640
    v_exp_f32 v42, v42
    v_exp_f32 v43, v43
    v_exp_f32 v44, v44
    v_exp_f32 v45, v45
    v_exp_f32 v46, v46
    v_exp_f32 v47, v47
    v_exp_f32 v48, v48
    v_exp_f32 v49, v49
    v_smfmac_f32_32x32x32_bf16 v[80:95], v[180:183], v[40:47], v207
    ds_read_b128 v[172:175], v202 offset:16640
    v_exp_f32 v50, v50
    v_exp_f32 v51, v51
    v_mfma_f32_32x32x16_bf16 v[32:47], v[160:163], v[144:147], v[112:127]
    v_exp_f32 v52, v52
    v_exp_f32 v53, v53
    v_exp_f32 v54, v54
    v_exp_f32 v55, v55
    v_exp_f32 v56, v56
    v_exp_f32 v57, v57
    v_smfmac_f32_32x32x32_bf16 v[96:111], v[176:179], v[48:55], v207
    s_waitcnt lgkmcnt(5)
    v_exp_f32 v58, v58
    v_exp_f32 v59, v59
    v_exp_f32 v60, v60
    v_exp_f32 v61, v61
    v_exp_f32 v62, v62
    v_exp_f32 v63, v63
    v_exp_f32 v32, v32
    v_exp_f32 v33, v33
    v_smfmac_f32_32x32x32_bf16 v[96:111], v[180:183], v[56:63], v207
    ds_read_b128 v[156:159], v200 offset:18720
    v_exp_f32 v34, v34
    v_exp_f32 v35, v35
    v_mfma_f32_32x32x16_bf16 v[48:63], v[160:163], v[148:151], v[128:143]
    v_exp_f32 v36, v36
    v_exp_f32 v37, v37
    v_exp_f32 v38, v38
    v_exp_f32 v39, v39
    v_exp_f32 v40, v40
    v_exp_f32 v41, v41
    v_smfmac_f32_32x32x32_bf16 v[80:95], v[184:187], v[32:39], v207
    ds_read_b128 v[176:179], v201 offset:18720
    v_exp_f32 v42, v42
    v_exp_f32 v43, v43
    v_exp_f32 v44, v44
    v_exp_f32 v45, v45
    v_exp_f32 v46, v46
    v_exp_f32 v47, v47
    v_exp_f32 v48, v48
    v_exp_f32 v49, v49
    v_smfmac_f32_32x32x32_bf16 v[80:95], v[188:191], v[40:47], v207
    ds_read_b128 v[180:183], v202 offset:18720
    v_exp_f32 v50, v50
    v_exp_f32 v51, v51
    v_mfma_f32_32x32x16_bf16 v[32:47], v[164:167], v[144:147], v[112:127]
    v_exp_f32 v52, v52
    v_exp_f32 v53, v53
    v_exp_f32 v54, v54
    v_exp_f32 v55, v55
    v_exp_f32 v56, v56
    v_exp_f32 v57, v57
    v_smfmac_f32_32x32x32_bf16 v[96:111], v[184:187], v[48:55], v207
    s_waitcnt lgkmcnt(5)
    v_exp_f32 v58, v58
    v_exp_f32 v59, v59
    v_exp_f32 v60, v60
    v_exp_f32 v61, v61
    v_exp_f32 v62, v62
    v_exp_f32 v63, v63
    v_exp_f32 v32, v32
    v_exp_f32 v33, v33
    v_smfmac_f32_32x32x32_bf16 v[96:111], v[188:191], v[56:63], v207
    ds_read_b128 v[160:163], v200 offset:20800
    v_exp_f32 v34, v34
    v_exp_f32 v35, v35
    v_mfma_f32_32x32x16_bf16 v[48:63], v[164:167], v[148:151], v[128:143]
    v_exp_f32 v36, v36
    v_exp_f32 v37, v37
    v_exp_f32 v38, v38
    v_exp_f32 v39, v39
    v_exp_f32 v40, v40
    v_exp_f32 v41, v41
    v_smfmac_f32_32x32x32_bf16 v[80:95], v[192:195], v[32:39], v207
    ds_read_b128 v[184:187], v201 offset:20800
    v_exp_f32 v42, v42
    v_exp_f32 v43, v43
    v_exp_f32 v44, v44
    v_exp_f32 v45, v45
    v_exp_f32 v46, v46
    v_exp_f32 v47, v47
    v_exp_f32 v48, v48
    v_exp_f32 v49, v49
    v_smfmac_f32_32x32x32_bf16 v[80:95], v[196:199], v[40:47], v207
    ds_read_b128 v[188:191], v202 offset:20800
    v_exp_f32 v50, v50
    v_exp_f32 v51, v51
    v_mfma_f32_32x32x16_bf16 v[32:47], v[152:155], v[144:147], v[112:127]
    v_exp_f32 v52, v52
    v_exp_f32 v53, v53
    v_exp_f32 v54, v54
    v_exp_f32 v55, v55
    v_exp_f32 v56, v56
    v_exp_f32 v57, v57
    v_smfmac_f32_32x32x32_bf16 v[96:111], v[192:195], v[48:55], v207
    s_waitcnt lgkmcnt(5)
    v_exp_f32 v58, v58
    v_exp_f32 v59, v59
    v_exp_f32 v60, v60
    v_exp_f32 v61, v61
    v_exp_f32 v62, v62
    v_exp_f32 v63, v63
    v_exp_f32 v32, v32
    v_exp_f32 v33, v33
    v_smfmac_f32_32x32x32_bf16 v[96:111], v[196:199], v[56:63], v207
    ds_read_b128 v[164:167], v200 offset:22880
    v_exp_f32 v34, v34
    v_exp_f32 v35, v35
    v_mfma_f32_32x32x16_bf16 v[48:63], v[152:155], v[148:151], v[128:143]
    v_exp_f32 v36, v36
    v_exp_f32 v37, v37
    v_exp_f32 v38, v38
    v_exp_f32 v39, v39
    v_exp_f32 v40, v40
    v_exp_f32 v41, v41
    v_smfmac_f32_32x32x32_bf16 v[80:95], v[168:171], v[32:39], v207
    ds_read_b128 v[192:195], v201 offset:22880
    v_exp_f32 v42, v42
    v_exp_f32 v43, v43
    v_exp_f32 v44, v44
    v_exp_f32 v45, v45
    v_exp_f32 v46, v46
    v_exp_f32 v47, v47
    v_exp_f32 v48, v48
    v_exp_f32 v49, v49
    v_smfmac_f32_32x32x32_bf16 v[80:95], v[172:175], v[40:47], v207
    ds_read_b128 v[196:199], v202 offset:22880
    v_exp_f32 v50, v50
    v_exp_f32 v51, v51
    v_mfma_f32_32x32x16_bf16 v[32:47], v[156:159], v[144:147], v[112:127]
    v_exp_f32 v52, v52
    v_exp_f32 v53, v53
    v_exp_f32 v54, v54
    v_exp_f32 v55, v55
    v_exp_f32 v56, v56
    v_exp_f32 v57, v57
    v_smfmac_f32_32x32x32_bf16 v[96:111], v[168:171], v[48:55], v207
    s_waitcnt lgkmcnt(5)
    v_exp_f32 v58, v58
    v_exp_f32 v59, v59
    v_exp_f32 v60, v60
    v_exp_f32 v61, v61
    v_exp_f32 v62, v62
    v_exp_f32 v63, v63
    v_exp_f32 v32, v32
    v_exp_f32 v33, v33
    v_smfmac_f32_32x32x32_bf16 v[96:111], v[172:175], v[56:63], v207
    s_mov_b64 exec, 1
    buffer_store_dword v206, v221, s[40:43], s62 offen sc1
    s_mov_b64 exec, -1
    v_exp_f32 v34, v34
    v_exp_f32 v35, v35
    v_mfma_f32_32x32x16_bf16 v[48:63], v[156:159], v[148:151], v[128:143]
    v_exp_f32 v36, v36
    v_exp_f32 v37, v37
    v_exp_f32 v38, v38
    v_exp_f32 v39, v39
    v_exp_f32 v40, v40
    v_exp_f32 v41, v41
    v_smfmac_f32_32x32x32_bf16 v[80:95], v[176:179], v[32:39], v207
    v_exp_f32 v42, v42
    v_exp_f32 v43, v43
    v_exp_f32 v44, v44
    v_exp_f32 v45, v45
    v_exp_f32 v46, v46
    v_exp_f32 v47, v47
    v_exp_f32 v48, v48
    v_exp_f32 v49, v49
    v_smfmac_f32_32x32x32_bf16 v[80:95], v[180:183], v[40:47], v207
    v_exp_f32 v50, v50
    v_exp_f32 v51, v51
    v_mfma_f32_32x32x16_bf16 v[32:47], v[160:163], v[144:147], v[112:127]
    v_exp_f32 v52, v52
    v_exp_f32 v53, v53
    v_exp_f32 v54, v54
    v_exp_f32 v55, v55
    v_exp_f32 v56, v56
    v_exp_f32 v57, v57
    v_smfmac_f32_32x32x32_bf16 v[96:111], v[176:179], v[48:55], v207
    s_waitcnt lgkmcnt(2)
    v_exp_f32 v58, v58
    v_exp_f32 v59, v59
    v_exp_f32 v60, v60
    v_exp_f32 v61, v61
    v_exp_f32 v62, v62
    v_exp_f32 v63, v63
    v_exp_f32 v32, v32
    v_exp_f32 v33, v33
    v_smfmac_f32_32x32x32_bf16 v[96:111], v[180:183], v[56:63], v207
    v_exp_f32 v34, v34
    v_exp_f32 v35, v35
    v_mfma_f32_32x32x16_bf16 v[48:63], v[160:163], v[148:151], v[128:143]
    v_exp_f32 v36, v36
    v_exp_f32 v37, v37
    v_exp_f32 v38, v38
    v_exp_f32 v39, v39
    v_exp_f32 v40, v40
    v_exp_f32 v41, v41
    v_smfmac_f32_32x32x32_bf16 v[80:95], v[184:187], v[32:39], v207
    v_exp_f32 v42, v42
    v_exp_f32 v43, v43
    v_exp_f32 v44, v44
    v_exp_f32 v45, v45
    v_exp_f32 v46, v46
    v_exp_f32 v47, v47
    v_exp_f32 v48, v48
    v_exp_f32 v49, v49
    v_smfmac_f32_32x32x32_bf16 v[80:95], v[188:191], v[40:47], v207
    v_exp_f32 v50, v50
    v_exp_f32 v51, v51
    v_mfma_f32_32x32x16_bf16 v[32:47], v[164:167], v[144:147], v[112:127]
    v_exp_f32 v52, v52
    v_exp_f32 v53, v53
    v_exp_f32 v54, v54
    v_exp_f32 v55, v55
    v_exp_f32 v56, v56
    v_exp_f32 v57, v57
    v_smfmac_f32_32x32x32_bf16 v[96:111], v[184:187], v[48:55], v207
    s_waitcnt lgkmcnt(0)
    v_exp_f32 v58, v58
    v_exp_f32 v59, v59
    v_exp_f32 v60, v60
    v_exp_f32 v61, v61
    v_exp_f32 v62, v62
    v_exp_f32 v63, v63
    v_exp_f32 v32, v32
    v_exp_f32 v33, v33
    v_smfmac_f32_32x32x32_bf16 v[96:111], v[188:191], v[56:63], v207
    v_exp_f32 v34, v34
    v_exp_f32 v35, v35
    v_mfma_f32_32x32x16_bf16 v[48:63], v[164:167], v[148:151], v[128:143]
    v_exp_f32 v36, v36
    v_exp_f32 v37, v37
    v_exp_f32 v38, v38
    v_exp_f32 v39, v39
    v_exp_f32 v40, v40
    v_exp_f32 v41, v41
    v_smfmac_f32_32x32x32_bf16 v[80:95], v[192:195], v[32:39], v207
    v_exp_f32 v42, v42
    v_exp_f32 v43, v43
    v_exp_f32 v44, v44
    v_exp_f32 v45, v45
    v_exp_f32 v46, v46
    v_exp_f32 v47, v47
    v_exp_f32 v48, v48
    v_exp_f32 v49, v49
    v_smfmac_f32_32x32x32_bf16 v[80:95], v[196:199], v[40:47], v207
    v_exp_f32 v50, v50
    v_exp_f32 v51, v51
    v_exp_f32 v52, v52
    v_exp_f32 v53, v53
    v_exp_f32 v54, v54
    v_exp_f32 v55, v55
    v_exp_f32 v56, v56
    v_exp_f32 v57, v57
    v_smfmac_f32_32x32x32_bf16 v[96:111], v[192:195], v[48:55], v207
    v_exp_f32 v58, v58
    v_exp_f32 v59, v59
    v_exp_f32 v60, v60
    v_exp_f32 v61, v61
    v_exp_f32 v62, v62
    v_exp_f32 v63, v63
L_att_done:
    v_rcp_f32 v24, v88
    s_nop 0
    v_smfmac_f32_32x32x32_bf16 v[96:111], v[196:199], v[56:63], v207
    s_mov_b64 exec, 1
    ds_add_u32 v6, v7 offset:52
    s_mov_b64 exec, -1
    v_mul_f32 v80, v80, v24
    v_mul_f32 v81, v81, v24
    v_mul_f32 v82, v82, v24
    v_mul_f32 v83, v83, v24
    v_mul_f32 v84, v84, v24
    v_mul_f32 v85, v85, v24
    v_mul_f32 v86, v86, v24
    v_mul_f32 v87, v87, v24
    v_cvt_pk_bf16_f32 v8, v80, v81
    v_cvt_pk_bf16_f32 v9, v82, v83
    v_cvt_pk_bf16_f32 v10, v84, v85
    v_cvt_pk_bf16_f32 v11, v86, v87
    v_min_u32 v8, -2, v8
    v_min_u32 v9, -2, v9
    v_min_u32 v10, -2, v10
    v_min_u32 v11, -2, v11
    buffer_store_dwordx4 v[8:11], v221, s[40:43], s6 offen offset:0 sc1
    v_rcp_f32 v24, v104
    s_nop 0
    v_mul_f32 v96, v96, v24
    v_mul_f32 v97, v97, v24
    v_mul_f32 v98, v98, v24
    v_mul_f32 v99, v99, v24
    v_mul_f32 v100, v100, v24
    v_mul_f32 v101, v101, v24
    v_mul_f32 v102, v102, v24
    v_mul_f32 v103, v103, v24
    v_cvt_pk_bf16_f32 v12, v96, v97
    v_cvt_pk_bf16_f32 v13, v98, v99
    v_cvt_pk_bf16_f32 v14, v100, v101
    v_cvt_pk_bf16_f32 v15, v102, v103
    v_min_u32 v12, -2, v12
    v_min_u32 v13, -2, v13
    v_min_u32 v14, -2, v14
    v_min_u32 v15, -2, v15
    buffer_store_dwordx4 v[12:15], v221, s[40:43], s6 offen offset:2048 sc1
    s_mov_b32 s47, s61
    v_readfirstlane_b32 s7, v206
    v_lshlrev_b32 v16, 7, v215
    v_and_b32 v17, 4, v1
    v_add_u32 v16, v16, v17
    s_and_b32 s73, s45, 1
    s_lshl_b32 s73, s73, 9
    s_add_u32 s47, s47, s73
    s_and_b32 s73, s45, 2
    s_lshl_b32 s73, s73, 2
    s_add_u32 s47, s47, s73
    v_mov_b32 v0, v221
    v_mov_b32 v3, v205
    v_lshl_add_u32 v3, v212, 3, v3
    s_and_b32 s74, s45, 1
    s_lshr_b32 s75, s45, 1
    s_lshl_b32 s73, s71, 6
    s_add_u32 s73, s73, s75
    s_lshl_b32 s75, s74, 5
    s_add_u32 s73, s73, s75
    s_lshl_b32 s73, s73, 10
    s_add_u32 s76, s73, 1048576
    s_add_u32 s64, s72, 1
    s_and_b32 s64, s64, 3
    s_lshl_b32 s64, s64, 13
    s_add_u32 s52, s76, s64
    s_add_u32 s53, s52, 4096
    s_add_u32 s65, s72, 2
    s_and_b32 s65, s65, 3
    s_lshl_b32 s65, s65, 13
    s_add_u32 s54, s76, s65
    s_add_u32 s55, s54, 4096
    s_add_u32 s66, s72, 3
    s_and_b32 s66, s66, 3
    s_lshl_b32 s66, s66, 13
    s_add_u32 s56, s76, s66
    s_add_u32 s57, s56, 4096
    s_add_u32 s67, s72, 4
    s_and_b32 s67, s67, 3
    s_lshl_b32 s67, s67, 13
    s_add_u32 s58, s76, s67
    s_add_u32 s59, s58, 4096
    s_mov_b32 s46, 0x2000000
L_lp_13:
    ds_read_b32 v5, v6 offset:48
    s_waitcnt lgkmcnt(0)
    v_readfirstlane_b32 s73, v5
    s_cmp_ge_u32 s73, 4
    s_cbranch_scc1 L_lpd_14
    s_sub_u32 s46, s46, 1
    s_cbranch_scc1 L_lpd_14
    s_sleep 1
    s_branch L_lp_13
L_lpd_14:
    s_mul_i32 s73, s74, 32832
    v_lshl_add_u32 v2, v212, 9, v216
    v_xor_b32 v2, s73, v2
    v_add_u32 v104, s64, v2
    v_xor_b32 v105, 64, v104
    v_add_u32 v106, s65, v2
    v_xor_b32 v107, 64, v106
    v_add_u32 v108, s66, v2
    v_xor_b32 v109, 64, v108
    v_add_u32 v110, s67, v2
    v_xor_b32 v111, 64, v110
    v_mov_b64 v[120:121], v[232:233]
    v_mov_b64 v[122:123], v[234:235]
    v_mov_b64 v[124:125], v[236:237]
    v_mov_b64 v[126:127], v[238:239]
    ds_read_b64_tr_b16 v[128:129], v104 offset:0
    ds_read_b64_tr_b16 v[130:131], v104 offset:1024
    ds_read_b64_tr_b16 v[132:133], v105 offset:0
    ds_read_b64_tr_b16 v[134:135], v105 offset:1024
    ds_read_b64_tr_b16 v[136:137], v104 offset:2048
    ds_read_b64_tr_b16 v[138:139], v104 offset:3072
    ds_read_b64_tr_b16 v[140:141], v105 offset:2048
    ds_read_b64_tr_b16 v[142:143], v105 offset:3072
    ds_read_b64_tr_b16 v[144:145], v104 offset:4096
    ds_read_b64_tr_b16 v[146:147], v104 offset:5120
    ds_read_b64_tr_b16 v[148:149], v105 offset:4096
    ds_read_b64_tr_b16 v[150:151], v105 offset:5120
    ds_read_b64_tr_b16 v[152:153], v104 offset:6144
    ds_read_b64_tr_b16 v[154:155], v104 offset:7168
    s_waitcnt lgkmcnt(8)
    ds_read_b64_tr_b16 v[156:157], v105 offset:6144
    ds_read_b64_tr_b16 v[158:159], v105 offset:7168
    ds_read_b64_tr_b16 v[160:161], v106 offset:0
    ds_read_b64_tr_b16 v[162:163], v106 offset:1024
    ds_read_b64_tr_b16 v[164:165], v107 offset:0
    ds_read_b64_tr_b16 v[166:167], v107 offset:1024
    s_waitcnt lgkmcnt(8)
    ds_read_b64_tr_b16 v[168:169], v106 offset:2048
    ds_read_b64_tr_b16 v[170:171], v106 offset:3072
    ds_read_b64_tr_b16 v[172:173], v107 offset:2048
    ds_read_b64_tr_b16 v[174:175], v107 offset:3072
    ds_read_b64_tr_b16 v[176:177], v106 offset:4096
    ds_read_b64_tr_b16 v[178:179], v106 offset:5120
    s_waitcnt lgkmcnt(8)
    ds_read_b64_tr_b16 v[180:181], v107 offset:4096
    ds_read_b64_tr_b16 v[182:183], v107 offset:5120
    ds_read_b64_tr_b16 v[184:185], v106 offset:6144
    ds_read_b64_tr_b16 v[186:187], v106 offset:7168
    ds_read_b64_tr_b16 v[188:189], v107 offset:6144
    ds_read_b64_tr_b16 v[190:191], v107 offset:7168
    s_waitcnt lgkmcnt(8)
    ds_read_b64_tr_b16 v[192:193], v108 offset:0
    ds_read_b64_tr_b16 v[194:195], v108 offset:1024
    ds_read_b64_tr_b16 v[196:197], v109 offset:0
    ds_read_b64_tr_b16 v[198:199], v109 offset:1024
    ds_read_b64_tr_b16 v[200:201], v108 offset:2048
    ds_read_b64_tr_b16 v[202:203], v108 offset:3072
    s_waitcnt lgkmcnt(8)
    ds_read_b64_tr_b16 v[204:205], v109 offset:2048
    ds_read_b64_tr_b16 v[206:207], v109 offset:3072
    ds_read_b64_tr_b16 v[208:209], v108 offset:4096
    ds_read_b64_tr_b16 v[210:211], v108 offset:5120
    ds_read_b64_tr_b16 v[212:213], v109 offset:4096
    ds_read_b64_tr_b16 v[214:215], v109 offset:5120
    s_waitcnt lgkmcnt(8)
    ds_read_b64_tr_b16 v[216:217], v108 offset:6144
    ds_read_b64_tr_b16 v[218:219], v108 offset:7168
    ds_read_b64_tr_b16 v[220:221], v109 offset:6144
    ds_read_b64_tr_b16 v[222:223], v109 offset:7168
    ds_read_b64_tr_b16 v[224:225], v110 offset:0
    ds_read_b64_tr_b16 v[226:227], v110 offset:1024
    s_waitcnt lgkmcnt(8)
    ds_read_b64_tr_b16 v[228:229], v111 offset:0
    ds_read_b64_tr_b16 v[230:231], v111 offset:1024
    ds_read_b64_tr_b16 v[232:233], v110 offset:2048
    ds_read_b64_tr_b16 v[234:235], v110 offset:3072
    ds_read_b64_tr_b16 v[236:237], v111 offset:2048
    ds_read_b64_tr_b16 v[238:239], v111 offset:3072
    s_waitcnt lgkmcnt(8)
    ds_read_b64_tr_b16 v[240:241], v110 offset:4096
    ds_read_b64_tr_b16 v[242:243], v110 offset:5120
    ds_read_b64_tr_b16 v[244:245], v111 offset:4096
    ds_read_b64_tr_b16 v[246:247], v111 offset:5120
    ds_read_b64_tr_b16 v[248:249], v110 offset:6144
    ds_read_b64_tr_b16 v[250:251], v110 offset:7168
    s_waitcnt lgkmcnt(8)
    ds_read_b64_tr_b16 v[252:253], v111 offset:6144
    ds_read_b64_tr_b16 v[254:255], v111 offset:7168
    s_lshl_b32 s75, s45, 12
    s_add_u32 s74, s75, 66560
    v_add_u32 v1, s74, v0
    s_xor_b32 s75, s75, 4096
    s_add_u32 s75, s75, 66560
    v_add_u32 v2, s75, v0
    s_and_b32 s75, s45, 2
    s_lshl_b32 s75, s75, 1
    v_add_u32 v4, s75, v6
    s_mov_b32 s79, 0
    s_mov_b32 s78, 0x200000
    s_mov_b32 s46, 0x2000000
L_lp_15:
    ds_read_b32 v5, v6 offset:52
    s_waitcnt lgkmcnt(0)
    v_readfirstlane_b32 s73, v5
    s_cmp_ge_u32 s73, 4
    s_cbranch_scc1 L_lpd_16
    s_sub_u32 s46, s46, 1
    s_cbranch_scc1 L_lpd_16
    s_branch L_lp_15
L_lpd_16:
    s_mov_b32 s46, 0x200000
L_hp_17:
    buffer_load_dword v17, v16, s[40:43], s47 offen sc1
    s_waitcnt vmcnt(0)
    v_cmp_ne_u32 vcc, s7, v17
    s_cbranch_vccz L_hpd_18
    s_sub_u32 s46, s46, 1
    s_cbranch_scc1 L_hpd_18
    s_sleep 2
    s_branch L_hp_17
L_hpd_18:
    buffer_load_dwordx4 v[40:43], v0, s[40:43], s52 offen offset:0 sc1
    buffer_load_dwordx4 v[44:47], v0, s[40:43], s52 offen offset:2048 sc1
    buffer_load_dwordx4 v[48:51], v0, s[40:43], s53 offen offset:0 sc1
    buffer_load_dwordx4 v[52:55], v0, s[40:43], s53 offen offset:2048 sc1
    buffer_load_dwordx4 v[56:59], v0, s[40:43], s54 offen offset:0 sc1
    buffer_load_dwordx4 v[60:63], v0, s[40:43], s54 offen offset:2048 sc1
    buffer_load_dwordx4 v[64:67], v0, s[40:43], s55 offen offset:0 sc1
    buffer_load_dwordx4 v[68:71], v0, s[40:43], s55 offen offset:2048 sc1
    buffer_load_dwordx4 v[72:75], v0, s[40:43], s56 offen offset:0 sc1
    buffer_load_dwordx4 v[76:79], v0, s[40:43], s56 offen offset:2048 sc1
    buffer_load_dwordx4 v[80:83], v0, s[40:43], s57 offen offset:0 sc1
    buffer_load_dwordx4 v[84:87], v0, s[40:43], s57 offen offset:2048 sc1
    buffer_load_dwordx4 v[88:91], v0, s[40:43], s58 offen offset:0 sc1
    buffer_load_dwordx4 v[92:95], v0, s[40:43], s58 offen offset:2048 sc1
    buffer_load_dwordx4 v[96:99], v0, s[40:43], s59 offen offset:0 sc1
    buffer_load_dwordx4 v[100:103], v0, s[40:43], s59 offen offset:2048 sc1
    s_waitcnt vmcnt(12)
    v_max3_u32 v5, v40, v41, v42
    v_max3_u32 v5, v5, v43, v44
    v_max3_u32 v5, v5, v45, v46
    v_max3_u32 v5, v5, v47, v48
    v_max3_u32 v5, v5, v49, v50
    v_max3_u32 v5, v5, v51, v52
    v_max3_u32 v5, v5, v53, v54
    v_max_u32 v5, v5, v55
    v_cmp_eq_u32 vcc, -1, v5
    s_cbranch_vccnz L_oretry_0
L_ogo_0:
    v_mfma_f32_32x32x16_bf16 v[24:39], v[132:135], v[40:43], 0
    v_mfma_f32_32x32x16_bf16 v[8:23], v[128:131], v[40:43], 0
    v_mfma_f32_32x32x16_bf16 v[24:39], v[140:143], v[44:47], v[24:39]
    v_mfma_f32_32x32x16_bf16 v[8:23], v[136:139], v[44:47], v[8:23]
    v_mfma_f32_32x32x16_bf16 v[24:39], v[148:151], v[48:51], v[24:39]
    v_mfma_f32_32x32x16_bf16 v[8:23], v[144:147], v[48:51], v[8:23]
    v_mfma_f32_32x32x16_bf16 v[24:39], v[156:159], v[52:55], v[24:39]
    v_mfma_f32_32x32x16_bf16 v[8:23], v[152:155], v[52:55], v[8:23]
    s_waitcnt vmcnt(8)
    v_max3_u32 v5, v56, v57, v58
    v_max3_u32 v5, v5, v59, v60
    v_max3_u32 v5, v5, v61, v62
    v_max3_u32 v5, v5, v63, v64
    v_max3_u32 v5, v5, v65, v66
    v_max3_u32 v5, v5, v67, v68
    v_max3_u32 v5, v5, v69, v70
    v_max_u32 v5, v5, v71
    v_cmp_eq_u32 vcc, -1, v5
    s_cbranch_vccnz L_oretry_1
L_ogo_1:
    v_mfma_f32_32x32x16_bf16 v[24:39], v[164:167], v[56:59], v[24:39]
    v_mfma_f32_32x32x16_bf16 v[8:23], v[160:163], v[56:59], v[8:23]
    v_mfma_f32_32x32x16_bf16 v[24:39], v[172:175], v[60:63], v[24:39]
    v_mfma_f32_32x32x16_bf16 v[8:23], v[168:171], v[60:63], v[8:23]
    v_mfma_f32_32x32x16_bf16 v[24:39], v[180:183], v[64:67], v[24:39]
    v_mfma_f32_32x32x16_bf16 v[8:23], v[176:179], v[64:67], v[8:23]
    v_mfma_f32_32x32x16_bf16 v[24:39], v[188:191], v[68:71], v[24:39]
    v_mfma_f32_32x32x16_bf16 v[8:23], v[184:187], v[68:71], v[8:23]
    s_waitcnt vmcnt(4)
    v_max3_u32 v5, v72, v73, v74
    v_max3_u32 v5, v5, v75, v76
    v_max3_u32 v5, v5, v77, v78
    v_max3_u32 v5, v5, v79, v80
    v_max3_u32 v5, v5, v81, v82
    v_max3_u32 v5, v5, v83, v84
    v_max3_u32 v5, v5, v85, v86
    v_max_u32 v5, v5, v87
    v_cmp_eq_u32 vcc, -1, v5
    s_cbranch_vccnz L_oretry_2
L_ogo_2:
    v_mfma_f32_32x32x16_bf16 v[24:39], v[196:199], v[72:75], v[24:39]
    v_mfma_f32_32x32x16_bf16 v[8:23], v[192:195], v[72:75], v[8:23]
    v_mfma_f32_32x32x16_bf16 v[24:39], v[204:207], v[76:79], v[24:39]
    v_mfma_f32_32x32x16_bf16 v[8:23], v[200:203], v[76:79], v[8:23]
    v_mfma_f32_32x32x16_bf16 v[24:39], v[212:215], v[80:83], v[24:39]
    v_mfma_f32_32x32x16_bf16 v[8:23], v[208:211], v[80:83], v[8:23]
    v_mfma_f32_32x32x16_bf16 v[24:39], v[220:223], v[84:87], v[24:39]
    v_mfma_f32_32x32x16_bf16 v[8:23], v[216:219], v[84:87], v[8:23]
    s_waitcnt vmcnt(0)
    v_max3_u32 v5, v88, v89, v90
    v_max3_u32 v5, v5, v91, v92
    v_max3_u32 v5, v5, v93, v94
    v_max3_u32 v5, v5, v95, v96
    v_max3_u32 v5, v5, v97, v98
    v_max3_u32 v5, v5, v99, v100
    v_max3_u32 v5, v5, v101, v102
    v_max_u32 v5, v5, v103
    v_cmp_eq_u32 vcc, -1, v5
    s_cbranch_vccnz L_oretry_3
L_ogo_3:
    v_mfma_f32_32x32x16_bf16 v[24:39], v[228:231], v[88:91], v[24:39]
    v_mfma_f32_32x32x16_bf16 v[8:23], v[224:227], v[88:91], v[8:23]
    v_mfma_f32_32x32x16_bf16 v[24:39], v[236:239], v[92:95], v[24:39]
    v_mfma_f32_32x32x16_bf16 v[8:23], v[232:235], v[92:95], v[8:23]
    v_mfma_f32_32x32x16_bf16 v[24:39], v[244:247], v[96:99], v[24:39]
    v_mfma_f32_32x32x16_bf16 v[8:23], v[240:243], v[96:99], v[8:23]
    v_mfma_f32_32x32x16_bf16 v[24:39], v[252:255], v[100:103], v[24:39]
    v_mfma_f32_32x32x16_bf16 v[8:23], v[248:251], v[100:103], v[8:23]
    v_lshlrev_b32 v128, 16, v120
    v_and_b32 v129, s44, v120
    v_lshlrev_b32 v130, 16, v121
    v_and_b32 v131, s44, v121
    v_lshlrev_b32 v132, 16, v122
    v_and_b32 v133, s44, v122
    v_lshlrev_b32 v134, 16, v123
    v_and_b32 v135, s44, v123
    v_lshlrev_b32 v136, 16, v124
    v_and_b32 v137, s44, v124
    v_lshlrev_b32 v138, 16, v125
    v_and_b32 v139, s44, v125
    v_lshlrev_b32 v140, 16, v126
    v_and_b32 v141, s44, v126
    v_lshlrev_b32 v142, 16, v127
    v_and_b32 v143, s44, v127
    ds_write_b128 v1, v[24:27] offset:0
    ds_write_b128 v1, v[28:31] offset:1024
    ds_write_b128 v1, v[32:35] offset:2048
    ds_write_b128 v1, v[36:39] offset:3072
    s_mov_b64 exec, 1
    ds_add_u32 v4, v7 offset:60
    s_mov_b64 exec, -1
    s_lshl_b32 s74, s45, 2
    v_add_u32 v1, s74, v6
    s_lshl_b32 s74, s45, 14
    s_add_u32 s74, s74, 103808
    v_add_u32 v0, s74, v0
    s_mov_b32 s46, 0x2000000
L_lp_19:
    ds_read_b32 v5, v1 offset:100
    s_waitcnt lgkmcnt(0)
    v_readfirstlane_b32 s73, v5
    s_cmp_ge_u32 s73, 1
    s_cbranch_scc1 L_lpd_20
    s_sub_u32 s46, s46, 1
    s_cbranch_scc1 L_lpd_20
    s_branch L_lp_19
L_lpd_20:
    ds_read_b128 v[40:43], v0
    ds_read_b128 v[44:47], v0 offset:1024
    s_mov_b32 s46, 0x2000000
L_lp_21:
    ds_read_b32 v5, v4 offset:60
    s_waitcnt lgkmcnt(0)
    v_readfirstlane_b32 s73, v5
    s_cmp_ge_u32 s73, 2
    s_cbranch_scc1 L_lpd_22
    s_sub_u32 s46, s46, 1
    s_cbranch_scc1 L_lpd_22
    s_branch L_lp_21
L_lpd_22:
    ds_read_b128 v[24:27], v2 offset:0
    ds_read_b128 v[28:31], v2 offset:1024
    ds_read_b128 v[32:35], v2 offset:2048
    ds_read_b128 v[36:39], v2 offset:3072
    v_lshlrev_b32 v104, 16, v40
    v_and_b32 v105, s44, v40
    v_lshlrev_b32 v106, 16, v41
    v_and_b32 v107, s44, v41
    v_lshlrev_b32 v108, 16, v42
    v_and_b32 v109, s44, v42
    v_lshlrev_b32 v110, 16, v43
    v_and_b32 v111, s44, v43
    v_lshlrev_b32 v112, 16, v44
    v_and_b32 v113, s44, v44
    v_lshlrev_b32 v114, 16, v45
    v_and_b32 v115, s44, v45
    v_lshlrev_b32 v116, 16, v46
    v_and_b32 v117, s44, v46
    v_lshlrev_b32 v118, 16, v47
    v_and_b32 v119, s44, v47
    s_waitcnt lgkmcnt(3)
    v_add_f32 v8, v8, v24
    v_add_f32 v9, v9, v25
    v_add_f32 v10, v10, v26
    v_add_f32 v11, v11, v27
    v_fmac_f32 v128, v8, v104
    v_fmac_f32 v129, v9, v105
    v_fmac_f32 v130, v10, v106
    v_fmac_f32 v131, v11, v107
    v_cvt_pk_bf16_f32 v120, v128, v129
    v_cvt_pk_bf16_f32 v121, v130, v131
    s_waitcnt lgkmcnt(2)
    v_add_f32 v12, v12, v28
    v_add_f32 v13, v13, v29
    v_add_f32 v14, v14, v30
    v_add_f32 v15, v15, v31
    v_fmac_f32 v132, v12, v108
    v_fmac_f32 v133, v13, v109
    v_fmac_f32 v134, v14, v110
    v_fmac_f32 v135, v15, v111
    v_cvt_pk_bf16_f32 v122, v132, v133
    v_cvt_pk_bf16_f32 v123, v134, v135
    s_nop 1
    v_permlane32_swap_b32 v120, v122
    v_permlane32_swap_b32 v121, v123
    buffer_store_dwordx4 v[120:123], v3, s[32:35], s63 offen offset:0
    s_waitcnt lgkmcnt(1)
    v_add_f32 v16, v16, v32
    v_add_f32 v17, v17, v33
    v_add_f32 v18, v18, v34
    v_add_f32 v19, v19, v35
    v_fmac_f32 v136, v16, v112
    v_fmac_f32 v137, v17, v113
    v_fmac_f32 v138, v18, v114
    v_fmac_f32 v139, v19, v115
    v_cvt_pk_bf16_f32 v124, v136, v137
    v_cvt_pk_bf16_f32 v125, v138, v139
    s_waitcnt lgkmcnt(0)
    v_add_f32 v20, v20, v36
    v_add_f32 v21, v21, v37
    v_add_f32 v22, v22, v38
    v_add_f32 v23, v23, v39
    v_fmac_f32 v140, v20, v116
    v_fmac_f32 v141, v21, v117
    v_fmac_f32 v142, v22, v118
    v_fmac_f32 v143, v23, v119
    v_cvt_pk_bf16_f32 v126, v140, v141
    v_cvt_pk_bf16_f32 v127, v142, v143
    s_nop 1
    v_permlane32_swap_b32 v124, v126
    v_permlane32_swap_b32 v125, v127
    buffer_store_dwordx4 v[124:127], v3, s[32:35], s63 offen offset:32
    s_endpgm
L_oretry_0:
    s_sub_u32 s78, s78, 1
    s_cbranch_scc1 L_odone_0
    s_sleep 2
    buffer_load_dwordx4 v[40:43], v0, s[40:43], s52 offen offset:0 sc1
    buffer_load_dwordx4 v[44:47], v0, s[40:43], s52 offen offset:2048 sc1
    buffer_load_dwordx4 v[48:51], v0, s[40:43], s53 offen offset:0 sc1
    buffer_load_dwordx4 v[52:55], v0, s[40:43], s53 offen offset:2048 sc1
    s_waitcnt vmcnt(0)
    v_max3_u32 v5, v40, v41, v42
    v_max3_u32 v5, v5, v43, v44
    v_max3_u32 v5, v5, v45, v46
    v_max3_u32 v5, v5, v47, v48
    v_max3_u32 v5, v5, v49, v50
    v_max3_u32 v5, v5, v51, v52
    v_max3_u32 v5, v5, v53, v54
    v_max_u32 v5, v5, v55
    v_cmp_eq_u32 vcc, -1, v5
    s_cbranch_vccnz L_oretry_0
L_odone_0:
    buffer_load_dwordx4 v[56:59], v0, s[40:43], s54 offen offset:0 sc1
    buffer_load_dwordx4 v[60:63], v0, s[40:43], s54 offen offset:2048 sc1
    buffer_load_dwordx4 v[64:67], v0, s[40:43], s55 offen offset:0 sc1
    buffer_load_dwordx4 v[68:71], v0, s[40:43], s55 offen offset:2048 sc1
    buffer_load_dwordx4 v[72:75], v0, s[40:43], s56 offen offset:0 sc1
    buffer_load_dwordx4 v[76:79], v0, s[40:43], s56 offen offset:2048 sc1
    buffer_load_dwordx4 v[80:83], v0, s[40:43], s57 offen offset:0 sc1
    buffer_load_dwordx4 v[84:87], v0, s[40:43], s57 offen offset:2048 sc1
    buffer_load_dwordx4 v[88:91], v0, s[40:43], s58 offen offset:0 sc1
    buffer_load_dwordx4 v[92:95], v0, s[40:43], s58 offen offset:2048 sc1
    buffer_load_dwordx4 v[96:99], v0, s[40:43], s59 offen offset:0 sc1
    buffer_load_dwordx4 v[100:103], v0, s[40:43], s59 offen offset:2048 sc1
    s_branch L_ogo_0
L_oretry_1:
    s_sub_u32 s78, s78, 1
    s_cbranch_scc1 L_odone_1
    s_sleep 2
    buffer_load_dwordx4 v[56:59], v0, s[40:43], s54 offen offset:0 sc1
    buffer_load_dwordx4 v[60:63], v0, s[40:43], s54 offen offset:2048 sc1
    buffer_load_dwordx4 v[64:67], v0, s[40:43], s55 offen offset:0 sc1
    buffer_load_dwordx4 v[68:71], v0, s[40:43], s55 offen offset:2048 sc1
    s_waitcnt vmcnt(0)
    v_max3_u32 v5, v56, v57, v58
    v_max3_u32 v5, v5, v59, v60
    v_max3_u32 v5, v5, v61, v62
    v_max3_u32 v5, v5, v63, v64
    v_max3_u32 v5, v5, v65, v66
    v_max3_u32 v5, v5, v67, v68
    v_max3_u32 v5, v5, v69, v70
    v_max_u32 v5, v5, v71
    v_cmp_eq_u32 vcc, -1, v5
    s_cbranch_vccnz L_oretry_1
L_odone_1:
    buffer_load_dwordx4 v[72:75], v0, s[40:43], s56 offen offset:0 sc1
    buffer_load_dwordx4 v[76:79], v0, s[40:43], s56 offen offset:2048 sc1
    buffer_load_dwordx4 v[80:83], v0, s[40:43], s57 offen offset:0 sc1
    buffer_load_dwordx4 v[84:87], v0, s[40:43], s57 offen offset:2048 sc1
    buffer_load_dwordx4 v[88:91], v0, s[40:43], s58 offen offset:0 sc1
    buffer_load_dwordx4 v[92:95], v0, s[40:43], s58 offen offset:2048 sc1
    buffer_load_dwordx4 v[96:99], v0, s[40:43], s59 offen offset:0 sc1
    buffer_load_dwordx4 v[100:103], v0, s[40:43], s59 offen offset:2048 sc1
    s_branch L_ogo_1
L_oretry_2:
    s_sub_u32 s78, s78, 1
    s_cbranch_scc1 L_odone_2
    s_sleep 2
    buffer_load_dwordx4 v[72:75], v0, s[40:43], s56 offen offset:0 sc1
    buffer_load_dwordx4 v[76:79], v0, s[40:43], s56 offen offset:2048 sc1
    buffer_load_dwordx4 v[80:83], v0, s[40:43], s57 offen offset:0 sc1
    buffer_load_dwordx4 v[84:87], v0, s[40:43], s57 offen offset:2048 sc1
    s_waitcnt vmcnt(0)
    v_max3_u32 v5, v72, v73, v74
    v_max3_u32 v5, v5, v75, v76
    v_max3_u32 v5, v5, v77, v78
    v_max3_u32 v5, v5, v79, v80
    v_max3_u32 v5, v5, v81, v82
    v_max3_u32 v5, v5, v83, v84
    v_max3_u32 v5, v5, v85, v86
    v_max_u32 v5, v5, v87
    v_cmp_eq_u32 vcc, -1, v5
    s_cbranch_vccnz L_oretry_2
L_odone_2:
    buffer_load_dwordx4 v[88:91], v0, s[40:43], s58 offen offset:0 sc1
    buffer_load_dwordx4 v[92:95], v0, s[40:43], s58 offen offset:2048 sc1
    buffer_load_dwordx4 v[96:99], v0, s[40:43], s59 offen offset:0 sc1
    buffer_load_dwordx4 v[100:103], v0, s[40:43], s59 offen offset:2048 sc1
    s_branch L_ogo_2
L_oretry_3:
    s_sub_u32 s78, s78, 1
    s_cbranch_scc1 L_odone_3
    s_sleep 2
    buffer_load_dwordx4 v[88:91], v0, s[40:43], s58 offen offset:0 sc1
    buffer_load_dwordx4 v[92:95], v0, s[40:43], s58 offen offset:2048 sc1
    buffer_load_dwordx4 v[96:99], v0, s[40:43], s59 offen offset:0 sc1
    buffer_load_dwordx4 v[100:103], v0, s[40:43], s59 offen offset:2048 sc1
    s_waitcnt vmcnt(0)
    v_max3_u32 v5, v88, v89, v90
    v_max3_u32 v5, v5, v91, v92
    v_max3_u32 v5, v5, v93, v94
    v_max3_u32 v5, v5, v95, v96
    v_max3_u32 v5, v5, v97, v98
    v_max3_u32 v5, v5, v99, v100
    v_max3_u32 v5, v5, v101, v102
    v_max_u32 v5, v5, v103
    v_cmp_eq_u32 vcc, -1, v5
    s_cbranch_vccnz L_oretry_3
L_odone_3:
    s_branch L_ogo_3
L_slow_wq:
    s_mov_b32 s46, 0x2000000
L_lp_23:
    ds_read_b32 v5, v6 offset:8
    s_waitcnt lgkmcnt(0)
    v_readfirstlane_b32 s73, v5
    s_cmp_ge_u32 s73, 2
    s_cbranch_scc1 L_lpd_24
    s_sub_u32 s46, s46, 1
    s_cbranch_scc1 L_lpd_24
    s_branch L_lp_23
L_lpd_24:
    s_branch L_back_wq
L_slow_a:
    s_mov_b32 s46, 0x2000000
L_lp_25:
    ds_read_b32 v5, v6 offset:28
    s_waitcnt lgkmcnt(0)
    v_readfirstlane_b32 s73, v5
    s_cmp_ge_u32 s73, 1
    s_cbranch_scc1 L_lpd_26
    s_sub_u32 s46, s46, 1
    s_cbranch_scc1 L_lpd_26
    s_branch L_lp_25
L_lpd_26:
    s_branch L_back_a
L_slow_a9:
    s_mov_b32 s46, 0x2000000
L_lp_27:
    ds_read_b32 v5, v6 offset:28
    s_waitcnt lgkmcnt(0)
    v_readfirstlane_b32 s73, v5
    s_cmp_ge_u32 s73, 2
    s_cbranch_scc1 L_lpd_28
    s_sub_u32 s46, s46, 1
    s_cbranch_scc1 L_lpd_28
    s_branch L_lp_27
L_lpd_28:
    s_branch L_back_a9
L_slow_a17:
    s_mov_b32 s46, 0x2000000
L_lp_29:
    ds_read_b32 v5, v6 offset:28
    s_waitcnt lgkmcnt(0)
    v_readfirstlane_b32 s73, v5
    s_cmp_ge_u32 s73, 3
    s_cbranch_scc1 L_lpd_30
    s_sub_u32 s46, s46, 1
    s_cbranch_scc1 L_lpd_30
    s_branch L_lp_29
L_lpd_30:
    s_branch L_back_a17
L_slow_a25:
    s_mov_b32 s46, 0x2000000
L_lp_31:
    ds_read_b32 v5, v6 offset:28
    s_waitcnt lgkmcnt(0)
    v_readfirstlane_b32 s73, v5
    s_cmp_ge_u32 s73, 4
    s_cbranch_scc1 L_lpd_32
    s_sub_u32 s46, s46, 1
    s_cbranch_scc1 L_lpd_32
    s_branch L_lp_31
L_lpd_32:
    s_branch L_back_a25
L_slow_l1:
    s_mov_b32 s46, 0x2000000
L_lp_33:
    ds_read_b32 v5, v6 offset:84
    s_waitcnt lgkmcnt(0)
    v_readfirstlane_b32 s73, v5
    s_cmp_ge_u32 s73, 4
    s_cbranch_scc1 L_lpd_34
    s_sub_u32 s46, s46, 1
    s_cbranch_scc1 L_lpd_34
    s_branch L_lp_33
L_lpd_34:
    s_branch L_back_l1
L_slow_h2:
    s_mov_b32 s46, 0x2000000
L_lp_35:
    ds_read_b32 v5, v6 offset:40
    s_waitcnt lgkmcnt(0)
    v_readfirstlane_b32 s73, v5
    s_cmp_ge_u32 s73, 4
    s_cbranch_scc1 L_lpd_36
    s_sub_u32 s46, s46, 1
    s_cbranch_scc1 L_lpd_36
    s_branch L_lp_35
L_lpd_36:
    s_branch L_back_h2
L_ln2:
    s_lshr_b32 s73, s3, 2
    s_mul_i32 s73, s73, 33792
    s_and_b32 s74, s3, 3
    s_lshl_b32 s74, s74, 7
    s_add_u32 s74, s74, 66560
    s_add_u32 s75, s74, 33792
    s_sub_u32 s75, s75, s73
    s_add_u32 s73, s73, s74
    v_mul_u32_u24 v122, 528, v3
    v_lshl_add_u32 v122, v2, 4, v122
    v_add_u32 v5, s75, v122
    v_add_u32 v122, s73, v122
    v_mov_b32 v110, 0x3f803f80
    v_mov_b64 v[112:113], 0
    v_mov_b64 v[104:105], 0
    v_mov_b32 v108, 0x3f80
    v_mov_b32 v109, 0x3f800000
    v_dot2c_f32_bf16 v112, v8, v110
    v_dot2c_f32_bf16 v113, v9, v110
    v_dot2c_f32_bf16 v112, v10, v110
    v_dot2c_f32_bf16 v113, v11, v110
    v_dot2c_f32_bf16 v112, v12, v110
    v_dot2c_f32_bf16 v113, v13, v110
    v_dot2c_f32_bf16 v112, v14, v110
    v_dot2c_f32_bf16 v113, v15, v110
    v_dot2c_f32_bf16 v112, v16, v110
    v_dot2c_f32_bf16 v113, v17, v110
    v_dot2c_f32_bf16 v112, v18, v110
    v_dot2c_f32_bf16 v113, v19, v110
    v_dot2c_f32_bf16 v112, v20, v110
    v_dot2c_f32_bf16 v113, v21, v110
    v_dot2c_f32_bf16 v112, v22, v110
    v_dot2c_f32_bf16 v113, v23, v110
    v_dot2c_f32_bf16 v112, v24, v110
    v_dot2c_f32_bf16 v113, v25, v110
    v_dot2c_f32_bf16 v112, v26, v110
    v_dot2c_f32_bf16 v113, v27, v110
    v_dot2c_f32_bf16 v112, v28, v110
    v_dot2c_f32_bf16 v113, v29, v110
    v_dot2c_f32_bf16 v112, v30, v110
    v_dot2c_f32_bf16 v113, v31, v110
    v_dot2c_f32_bf16 v112, v32, v110
    v_dot2c_f32_bf16 v113, v33, v110
    v_dot2c_f32_bf16 v112, v34, v110
    v_dot2c_f32_bf16 v113, v35, v110
    v_dot2c_f32_bf16 v112, v36, v110
    v_dot2c_f32_bf16 v113, v37, v110
    v_dot2c_f32_bf16 v112, v38, v110
    v_dot2c_f32_bf16 v113, v39, v110
    s_nop 2
    v_add_f32 v112, v112, v113
    s_nop 1
    v_add_f32_dpp v112, v112, v112 quad_perm:[1,0,3,2] row_mask:0xf bank_mask:0xf
    s_nop 1
    v_add_f32_dpp v112, v112, v112 quad_perm:[2,3,0,1] row_mask:0xf bank_mask:0xf
    s_nop 1
    v_add_f32_dpp v112, v112, v112 row_half_mirror row_mask:0xf bank_mask:0xf
    v_mul_f32 v121, 0xbb000000, v112
    v_cvt_pk_bf16_f32 v120, v121, v121
    v_and_b32 v120, s44, v120
    v_sub_f32 v121, v121, v120
    v_dot2_f32_bf16 v40, v8, v108, v120
    v_dot2_f32_bf16 v41, v8, v109, v120
    v_dot2_f32_bf16 v42, v9, v108, v120
    v_dot2_f32_bf16 v43, v9, v109, v120
    v_dot2_f32_bf16 v44, v10, v108, v120
    v_dot2_f32_bf16 v45, v10, v109, v120
    v_dot2_f32_bf16 v46, v11, v108, v120
    v_dot2_f32_bf16 v47, v11, v109, v120
    v_dot2_f32_bf16 v48, v12, v108, v120
    v_dot2_f32_bf16 v49, v12, v109, v120
    v_dot2_f32_bf16 v50, v13, v108, v120
    v_dot2_f32_bf16 v51, v13, v109, v120
    v_dot2_f32_bf16 v52, v14, v108, v120
    v_dot2_f32_bf16 v53, v14, v109, v120
    v_dot2_f32_bf16 v54, v15, v108, v120
    v_dot2_f32_bf16 v55, v15, v109, v120
    v_dot2_f32_bf16 v56, v16, v108, v120
    v_dot2_f32_bf16 v57, v16, v109, v120
    v_dot2_f32_bf16 v58, v17, v108, v120
    v_dot2_f32_bf16 v59, v17, v109, v120
    v_dot2_f32_bf16 v60, v18, v108, v120
    v_dot2_f32_bf16 v61, v18, v109, v120
    v_dot2_f32_bf16 v62, v19, v108, v120
    v_dot2_f32_bf16 v63, v19, v109, v120
    v_dot2_f32_bf16 v64, v20, v108, v120
    v_dot2_f32_bf16 v65, v20, v109, v120
    v_dot2_f32_bf16 v66, v21, v108, v120
    v_dot2_f32_bf16 v67, v21, v109, v120
    v_dot2_f32_bf16 v68, v22, v108, v120
    v_dot2_f32_bf16 v69, v22, v109, v120
    v_dot2_f32_bf16 v70, v23, v108, v120
    v_dot2_f32_bf16 v71, v23, v109, v120
    v_dot2_f32_bf16 v72, v24, v108, v120
    v_dot2_f32_bf16 v73, v24, v109, v120
    v_dot2_f32_bf16 v74, v25, v108, v120
    v_dot2_f32_bf16 v75, v25, v109, v120
    v_dot2_f32_bf16 v76, v26, v108, v120
    v_dot2_f32_bf16 v77, v26, v109, v120
    v_dot2_f32_bf16 v78, v27, v108, v120
    v_dot2_f32_bf16 v79, v27, v109, v120
    v_dot2_f32_bf16 v80, v28, v108, v120
    v_dot2_f32_bf16 v81, v28, v109, v120
    v_dot2_f32_bf16 v82, v29, v108, v120
    v_dot2_f32_bf16 v83, v29, v109, v120
    v_dot2_f32_bf16 v84, v30, v108, v120
    v_dot2_f32_bf16 v85, v30, v109, v120
    v_dot2_f32_bf16 v86, v31, v108, v120
    v_dot2_f32_bf16 v87, v31, v109, v120
    v_dot2_f32_bf16 v88, v32, v108, v120
    v_dot2_f32_bf16 v89, v32, v109, v120
    v_dot2_f32_bf16 v90, v33, v108, v120
    v_dot2_f32_bf16 v91, v33, v109, v120
    v_dot2_f32_bf16 v92, v34, v108, v120
    v_dot2_f32_bf16 v93, v34, v109, v120
    v_dot2_f32_bf16 v94, v35, v108, v120
    v_dot2_f32_bf16 v95, v35, v109, v120
    v_dot2_f32_bf16 v96, v36, v108, v120
    v_dot2_f32_bf16 v97, v36, v109, v120
    v_dot2_f32_bf16 v98, v37, v108, v120
    v_dot2_f32_bf16 v99, v37, v109, v120
    v_dot2_f32_bf16 v100, v38, v108, v120
    v_dot2_f32_bf16 v101, v38, v109, v120
    v_dot2_f32_bf16 v102, v39, v108, v120
    v_dot2_f32_bf16 v103, v39, v109, v120
    v_pk_mul_f32 v[112:113], v[40:41], v[40:41]
    v_pk_mul_f32 v[114:115], v[42:43], v[42:43]
    v_pk_mul_f32 v[116:117], v[44:45], v[44:45]
    v_pk_mul_f32 v[118:119], v[46:47], v[46:47]
    v_pk_fma_f32 v[112:113], v[48:49], v[48:49], v[112:113]
    v_pk_fma_f32 v[114:115], v[50:51], v[50:51], v[114:115]
    v_pk_fma_f32 v[116:117], v[52:53], v[52:53], v[116:117]
    v_pk_fma_f32 v[118:119], v[54:55], v[54:55], v[118:119]
    v_pk_fma_f32 v[112:113], v[56:57], v[56:57], v[112:113]
    v_pk_fma_f32 v[114:115], v[58:59], v[58:59], v[114:115]
    v_pk_fma_f32 v[116:117], v[60:61], v[60:61], v[116:117]
    v_pk_fma_f32 v[118:119], v[62:63], v[62:63], v[118:119]
    v_pk_fma_f32 v[112:113], v[64:65], v[64:65], v[112:113]
    v_pk_fma_f32 v[114:115], v[66:67], v[66:67], v[114:115]
    v_pk_fma_f32 v[116:117], v[68:69], v[68:69], v[116:117]
    v_pk_fma_f32 v[118:119], v[70:71], v[70:71], v[118:119]
    v_pk_fma_f32 v[112:113], v[72:73], v[72:73], v[112:113]
    v_pk_fma_f32 v[114:115], v[74:75], v[74:75], v[114:115]
    v_pk_fma_f32 v[116:117], v[76:77], v[76:77], v[116:117]
    v_pk_fma_f32 v[118:119], v[78:79], v[78:79], v[118:119]
    v_pk_fma_f32 v[112:113], v[80:81], v[80:81], v[112:113]
    v_pk_fma_f32 v[114:115], v[82:83], v[82:83], v[114:115]
    v_pk_fma_f32 v[116:117], v[84:85], v[84:85], v[116:117]
    v_pk_fma_f32 v[118:119], v[86:87], v[86:87], v[118:119]
    v_pk_fma_f32 v[112:113], v[88:89], v[88:89], v[112:113]
    v_pk_fma_f32 v[114:115], v[90:91], v[90:91], v[114:115]
    v_pk_fma_f32 v[116:117], v[92:93], v[92:93], v[116:117]
    v_pk_fma_f32 v[118:119], v[94:95], v[94:95], v[118:119]
    v_pk_fma_f32 v[112:113], v[96:97], v[96:97], v[112:113]
    v_pk_fma_f32 v[114:115], v[98:99], v[98:99], v[114:115]
    v_pk_fma_f32 v[116:117], v[100:101], v[100:101], v[116:117]
    v_pk_fma_f32 v[118:119], v[102:103], v[102:103], v[118:119]
    v_pk_add_f32 v[112:113], v[112:113], v[114:115]
    v_pk_add_f32 v[116:117], v[116:117], v[118:119]
    v_pk_add_f32 v[112:113], v[112:113], v[116:117]
    v_add_f32 v112, v112, v113
    s_nop 1
    v_add_f32_dpp v112, v112, v112 quad_perm:[1,0,3,2] row_mask:0xf bank_mask:0xf
    s_nop 1
    v_add_f32_dpp v112, v112, v112 quad_perm:[2,3,0,1] row_mask:0xf bank_mask:0xf
    s_nop 1
    v_add_f32_dpp v112, v112, v112 row_half_mirror row_mask:0xf bank_mask:0xf
    v_mul_f32 v119, 0x3b000000, v112
    v_fma_f32 v119, -v121, v121, v119
    v_max_f32 v119, 0, v119
    v_cvt_pk_bf16_f32 v119, v119, v119
    v_and_b32 v119, s44, v119
    v_add_f32 v119, 0x3727c5ac, v119
    v_cvt_pk_bf16_f32 v119, v119, v119
    v_and_b32 v119, s44, v119
    v_sqrt_f32 v119, v119
    s_nop 0
    v_cvt_pk_bf16_f32 v119, v119, v119
    v_and_b32 v119, s44, v119
    v_rcp_f32 v118, v119
    s_nop 0
    v_pk_mul_f32 v[40:41], v[40:41], v[118:119] op_sel_hi:[1,0]
    v_pk_mul_f32 v[42:43], v[42:43], v[118:119] op_sel_hi:[1,0]
    v_pk_mul_f32 v[44:45], v[44:45], v[118:119] op_sel_hi:[1,0]
    v_pk_mul_f32 v[46:47], v[46:47], v[118:119] op_sel_hi:[1,0]
    v_cvt_pk_bf16_f32 v8, v40, v41
    v_cvt_pk_bf16_f32 v9, v42, v43
    v_cvt_pk_bf16_f32 v10, v44, v45
    v_cvt_pk_bf16_f32 v11, v46, v47
    ds_write_b128 v122, v[8:11] offset:0
    s_waitcnt vmcnt(0)
    v_dot2c_f32_bf16 v104, v128, v110
    v_dot2c_f32_bf16 v105, v129, v110
    v_dot2c_f32_bf16 v104, v130, v110
    v_dot2c_f32_bf16 v105, v131, v110
    v_dot2c_f32_bf16 v104, v132, v110
    v_dot2c_f32_bf16 v105, v133, v110
    v_dot2c_f32_bf16 v104, v134, v110
    v_dot2c_f32_bf16 v105, v135, v110
    v_dot2c_f32_bf16 v104, v136, v110
    v_dot2c_f32_bf16 v105, v137, v110
    v_dot2c_f32_bf16 v104, v138, v110
    v_dot2c_f32_bf16 v105, v139, v110
    v_dot2c_f32_bf16 v104, v140, v110
    v_dot2c_f32_bf16 v105, v141, v110
    v_dot2c_f32_bf16 v104, v142, v110
    v_dot2c_f32_bf16 v105, v143, v110
    v_pk_mul_f32 v[48:49], v[48:49], v[118:119] op_sel_hi:[1,0]
    v_pk_mul_f32 v[50:51], v[50:51], v[118:119] op_sel_hi:[1,0]
    v_pk_mul_f32 v[52:53], v[52:53], v[118:119] op_sel_hi:[1,0]
    v_pk_mul_f32 v[54:55], v[54:55], v[118:119] op_sel_hi:[1,0]
    v_cvt_pk_bf16_f32 v12, v48, v49
    v_cvt_pk_bf16_f32 v13, v50, v51
    v_cvt_pk_bf16_f32 v14, v52, v53
    v_cvt_pk_bf16_f32 v15, v54, v55
    ds_write_b128 v122, v[12:15] offset:4224
    v_dot2c_f32_bf16 v104, v144, v110
    v_dot2c_f32_bf16 v105, v145, v110
    v_dot2c_f32_bf16 v104, v146, v110
    v_dot2c_f32_bf16 v105, v147, v110
    v_dot2c_f32_bf16 v104, v148, v110
    v_dot2c_f32_bf16 v105, v149, v110
    v_dot2c_f32_bf16 v104, v150, v110
    v_dot2c_f32_bf16 v105, v151, v110
    v_dot2c_f32_bf16 v104, v152, v110
    v_dot2c_f32_bf16 v105, v153, v110
    v_dot2c_f32_bf16 v104, v154, v110
    v_dot2c_f32_bf16 v105, v155, v110
    v_dot2c_f32_bf16 v104, v156, v110
    v_dot2c_f32_bf16 v105, v157, v110
    v_dot2c_f32_bf16 v104, v158, v110
    v_dot2c_f32_bf16 v105, v159, v110
    v_pk_mul_f32 v[56:57], v[56:57], v[118:119] op_sel_hi:[1,0]
    v_pk_mul_f32 v[58:59], v[58:59], v[118:119] op_sel_hi:[1,0]
    v_pk_mul_f32 v[60:61], v[60:61], v[118:119] op_sel_hi:[1,0]
    v_add_f32 v104, v104, v105
    v_pk_mul_f32 v[62:63], v[62:63], v[118:119] op_sel_hi:[1,0]
    v_cvt_pk_bf16_f32 v16, v56, v57
    v_cvt_pk_bf16_f32 v17, v58, v59
    v_add_f32_dpp v104, v104, v104 quad_perm:[1,0,3,2] row_mask:0xf bank_mask:0xf
    v_cvt_pk_bf16_f32 v18, v60, v61
    v_cvt_pk_bf16_f32 v19, v62, v63
    ds_write_b128 v122, v[16:19] offset:8448
    v_add_f32_dpp v104, v104, v104 quad_perm:[2,3,0,1] row_mask:0xf bank_mask:0xf
    v_pk_mul_f32 v[64:65], v[64:65], v[118:119] op_sel_hi:[1,0]
    v_pk_mul_f32 v[66:67], v[66:67], v[118:119] op_sel_hi:[1,0]
    v_pk_mul_f32 v[68:69], v[68:69], v[118:119] op_sel_hi:[1,0]
    v_add_f32_dpp v104, v104, v104 row_half_mirror row_mask:0xf bank_mask:0xf
    v_pk_mul_f32 v[70:71], v[70:71], v[118:119] op_sel_hi:[1,0]
    v_cvt_pk_bf16_f32 v20, v64, v65
    v_cvt_pk_bf16_f32 v21, v66, v67
    v_mul_f32 v123, 0xbb000000, v104
    v_cvt_pk_bf16_f32 v22, v68, v69
    v_cvt_pk_bf16_f32 v23, v70, v71
    ds_write_b128 v122, v[20:23] offset:12672
    v_cvt_pk_bf16_f32 v111, v123, v123
    v_and_b32 v111, s44, v111
    v_sub_f32 v123, v123, v111
    v_dot2_f32_bf16 v160, v128, v108, v111
    v_dot2_f32_bf16 v161, v128, v109, v111
    v_dot2_f32_bf16 v162, v129, v108, v111
    v_dot2_f32_bf16 v163, v129, v109, v111
    v_dot2_f32_bf16 v164, v130, v108, v111
    v_dot2_f32_bf16 v165, v130, v109, v111
    v_dot2_f32_bf16 v166, v131, v108, v111
    v_dot2_f32_bf16 v167, v131, v109, v111
    v_dot2_f32_bf16 v168, v132, v108, v111
    v_dot2_f32_bf16 v169, v132, v109, v111
    v_dot2_f32_bf16 v170, v133, v108, v111
    v_dot2_f32_bf16 v171, v133, v109, v111
    v_dot2_f32_bf16 v172, v134, v108, v111
    v_dot2_f32_bf16 v173, v134, v109, v111
    v_dot2_f32_bf16 v174, v135, v108, v111
    v_dot2_f32_bf16 v175, v135, v109, v111
    v_dot2_f32_bf16 v176, v136, v108, v111
    v_dot2_f32_bf16 v177, v136, v109, v111
    v_dot2_f32_bf16 v178, v137, v108, v111
    v_dot2_f32_bf16 v179, v137, v109, v111
    v_dot2_f32_bf16 v180, v138, v108, v111
    v_dot2_f32_bf16 v181, v138, v109, v111
    v_dot2_f32_bf16 v182, v139, v108, v111
    v_dot2_f32_bf16 v183, v139, v109, v111
    v_pk_mul_f32 v[72:73], v[72:73], v[118:119] op_sel_hi:[1,0]
    v_pk_mul_f32 v[74:75], v[74:75], v[118:119] op_sel_hi:[1,0]
    v_pk_mul_f32 v[76:77], v[76:77], v[118:119] op_sel_hi:[1,0]
    v_pk_mul_f32 v[78:79], v[78:79], v[118:119] op_sel_hi:[1,0]
    v_cvt_pk_bf16_f32 v24, v72, v73
    v_cvt_pk_bf16_f32 v25, v74, v75
    v_cvt_pk_bf16_f32 v26, v76, v77
    v_cvt_pk_bf16_f32 v27, v78, v79
    ds_write_b128 v122, v[24:27] offset:16896
    v_dot2_f32_bf16 v184, v140, v108, v111
    v_dot2_f32_bf16 v185, v140, v109, v111
    v_dot2_f32_bf16 v186, v141, v108, v111
    v_dot2_f32_bf16 v187, v141, v109, v111
    v_dot2_f32_bf16 v188, v142, v108, v111
    v_dot2_f32_bf16 v189, v142, v109, v111
    v_dot2_f32_bf16 v190, v143, v108, v111
    v_dot2_f32_bf16 v191, v143, v109, v111
    v_dot2_f32_bf16 v192, v144, v108, v111
    v_dot2_f32_bf16 v193, v144, v109, v111
    v_dot2_f32_bf16 v194, v145, v108, v111
    v_dot2_f32_bf16 v195, v145, v109, v111
    v_dot2_f32_bf16 v196, v146, v108, v111
    v_dot2_f32_bf16 v197, v146, v109, v111
    v_dot2_f32_bf16 v198, v147, v108, v111
    v_dot2_f32_bf16 v199, v147, v109, v111
    v_dot2_f32_bf16 v232, v148, v108, v111
    v_dot2_f32_bf16 v233, v148, v109, v111
    v_dot2_f32_bf16 v234, v149, v108, v111
    v_dot2_f32_bf16 v235, v149, v109, v111
    v_dot2_f32_bf16 v236, v150, v108, v111
    v_dot2_f32_bf16 v237, v150, v109, v111
    v_dot2_f32_bf16 v238, v151, v108, v111
    v_dot2_f32_bf16 v239, v151, v109, v111
    v_pk_mul_f32 v[80:81], v[80:81], v[118:119] op_sel_hi:[1,0]
    v_pk_mul_f32 v[82:83], v[82:83], v[118:119] op_sel_hi:[1,0]
    v_pk_mul_f32 v[84:85], v[84:85], v[118:119] op_sel_hi:[1,0]
    v_pk_mul_f32 v[86:87], v[86:87], v[118:119] op_sel_hi:[1,0]
    v_cvt_pk_bf16_f32 v28, v80, v81
    v_cvt_pk_bf16_f32 v29, v82, v83
    v_cvt_pk_bf16_f32 v30, v84, v85
    v_cvt_pk_bf16_f32 v31, v86, v87
    ds_write_b128 v122, v[28:31] offset:21120
    v_dot2_f32_bf16 v240, v152, v108, v111
    v_dot2_f32_bf16 v241, v152, v109, v111
    v_dot2_f32_bf16 v242, v153, v108, v111
    v_dot2_f32_bf16 v243, v153, v109, v111
    v_dot2_f32_bf16 v244, v154, v108, v111
    v_dot2_f32_bf16 v245, v154, v109, v111
    v_dot2_f32_bf16 v246, v155, v108, v111
    v_dot2_f32_bf16 v247, v155, v109, v111
    v_dot2_f32_bf16 v248, v156, v108, v111
    v_dot2_f32_bf16 v249, v156, v109, v111
    v_dot2_f32_bf16 v250, v157, v108, v111
    v_dot2_f32_bf16 v251, v157, v109, v111
    v_dot2_f32_bf16 v252, v158, v108, v111
    v_dot2_f32_bf16 v253, v158, v109, v111
    v_dot2_f32_bf16 v254, v159, v108, v111
    v_dot2_f32_bf16 v255, v159, v109, v111
    v_pk_mul_f32 v[104:105], v[160:161], v[160:161]
    v_pk_mul_f32 v[106:107], v[162:163], v[162:163]
    v_pk_mul_f32 v[124:125], v[164:165], v[164:165]
    v_pk_mul_f32 v[126:127], v[166:167], v[166:167]
    v_pk_fma_f32 v[104:105], v[168:169], v[168:169], v[104:105]
    v_pk_fma_f32 v[106:107], v[170:171], v[170:171], v[106:107]
    v_pk_fma_f32 v[124:125], v[172:173], v[172:173], v[124:125]
    v_pk_fma_f32 v[126:127], v[174:175], v[174:175], v[126:127]
    v_pk_mul_f32 v[88:89], v[88:89], v[118:119] op_sel_hi:[1,0]
    v_pk_mul_f32 v[90:91], v[90:91], v[118:119] op_sel_hi:[1,0]
    v_pk_mul_f32 v[92:93], v[92:93], v[118:119] op_sel_hi:[1,0]
    v_pk_mul_f32 v[94:95], v[94:95], v[118:119] op_sel_hi:[1,0]
    v_cvt_pk_bf16_f32 v32, v88, v89
    v_cvt_pk_bf16_f32 v33, v90, v91
    v_cvt_pk_bf16_f32 v34, v92, v93
    v_cvt_pk_bf16_f32 v35, v94, v95
    ds_write_b128 v122, v[32:35] offset:25344
    v_pk_fma_f32 v[104:105], v[176:177], v[176:177], v[104:105]
    v_pk_fma_f32 v[106:107], v[178:179], v[178:179], v[106:107]
    v_pk_fma_f32 v[124:125], v[180:181], v[180:181], v[124:125]
    v_pk_fma_f32 v[126:127], v[182:183], v[182:183], v[126:127]
    v_pk_fma_f32 v[104:105], v[184:185], v[184:185], v[104:105]
    v_pk_fma_f32 v[106:107], v[186:187], v[186:187], v[106:107]
    v_pk_fma_f32 v[124:125], v[188:189], v[188:189], v[124:125]
    v_pk_fma_f32 v[126:127], v[190:191], v[190:191], v[126:127]
    v_pk_fma_f32 v[104:105], v[192:193], v[192:193], v[104:105]
    v_pk_fma_f32 v[106:107], v[194:195], v[194:195], v[106:107]
    v_pk_fma_f32 v[124:125], v[196:197], v[196:197], v[124:125]
    v_pk_fma_f32 v[126:127], v[198:199], v[198:199], v[126:127]
    v_pk_fma_f32 v[104:105], v[232:233], v[232:233], v[104:105]
    v_pk_fma_f32 v[106:107], v[234:235], v[234:235], v[106:107]
    v_pk_fma_f32 v[124:125], v[236:237], v[236:237], v[124:125]
    v_pk_fma_f32 v[126:127], v[238:239], v[238:239], v[126:127]
    v_pk_fma_f32 v[104:105], v[240:241], v[240:241], v[104:105]
    v_pk_fma_f32 v[106:107], v[242:243], v[242:243], v[106:107]
    v_pk_fma_f32 v[124:125], v[244:245], v[244:245], v[124:125]
    v_pk_fma_f32 v[126:127], v[246:247], v[246:247], v[126:127]
    v_pk_fma_f32 v[104:105], v[248:249], v[248:249], v[104:105]
    v_pk_fma_f32 v[106:107], v[250:251], v[250:251], v[106:107]
    v_pk_fma_f32 v[124:125], v[252:253], v[252:253], v[124:125]
    v_pk_fma_f32 v[126:127], v[254:255], v[254:255], v[126:127]
    v_pk_mul_f32 v[96:97], v[96:97], v[118:119] op_sel_hi:[1,0]
    v_pk_mul_f32 v[98:99], v[98:99], v[118:119] op_sel_hi:[1,0]
    v_pk_mul_f32 v[100:101], v[100:101], v[118:119] op_sel_hi:[1,0]
    v_pk_mul_f32 v[102:103], v[102:103], v[118:119] op_sel_hi:[1,0]
    v_cvt_pk_bf16_f32 v36, v96, v97
    v_cvt_pk_bf16_f32 v37, v98, v99
    v_cvt_pk_bf16_f32 v38, v100, v101
    v_cvt_pk_bf16_f32 v39, v102, v103
    ds_write_b128 v122, v[36:39] offset:29568
    v_pk_add_f32 v[104:105], v[104:105], v[106:107]
    v_pk_add_f32 v[124:125], v[124:125], v[126:127]
    v_pk_add_f32 v[104:105], v[104:105], v[124:125]
    v_add_f32 v104, v104, v105
    s_nop 1
    v_add_f32_dpp v104, v104, v104 quad_perm:[1,0,3,2] row_mask:0xf bank_mask:0xf
    s_nop 1
    v_add_f32_dpp v104, v104, v104 quad_perm:[2,3,0,1] row_mask:0xf bank_mask:0xf
    s_nop 1
    v_add_f32_dpp v104, v104, v104 row_half_mirror row_mask:0xf bank_mask:0xf
    v_mul_f32 v127, 0x3b000000, v104
    v_fma_f32 v127, -v123, v123, v127
    v_max_f32 v127, 0, v127
    v_cvt_pk_bf16_f32 v127, v127, v127
    v_and_b32 v127, s44, v127
    v_add_f32 v127, 0x3727c5ac, v127
    v_cvt_pk_bf16_f32 v127, v127, v127
    v_and_b32 v127, s44, v127
    v_sqrt_f32 v127, v127
    s_nop 0
    v_cvt_pk_bf16_f32 v127, v127, v127
    v_and_b32 v127, s44, v127
    v_rcp_f32 v126, v127
    s_nop 0
    s_mov_b64 exec, 1
    ds_add_u32 v6, v7 offset:0
    s_mov_b64 exec, -1
L_dry_3:
    v_pk_mul_f32 v[160:161], v[160:161], v[126:127] op_sel_hi:[1,0]
    v_pk_mul_f32 v[162:163], v[162:163], v[126:127] op_sel_hi:[1,0]
    v_pk_mul_f32 v[164:165], v[164:165], v[126:127] op_sel_hi:[1,0]
    v_pk_mul_f32 v[166:167], v[166:167], v[126:127] op_sel_hi:[1,0]
    v_cvt_pk_bf16_f32 v128, v160, v161
    v_cvt_pk_bf16_f32 v129, v162, v163
    v_cvt_pk_bf16_f32 v130, v164, v165
    v_cvt_pk_bf16_f32 v131, v166, v167
    ds_write_b128 v5, v[128:131] offset:0
    v_pk_mul_f32 v[168:169], v[168:169], v[126:127] op_sel_hi:[1,0]
    v_pk_mul_f32 v[170:171], v[170:171], v[126:127] op_sel_hi:[1,0]
    v_pk_mul_f32 v[172:173], v[172:173], v[126:127] op_sel_hi:[1,0]
    v_pk_mul_f32 v[174:175], v[174:175], v[126:127] op_sel_hi:[1,0]
    v_cvt_pk_bf16_f32 v132, v168, v169
    v_cvt_pk_bf16_f32 v133, v170, v171
    v_cvt_pk_bf16_f32 v134, v172, v173
    v_cvt_pk_bf16_f32 v135, v174, v175
    ds_write_b128 v5, v[132:135] offset:4224
    v_pk_mul_f32 v[176:177], v[176:177], v[126:127] op_sel_hi:[1,0]
    v_pk_mul_f32 v[178:179], v[178:179], v[126:127] op_sel_hi:[1,0]
    v_pk_mul_f32 v[180:181], v[180:181], v[126:127] op_sel_hi:[1,0]
    v_pk_mul_f32 v[182:183], v[182:183], v[126:127] op_sel_hi:[1,0]
    v_cvt_pk_bf16_f32 v136, v176, v177
    v_cvt_pk_bf16_f32 v137, v178, v179
    v_cvt_pk_bf16_f32 v138, v180, v181
    v_cvt_pk_bf16_f32 v139, v182, v183
    ds_write_b128 v5, v[136:139] offset:8448
    v_pk_mul_f32 v[184:185], v[184:185], v[126:127] op_sel_hi:[1,0]
    v_pk_mul_f32 v[186:187], v[186:187], v[126:127] op_sel_hi:[1,0]
    v_pk_mul_f32 v[188:189], v[188:189], v[126:127] op_sel_hi:[1,0]
    v_pk_mul_f32 v[190:191], v[190:191], v[126:127] op_sel_hi:[1,0]
    v_cvt_pk_bf16_f32 v140, v184, v185
    v_cvt_pk_bf16_f32 v141, v186, v187
    v_cvt_pk_bf16_f32 v142, v188, v189
    v_cvt_pk_bf16_f32 v143, v190, v191
    ds_write_b128 v5, v[140:143] offset:12672
    v_pk_mul_f32 v[192:193], v[192:193], v[126:127] op_sel_hi:[1,0]
    v_pk_mul_f32 v[194:195], v[194:195], v[126:127] op_sel_hi:[1,0]
    v_pk_mul_f32 v[196:197], v[196:197], v[126:127] op_sel_hi:[1,0]
    v_pk_mul_f32 v[198:199], v[198:199], v[126:127] op_sel_hi:[1,0]
    v_cvt_pk_bf16_f32 v144, v192, v193
    v_cvt_pk_bf16_f32 v145, v194, v195
    v_cvt_pk_bf16_f32 v146, v196, v197
    v_cvt_pk_bf16_f32 v147, v198, v199
    ds_write_b128 v5, v[144:147] offset:16896
    v_pk_mul_f32 v[232:233], v[232:233], v[126:127] op_sel_hi:[1,0]
    v_pk_mul_f32 v[234:235], v[234:235], v[126:127] op_sel_hi:[1,0]
    v_pk_mul_f32 v[236:237], v[236:237], v[126:127] op_sel_hi:[1,0]
    v_pk_mul_f32 v[238:239], v[238:239], v[126:127] op_sel_hi:[1,0]
    v_cvt_pk_bf16_f32 v148, v232, v233
    v_cvt_pk_bf16_f32 v149, v234, v235
    v_cvt_pk_bf16_f32 v150, v236, v237
    v_cvt_pk_bf16_f32 v151, v238, v239
    ds_write_b128 v5, v[148:151] offset:21120
    v_pk_mul_f32 v[240:241], v[240:241], v[126:127] op_sel_hi:[1,0]
    v_pk_mul_f32 v[242:243], v[242:243], v[126:127] op_sel_hi:[1,0]
    v_pk_mul_f32 v[244:245], v[244:245], v[126:127] op_sel_hi:[1,0]
    v_pk_mul_f32 v[246:247], v[246:247], v[126:127] op_sel_hi:[1,0]
    v_cvt_pk_bf16_f32 v152, v240, v241
    v_cvt_pk_bf16_f32 v153, v242, v243
    v_cvt_pk_bf16_f32 v154, v244, v245
    v_cvt_pk_bf16_f32 v155, v246, v247
    ds_write_b128 v5, v[152:155] offset:25344
    v_pk_mul_f32 v[248:249], v[248:249], v[126:127] op_sel_hi:[1,0]
    v_pk_mul_f32 v[250:251], v[250:251], v[126:127] op_sel_hi:[1,0]
    v_pk_mul_f32 v[252:253], v[252:253], v[126:127] op_sel_hi:[1,0]
    v_pk_mul_f32 v[254:255], v[254:255], v[126:127] op_sel_hi:[1,0]
    v_cvt_pk_bf16_f32 v156, v248, v249
    v_cvt_pk_bf16_f32 v157, v250, v251
    v_cvt_pk_bf16_f32 v158, v252, v253
    v_cvt_pk_bf16_f32 v159, v254, v255
    ds_write_b128 v5, v[156:159] offset:29568
    s_mov_b64 exec, 1
    ds_add_u32 v6, v7 offset:0
    s_mov_b64 exec, -1
    s_branch L_ln_done
L_fallback:
    v_mov_b32 v24, 0xff800000
    v_mov_b32 v25, 0xff800000
    s_mov_b32 s74, 0
    s_mov_b32 s78, 31
L_fb_loop:
    buffer_load_dwordx4 v[8:11], v221, s[40:43], s74 offen sc1
    buffer_load_dwordx4 v[12:15], v221, s[40:43], s74 offen offset:2048 sc1
    s_add_u32 s74, s74, 4096
    s_waitcnt vmcnt(0)
    v_mfma_f32_32x32x16_bf16 v[112:127], v[8:11], v[144:147], 0
    v_mfma_f32_32x32x16_bf16 v[128:143], v[8:11], v[148:151], 0
    s_nop 11
    v_max3_f32 v24, v24, v112, v113
    v_max3_f32 v24, v24, v114, v115
    v_max3_f32 v24, v24, v116, v117
    v_max3_f32 v24, v24, v118, v119
    v_max3_f32 v24, v24, v120, v121
    v_max3_f32 v24, v24, v122, v123
    v_max3_f32 v24, v24, v124, v125
    v_max3_f32 v24, v24, v126, v127
    v_max3_f32 v25, v25, v128, v129
    v_max3_f32 v25, v25, v130, v131
    v_max3_f32 v25, v25, v132, v133
    v_max3_f32 v25, v25, v134, v135
    v_max3_f32 v25, v25, v136, v137
    v_max3_f32 v25, v25, v138, v139
    v_max3_f32 v25, v25, v140, v141
    v_max3_f32 v25, v25, v142, v143
    v_mfma_f32_32x32x16_bf16 v[112:127], v[12:15], v[144:147], 0
    v_mfma_f32_32x32x16_bf16 v[128:143], v[12:15], v[148:151], 0
    s_nop 11
    v_max3_f32 v24, v24, v112, v113
    v_max3_f32 v24, v24, v114, v115
    v_max3_f32 v24, v24, v116, v117
    v_max3_f32 v24, v24, v118, v119
    v_max3_f32 v24, v24, v120, v121
    v_max3_f32 v24, v24, v122, v123
    v_max3_f32 v24, v24, v124, v125
    v_max3_f32 v24, v24, v126, v127
    v_max3_f32 v25, v25, v128, v129
    v_max3_f32 v25, v25, v130, v131
    v_max3_f32 v25, v25, v132, v133
    v_max3_f32 v25, v25, v134, v135
    v_max3_f32 v25, v25, v136, v137
    v_max3_f32 v25, v25, v138, v139
    v_max3_f32 v25, v25, v140, v141
    v_max3_f32 v25, v25, v142, v143
    s_sub_u32 s78, s78, 1
    s_cbranch_scc0 L_fb_loop
    v_mov_b32 v26, v24
    v_mov_b32 v27, v25
    s_nop 1
    v_permlane32_swap_b32 v24, v26
    v_permlane32_swap_b32 v25, v27
    v_max_f32 v24, v24, v26
    v_max_f32 v25, v25, v27
    s_branch L_att_start
L_pre_7:
    s_setprio 3
    s_bitcmp1_b32 s72, 0
    v_lshlrev_b32 v40, 4, v1
    s_waitcnt lgkmcnt(0)
    s_cselect_b64 s[16:17], s[54:55], s[52:53]
    s_cselect_b32 s36, 0, 6
    s_load_dword s7, s[68:69], 0x30000
    s_mov_b64 s[8:9], s[48:49]
    s_mov_b32 m0, 134144
    s_mov_b32 s73, 0
    buffer_load_dwordx4 v40, s[16:19], s73 offen offset:0 lds
    buffer_load_dwordx4 v40, s[16:19], s73 offen offset:1024 lds
    buffer_load_dwordx4 v40, s[16:19], s73 offen offset:2048 lds
    buffer_load_dwordx4 v40, s[16:19], s73 offen offset:3072 lds
    s_mov_b32 m0, 138240
    s_mov_b32 s73, 4096
    buffer_load_dwordx4 v40, s[16:19], s73 offen offset:0 lds
    buffer_load_dwordx4 v40, s[16:19], s73 offen offset:1024 lds
    buffer_load_dwordx4 v40, s[16:19], s73 offen offset:2048 lds
    buffer_load_dwordx4 v40, s[16:19], s73 offen offset:3072 lds
    s_mov_b32 m0, 142336
    s_mov_b32 s73, 8192
    buffer_load_dwordx4 v40, s[16:19], s73 offen offset:0 lds
    buffer_load_dwordx4 v40, s[16:19], s73 offen offset:1024 lds
    buffer_load_dwordx4 v40, s[16:19], s73 offen offset:2048 lds
    buffer_load_dwordx4 v40, s[16:19], s73 offen offset:3072 lds
    s_mov_b32 m0, 146432
    s_mov_b32 s73, 12288
    buffer_load_dwordx4 v40, s[16:19], s73 offen offset:0 lds
    buffer_load_dwordx4 v40, s[16:19], s73 offen offset:1024 lds
    buffer_load_dwordx4 v40, s[16:19], s73 offen offset:2048 lds
    buffer_load_dwordx4 v40, s[16:19], s73 offen offset:3072 lds
    s_barrier
    s_mov_b64 s[12:13], s[50:51]
    s_mov_b64 s[20:21], s[56:57]
    s_mov_b64 s[24:25], s[60:61]
    s_mov_b64 s[28:29], s[62:63]
    s_mov_b64 s[32:33], s[64:65]
    s_mov_b64 s[40:41], s[68:69]
    s_lshl_b32 s47, s71, 10
    s_add_u32 s47, s47, 0x40000
    s_mul_i32 s37, s45, 6144
    s_add_u32 s37, s37, 134144
    s_lshl_b32 s73, s71, 5
    s_lshl_b32 s74, s72, 2
    s_add_u32 s73, s73, s74
    s_and_b32 s74, s45, 1
    s_lshl_b32 s63, s74, 6
    s_lshl_b32 s74, s74, 1
    s_add_u32 s73, s73, s74
    s_lshl_b32 s73, s73, 1
    s_lshr_b32 s74, s45, 1
    s_add_u32 s73, s73, s74
    s_lshl_b32 s73, s73, 10
    s_add_u32 s6, s73, 1048576
    s_lshl_b32 s73, s71, 1
    s_add_u32 s73, s73, s74
    s_lshl_b32 s73, s73, 15
    s_add_u32 s63, s63, s73
    s_lshl_b32 s73, s72, 7
    s_add_u32 s63, s63, s73
    v_lshrrev_b32 v5, 2, v1
    v_and_b32 v5, 4, v5
    v_xor_b32 v5, v5, v3
    v_lshlrev_b32 v5, 4, v5
    v_lshl_add_u32 v219, v2, 10, v5
    v_mul_u32_u24 v220, 3584, v2
    v_add_u32 v220, v220, v5
    v_lshlrev_b32 v221, 4, v1
    v_lshrrev_b32 v212, 5, v1
    v_bfe_u32 v213, v1, 4, 1
    v_bfe_u32 v214, v1, 2, 2
    v_and_b32 v215, 3, v1
    v_lshrrev_b32 v4, 1, v215
    v_lshl_add_u32 v4, v213, 1, v4
    v_lshlrev_b32 v5, 1, v214
    v_and_b32 v5, 4, v5
    v_xor_b32 v4, v4, v5
    v_lshlrev_b32 v216, 7, v214
    v_lshl_add_u32 v216, v4, 4, v216
    v_and_b32 v5, 1, v215
    v_lshl_add_u32 v216, v5, 3, v216
    v_and_b32 v5, 31, v1
    v_mul_u32_u24 v217, 528, v212
    v_lshl_add_u32 v217, v5, 4, v217
    v_add_u32 v217, 66560, v217
    v_add_u32 v218, 33792, v217
    v_lshlrev_b32 v205, 10, v5
    v_lshl_add_u32 v205, v212, 3, v205
    v_mul_u32_u24 v224, 2080, v5
    v_lshl_add_u32 v224, v212, 4, v224
    v_subrev_u32 v228, 1, v212
    v_and_b32 v228, 0x3f803f80, v228
    v_mov_b32 v229, v228
    v_mov_b32 v230, v228
    v_mov_b32 v231, v228
    v_and_b32 v4, 15, v1
    v_lshl_add_u32 v4, v212, 4, v4
    v_lshlrev_b32 v203, 4, v4
    v_lshl_add_u32 v222, v212, 10, v216
    v_lshrrev_b32 v42, 4, v1
    v_and_b32 v43, 15, v1
    s_lshr_b32 s73, s72, 2
    s_mul_i32 s73, s73, 33792
    s_bfe_u32 s74, s72, 0x10001
    s_lshl_b32 s74, s74, 8
    s_add_u32 s73, s73, s74
    s_add_u32 s73, s73, 66560
    v_mul_u32_u24 v44, 528, v42
    v_lshl_add_u32 v44, v43, 4, v44
    v_add_u32 v44, s73, v44
    v_lshlrev_b32 v45, 8, v42
    v_lshl_add_u32 v45, v214, 5, v45
    v_lshl_add_u32 v45, v215, 3, v45
    v_add_u32 v45, 134144, v45
    v_mov_b32 v20, 0x3f803f80
    v_mov_b32 v21, 0x3f803f80
    v_mov_b32 v22, 0x3f803f80
    v_mov_b32 v23, 0x3f803f80
    s_lshl_b32 s75, s71, 1
    s_lshr_b32 s77, s72, 2
    s_add_u32 s75, s75, s77
    s_lshl_b32 s75, s75, 11
    s_add_u32 s75, s75, s74
    v_lshlrev_b32 v46, 3, v212
    v_lshl_add_u32 v46, v43, 4, v46
    s_lshl_b32 s77, s71, 7
    s_lshl_b32 s76, s72, 3
    s_add_u32 s77, s77, s76
    v_mov_b32 v18, 0x38000
    v_lshrrev_b32 v220, 2, v1
    v_lshlrev_b32 v19, 7, v220
    v_lshl_add_u32 v19, v215, 4, v19
    v_lshlrev_b32 v31, 11, v1
    v_mul_u32_u24 v220, 3584, v220
    v_lshl_add_u32 v220, v215, 4, v220
    v_lshlrev_b32 v222, 6, v214
    v_lshl_add_u32 v222, v213, 5, v222
    v_lshl_add_u32 v222, v215, 3, v222
    v_lshl_add_u32 v222, v212, 9, v222
    v_add_u32 v222, s37, v222
    s_waitcnt lgkmcnt(0)
    s_mul_i32 s7, s7, 0x9e3779b1
    s_add_u32 s7, s7, 0x7f4a7c15
    v_mov_b32 v16, s7
    ds_write_b32 v6, v16 offset:24
    s_waitcnt vmcnt(0)
    ds_read_b64_tr_b16 v[128:129], v45 offset:0
    ds_read_b64_tr_b16 v[130:131], v45 offset:128
    ds_read_b64_tr_b16 v[132:133], v45 offset:1024
    ds_read_b64_tr_b16 v[134:135], v45 offset:1152
    ds_read_b64_tr_b16 v[136:137], v45 offset:2048
    ds_read_b64_tr_b16 v[138:139], v45 offset:2176
    ds_read_b64_tr_b16 v[140:141], v45 offset:3072
    ds_read_b64_tr_b16 v[142:143], v45 offset:3200
    ds_read_b64_tr_b16 v[144:145], v45 offset:4096
    ds_read_b64_tr_b16 v[146:147], v45 offset:4224
    ds_read_b64_tr_b16 v[148:149], v45 offset:5120
    ds_read_b64_tr_b16 v[150:151], v45 offset:5248
    ds_read_b64_tr_b16 v[152:153], v45 offset:6144
    s_waitcnt lgkmcnt(8)
    ds_read_b64_tr_b16 v[154:155], v45 offset:6272
    ds_read_b64_tr_b16 v[156:157], v45 offset:7168
    ds_read_b64_tr_b16 v[158:159], v45 offset:7296
    ds_read_b64_tr_b16 v[160:161], v45 offset:8192
    ds_read_b64_tr_b16 v[162:163], v45 offset:8320
    ds_read_b64_tr_b16 v[164:165], v45 offset:9216
    s_waitcnt lgkmcnt(8)
    ds_read_b64_tr_b16 v[166:167], v45 offset:9344
    ds_read_b64_tr_b16 v[168:169], v45 offset:10240
    ds_read_b64_tr_b16 v[170:171], v45 offset:10368
    ds_read_b64_tr_b16 v[172:173], v45 offset:11264
    ds_read_b64_tr_b16 v[174:175], v45 offset:11392
    ds_read_b64_tr_b16 v[176:177], v45 offset:12288
    s_waitcnt lgkmcnt(8)
    ds_read_b64_tr_b16 v[178:179], v45 offset:12416
    ds_read_b64_tr_b16 v[180:181], v45 offset:13312
    ds_read_b64_tr_b16 v[182:183], v45 offset:13440
    ds_read_b64_tr_b16 v[184:185], v45 offset:14336
    ds_read_b64_tr_b16 v[186:187], v45 offset:14464
    ds_read_b64_tr_b16 v[188:189], v45 offset:15360
    s_waitcnt lgkmcnt(8)
    ds_read_b64_tr_b16 v[190:191], v45 offset:15488
    s_mov_b64 exec, 1
    ds_add_u32 v6, v7 offset:0
    s_mov_b64 exec, -1
    v_add_u32 v41, 152576, v224
    s_mov_b32 exec_lo, 0x1f
    s_mov_b32 exec_hi, 0x1f
    ds_write_b128 v41, v[228:231] offset:2048
    s_mov_b64 exec, -1
    s_mov_b32 s46, 0x2000000
L_lp_37:
    ds_read_b32 v5, v6 offset:68
    s_waitcnt lgkmcnt(0)
    v_readfirstlane_b32 s73, v5
    s_cmp_ge_u32 s73, 2
    s_cbranch_scc1 L_lpd_38
    s_sub_u32 s46, s46, 1
    s_cbranch_scc1 L_lpd_38
    s_branch L_lp_37
L_lpd_38:
    ds_read_b128 v[64:67], v44 offset:0
    ds_read_b128 v[68:71], v44 offset:2112
    ds_read_b128 v[72:75], v44 offset:4224
    ds_read_b128 v[76:79], v44 offset:6336
    ds_read_b128 v[80:83], v44 offset:8448
    ds_read_b128 v[84:87], v44 offset:10560
    ds_read_b128 v[88:91], v44 offset:12672
    ds_read_b128 v[92:95], v44 offset:14784
    ds_read_b128 v[96:99], v44 offset:16896
    ds_read_b128 v[100:103], v44 offset:19008
    ds_read_b128 v[104:107], v44 offset:21120
    ds_read_b128 v[108:111], v44 offset:23232
    ds_read_b128 v[112:115], v44 offset:25344
    ds_read_b128 v[116:119], v44 offset:27456
    ds_read_b128 v[120:123], v44 offset:29568
    s_waitcnt lgkmcnt(14)
    ds_read_b128 v[124:127], v44 offset:31680
    s_mov_b64 exec, 1
    s_waitcnt lgkmcnt(8)
    ds_add_u32 v6, v7 offset:72
    s_mov_b64 exec, -1
    s_bitcmp1_b32 s72, 0
    s_cbranch_scc1 L_w7_v
    v_mfma_f32_16x16x32_bf16 v[12:15], v[128:131], v[20:23], 0
    v_mfma_f32_16x16x32_bf16 v[8:11], v[128:131], v[64:67], 0
    v_mfma_f32_16x16x32_bf16 v[12:15], v[132:135], v[20:23], v[12:15]
    v_mfma_f32_16x16x32_bf16 v[8:11], v[132:135], v[68:71], v[8:11]
    v_mfma_f32_16x16x32_bf16 v[12:15], v[136:139], v[20:23], v[12:15]
    v_mfma_f32_16x16x32_bf16 v[8:11], v[136:139], v[72:75], v[8:11]
    v_mfma_f32_16x16x32_bf16 v[12:15], v[140:143], v[20:23], v[12:15]
    v_mfma_f32_16x16x32_bf16 v[8:11], v[140:143], v[76:79], v[8:11]
    v_mfma_f32_16x16x32_bf16 v[12:15], v[144:147], v[20:23], v[12:15]
    v_mfma_f32_16x16x32_bf16 v[8:11], v[144:147], v[80:83], v[8:11]
    v_mfma_f32_16x16x32_bf16 v[12:15], v[148:151], v[20:23], v[12:15]
    v_mfma_f32_16x16x32_bf16 v[8:11], v[148:151], v[84:87], v[8:11]
    v_mfma_f32_16x16x32_bf16 v[12:15], v[152:155], v[20:23], v[12:15]
    v_mfma_f32_16x16x32_bf16 v[8:11], v[152:155], v[88:91], v[8:11]
    v_mfma_f32_16x16x32_bf16 v[12:15], v[156:159], v[20:23], v[12:15]
    v_mfma_f32_16x16x32_bf16 v[8:11], v[156:159], v[92:95], v[8:11]
    v_mfma_f32_16x16x32_bf16 v[12:15], v[160:163], v[20:23], v[12:15]
    s_waitcnt lgkmcnt(8)
    v_mfma_f32_16x16x32_bf16 v[8:11], v[160:163], v[96:99], v[8:11]
    v_mfma_f32_16x16x32_bf16 v[12:15], v[164:167], v[20:23], v[12:15]
    s_waitcnt lgkmcnt(7)
    v_mfma_f32_16x16x32_bf16 v[8:11], v[164:167], v[100:103], v[8:11]
    v_mfma_f32_16x16x32_bf16 v[12:15], v[168:171], v[20:23], v[12:15]
    s_waitcnt lgkmcnt(6)
    v_mfma_f32_16x16x32_bf16 v[8:11], v[168:171], v[104:107], v[8:11]
    v_mfma_f32_16x16x32_bf16 v[12:15], v[172:175], v[20:23], v[12:15]
    s_waitcnt lgkmcnt(5)
    v_mfma_f32_16x16x32_bf16 v[8:11], v[172:175], v[108:111], v[8:11]
    v_mfma_f32_16x16x32_bf16 v[12:15], v[176:179], v[20:23], v[12:15]
    s_waitcnt lgkmcnt(4)
    v_mfma_f32_16x16x32_bf16 v[8:11], v[176:179], v[112:115], v[8:11]
    v_mfma_f32_16x16x32_bf16 v[12:15], v[180:183], v[20:23], v[12:15]
    s_waitcnt lgkmcnt(3)
    v_mfma_f32_16x16x32_bf16 v[8:11], v[180:183], v[116:119], v[8:11]
    v_mfma_f32_16x16x32_bf16 v[12:15], v[184:187], v[20:23], v[12:15]
    s_waitcnt lgkmcnt(2)
    v_mfma_f32_16x16x32_bf16 v[8:11], v[184:187], v[120:123], v[8:11]
    v_mfma_f32_16x16x32_bf16 v[12:15], v[188:191], v[20:23], v[12:15]
    s_waitcnt lgkmcnt(1)
    v_mfma_f32_16x16x32_bf16 v[8:11], v[188:191], v[124:127], v[8:11]
    v_lshl_add_u32 v46, v213, 9, v46
    v_lshl_add_u32 v47, v43, 2, v6
    s_mov_b32 s46, 0x2000000
L_lp_39:
    ds_read_b32 v5, v6 offset:4
    s_waitcnt lgkmcnt(0)
    v_readfirstlane_b32 s73, v5
    s_cmp_ge_u32 s73, 2
    s_cbranch_scc1 L_lpd_40
    s_sub_u32 s46, s46, 1
    s_cbranch_scc1 L_lpd_40
    s_branch L_lp_39
L_lpd_40:
    ds_read2_b32 v[24:25], v47 offset0:32 offset1:48
    s_waitcnt lgkmcnt(0)
    v_fmac_f32 v8, v24, v12
    v_fmac_f32 v9, v24, v13
    v_fmac_f32 v10, v24, v14
    v_fmac_f32 v11, v24, v15
    v_mul_f32 v8, v25, v8
    v_mul_f32 v9, v25, v9
    v_mul_f32 v10, v25, v10
    v_mul_f32 v11, v25, v11
    v_cvt_pk_bf16_f32 v12, v8, v9
    v_cvt_pk_bf16_f32 v13, v10, v11
    buffer_store_dwordx2 v[12:13], v46, s[40:43], s75 offen sc1
    v_mul_f32 v17, v8, v8
    v_fmac_f32 v17, v9, v9
    v_fmac_f32 v17, v10, v10
    v_fmac_f32 v17, v11, v11
    v_mov_b32 v15, v17
    s_nop 1
    v_permlane32_swap_b32 v17, v15
    v_add_f32 v17, v17, v15
    v_mov_b32 v15, v17
    s_nop 1
    v_permlane16_swap_b32 v17, v15
    v_add_f32 v17, v17, v15
    s_nop 1
    v_max_u32_dpp v17, v17, v17 row_ror:1 row_mask:0xf bank_mask:0xf
    s_nop 1
    v_max_u32_dpp v17, v17, v17 row_ror:2 row_mask:0xf bank_mask:0xf
    s_nop 1
    v_max_u32_dpp v17, v17, v17 row_ror:4 row_mask:0xf bank_mask:0xf
    s_nop 1
    v_max_u32_dpp v17, v17, v17 row_ror:8 row_mask:0xf bank_mask:0xf
    s_branch L_w7_pub
L_w7_v:
    v_mfma_f32_16x16x32_bf16 v[12:15], v[20:23], v[128:131], 0
    v_mfma_f32_16x16x32_bf16 v[8:11], v[64:67], v[128:131], 0
    v_mfma_f32_16x16x32_bf16 v[12:15], v[20:23], v[132:135], v[12:15]
    v_mfma_f32_16x16x32_bf16 v[8:11], v[68:71], v[132:135], v[8:11]
    v_mfma_f32_16x16x32_bf16 v[12:15], v[20:23], v[136:139], v[12:15]
    v_mfma_f32_16x16x32_bf16 v[8:11], v[72:75], v[136:139], v[8:11]
    v_mfma_f32_16x16x32_bf16 v[12:15], v[20:23], v[140:143], v[12:15]
    v_mfma_f32_16x16x32_bf16 v[8:11], v[76:79], v[140:143], v[8:11]
    v_mfma_f32_16x16x32_bf16 v[12:15], v[20:23], v[144:147], v[12:15]
    v_mfma_f32_16x16x32_bf16 v[8:11], v[80:83], v[144:147], v[8:11]
    v_mfma_f32_16x16x32_bf16 v[12:15], v[20:23], v[148:151], v[12:15]
    v_mfma_f32_16x16x32_bf16 v[8:11], v[84:87], v[148:151], v[8:11]
    v_mfma_f32_16x16x32_bf16 v[12:15], v[20:23], v[152:155], v[12:15]
    v_mfma_f32_16x16x32_bf16 v[8:11], v[88:91], v[152:155], v[8:11]
    v_mfma_f32_16x16x32_bf16 v[12:15], v[20:23], v[156:159], v[12:15]
    v_mfma_f32_16x16x32_bf16 v[8:11], v[92:95], v[156:159], v[8:11]
    v_mfma_f32_16x16x32_bf16 v[12:15], v[20:23], v[160:163], v[12:15]
    s_waitcnt lgkmcnt(8)
    v_mfma_f32_16x16x32_bf16 v[8:11], v[96:99], v[160:163], v[8:11]
    v_mfma_f32_16x16x32_bf16 v[12:15], v[20:23], v[164:167], v[12:15]
    s_waitcnt lgkmcnt(7)
    v_mfma_f32_16x16x32_bf16 v[8:11], v[100:103], v[164:167], v[8:11]
    v_mfma_f32_16x16x32_bf16 v[12:15], v[20:23], v[168:171], v[12:15]
    s_waitcnt lgkmcnt(6)
    v_mfma_f32_16x16x32_bf16 v[8:11], v[104:107], v[168:171], v[8:11]
    v_mfma_f32_16x16x32_bf16 v[12:15], v[20:23], v[172:175], v[12:15]
    s_waitcnt lgkmcnt(5)
    v_mfma_f32_16x16x32_bf16 v[8:11], v[108:111], v[172:175], v[8:11]
    v_mfma_f32_16x16x32_bf16 v[12:15], v[20:23], v[176:179], v[12:15]
    s_waitcnt lgkmcnt(4)
    v_mfma_f32_16x16x32_bf16 v[8:11], v[112:115], v[176:179], v[8:11]
    v_mfma_f32_16x16x32_bf16 v[12:15], v[20:23], v[180:183], v[12:15]
    s_waitcnt lgkmcnt(3)
    v_mfma_f32_16x16x32_bf16 v[8:11], v[116:119], v[180:183], v[8:11]
    v_mfma_f32_16x16x32_bf16 v[12:15], v[20:23], v[184:187], v[12:15]
    s_waitcnt lgkmcnt(2)
    v_mfma_f32_16x16x32_bf16 v[8:11], v[120:123], v[184:187], v[8:11]
    v_mfma_f32_16x16x32_bf16 v[12:15], v[20:23], v[188:191], v[12:15]
    s_waitcnt lgkmcnt(1)
    v_mfma_f32_16x16x32_bf16 v[8:11], v[124:127], v[188:191], v[8:11]
    v_lshlrev_b32 v46, 4, v43
    v_lshl_add_u32 v46, v212, 8, v46
    v_lshl_add_u32 v46, v213, 3, v46
    s_add_u32 s75, s75, s74
    s_add_u32 s75, s75, 1024
    v_lshl_add_u32 v47, v42, 4, v6
    s_mov_b32 s46, 0x2000000
L_lp_41:
    ds_read_b32 v5, v6 offset:4
    s_waitcnt lgkmcnt(0)
    v_readfirstlane_b32 s73, v5
    s_cmp_ge_u32 s73, 2
    s_cbranch_scc1 L_lpd_42
    s_sub_u32 s46, s46, 1
    s_cbranch_scc1 L_lpd_42
    s_branch L_lp_41
L_lpd_42:
    ds_read_b128 v[24:27], v47 offset:128
    ds_read_b128 v[32:35], v47 offset:192
    s_waitcnt lgkmcnt(0)
    v_fmac_f32 v8, v24, v12
    v_fmac_f32 v9, v25, v13
    v_fmac_f32 v10, v26, v14
    v_fmac_f32 v11, v27, v15
    v_mul_f32 v8, v32, v8
    v_mul_f32 v9, v33, v9
    v_mul_f32 v10, v34, v10
    v_mul_f32 v11, v35, v11
    v_cvt_pk_bf16_f32 v12, v8, v9
    v_cvt_pk_bf16_f32 v13, v10, v11
    buffer_store_dwordx2 v[12:13], v46, s[40:43], s75 offen sc1
    v_mov_b32 v17, 0
L_w7_pub:
    s_mov_b64 exec, 1
    s_waitcnt vmcnt(0)
    buffer_store_dwordx2 v[16:17], v18, s[40:43], s77 offen sc1
    s_mov_b64 exec, -1
    s_mov_b32 s74, 0x38000
    s_bfe_u32 s75, s2, 0x40003
    s_lshl_b32 s75, s75, 7
    s_sleep 26
    s_mov_b32 s46, 0x200000
L_kv_43:
    buffer_load_dwordx4 v[32:35], v19, s[40:43], s74 offen sc1
    buffer_load_dwordx4 v[36:39], v19, s[40:43], s74 offen offset:2048 sc1
    s_waitcnt vmcnt(0)
    v_xor_b32 v32, v16, v32
    v_xor_b32 v34, v16, v34
    v_xor_b32 v36, v16, v36
    v_xor_b32 v38, v16, v38
    v_or3_b32 v32, v32, v34, v36
    v_or_b32 v32, v32, v38
    v_cmp_ne_u32 vcc, 0, v32
    v_max_u32 v30, v33, v37
    s_cbranch_vccz L_kvd_44
    s_sub_u32 s46, s46, 1
    s_cbranch_scc1 L_kvd_44
    s_sleep 1
    s_branch L_kv_43
L_kvd_44:
    s_mov_b64 exec, 1
    ds_add_u32 v6, v7 offset:16
    s_mov_b64 exec, -1
    s_mov_b32 s77, 0
    s_mov_b32 s74, 152576
    s_mov_b32 m0, s74
    s_add_u32 s74, s74, 2080
    buffer_load_dwordx4 v221, s[40:43], s77 offen offset:0 sc1 lds
    buffer_load_dwordx4 v221, s[40:43], s77 offen offset:1024 sc1 lds
    s_add_u32 s77, s77, 2048
    s_mov_b32 m0, s74
    s_add_u32 s74, s74, 2080
    buffer_load_dwordx4 v221, s[40:43], s77 offen offset:0 sc1 lds
    buffer_load_dwordx4 v221, s[40:43], s77 offen offset:1024 sc1 lds
    s_add_u32 s77, s77, 2048
    s_mov_b32 m0, s74
    s_add_u32 s74, s74, 2080
    buffer_load_dwordx4 v221, s[40:43], s77 offen offset:0 sc1 lds
    buffer_load_dwordx4 v221, s[40:43], s77 offen offset:1024 sc1 lds
    s_add_u32 s77, s77, 2048
    s_mov_b32 m0, s74
    s_add_u32 s74, s74, 2080
    buffer_load_dwordx4 v221, s[40:43], s77 offen offset:0 sc1 lds
    buffer_load_dwordx4 v221, s[40:43], s77 offen offset:1024 sc1 lds
    s_add_u32 s77, s77, 2048
    s_mov_b32 m0, s74
    s_add_u32 s74, s74, 2080
    buffer_load_dwordx4 v221, s[40:43], s77 offen offset:0 sc1 lds
    buffer_load_dwordx4 v221, s[40:43], s77 offen offset:1024 sc1 lds
    s_add_u32 s77, s77, 2048
    buffer_load_dword v106, v31, s[40:43], s75 offen sc1
    s_nop 1
    v_max_u32_dpp v30, v30, v30 row_ror:1 row_mask:0xf bank_mask:0xf
    s_nop 1
    v_max_u32_dpp v30, v30, v30 row_ror:2 row_mask:0xf bank_mask:0xf
    s_nop 1
    v_max_u32_dpp v30, v30, v30 row_ror:4 row_mask:0xf bank_mask:0xf
    s_nop 1
    v_max_u32_dpp v30, v30, v30 row_ror:8 row_mask:0xf bank_mask:0xf
    v_mov_b32 v29, v30
    s_nop 1
    v_permlane16_swap_b32 v29, v30
    v_max_u32 v30, v29, v30
    v_mov_b32 v29, v30
    s_nop 1
    v_permlane32_swap_b32 v29, v30
    v_max_u32 v30, v29, v30
    ds_write_b32 v6, v30 offset:20
    s_mov_b64 exec, 1
    ds_add_u32 v6, v7 offset:16
    s_mov_b64 exec, -1
    s_mov_b32 s74, 0
    s_mov_b32 s46, 0x2000000
L_lp_45:
    ds_read_b32 v5, v6 offset:12
    s_waitcnt lgkmcnt(0)
    v_readfirstlane_b32 s73, v5
    s_cmp_ge_u32 s73, 4
    s_cbranch_scc1 L_lpd_46
    s_sub_u32 s46, s46, 1
    s_cbranch_scc1 L_lpd_46
    s_branch L_lp_45
L_lpd_46:
    ds_write_b128 v224, v[228:231] offset:2048
    s_mov_b32 m0, s74
    s_add_u32 s74, s74, 2080
    buffer_load_dwordx4 v221, s[40:43], s77 offen offset:0 sc1 lds
    buffer_load_dwordx4 v221, s[40:43], s77 offen offset:1024 sc1 lds
    s_add_u32 s77, s77, 2048
    s_mov_b32 m0, s74
    s_add_u32 s74, s74, 2080
    buffer_load_dwordx4 v221, s[40:43], s77 offen offset:0 sc1 lds
    buffer_load_dwordx4 v221, s[40:43], s77 offen offset:1024 sc1 lds
    s_add_u32 s77, s77, 2048
    s_mov_b32 m0, s74
    s_add_u32 s74, s74, 2080
    buffer_load_dwordx4 v221, s[40:43], s77 offen offset:0 sc1 lds
    buffer_load_dwordx4 v221, s[40:43], s77 offen offset:1024 sc1 lds
    s_add_u32 s77, s77, 2048
    s_mov_b32 m0, s74
    s_add_u32 s74, s74, 2080
    buffer_load_dwordx4 v221, s[40:43], s77 offen offset:0 sc1 lds
    buffer_load_dwordx4 v221, s[40:43], s77 offen offset:1024 sc1 lds
    s_add_u32 s77, s77, 2048
    s_mov_b32 m0, s74
    s_add_u32 s74, s74, 2080
    buffer_load_dwordx4 v221, s[40:43], s77 offen offset:0 sc1 lds
    buffer_load_dwordx4 v221, s[40:43], s77 offen offset:1024 sc1 lds
    s_add_u32 s77, s77, 2048
    s_mov_b32 m0, s74
    s_add_u32 s74, s74, 2080
    buffer_load_dwordx4 v221, s[40:43], s77 offen offset:0 sc1 lds
    buffer_load_dwordx4 v221, s[40:43], s77 offen offset:1024 sc1 lds
    s_add_u32 s77, s77, 2048
    s_mov_b32 m0, s74
    s_add_u32 s74, s74, 2080
    buffer_load_dwordx4 v221, s[40:43], s77 offen offset:0 sc1 lds
    buffer_load_dwordx4 v221, s[40:43], s77 offen offset:1024 sc1 lds
    s_add_u32 s77, s77, 2048
    s_mov_b32 m0, s74
    s_add_u32 s74, s74, 2080
    buffer_load_dwordx4 v221, s[40:43], s77 offen offset:0 sc1 lds
    buffer_load_dwordx4 v221, s[40:43], s77 offen offset:1024 sc1 lds
    s_add_u32 s77, s77, 2048
    s_waitcnt vmcnt(17)
    s_mov_b64 exec, 1
    ds_add_u32 v6, v7 offset:116
    s_mov_b64 exec, -1
    s_setprio 0
    s_waitcnt vmcnt(0)
    s_mov_b64 exec, 1
    ds_add_u32 v6, v7 offset:28
    s_mov_b64 exec, -1
    s_mov_b32 m0, s74
    s_add_u32 s74, s74, 2080
    buffer_load_dwordx4 v221, s[40:43], s77 offen offset:0 sc1 lds
    buffer_load_dwordx4 v221, s[40:43], s77 offen offset:1024 sc1 lds
    s_add_u32 s77, s77, 2048
    s_mov_b32 m0, s74
    s_add_u32 s74, s74, 2080
    buffer_load_dwordx4 v221, s[40:43], s77 offen offset:0 sc1 lds
    buffer_load_dwordx4 v221, s[40:43], s77 offen offset:1024 sc1 lds
    s_add_u32 s77, s77, 2048
    s_mov_b32 m0, s74
    s_add_u32 s74, s74, 2080
    buffer_load_dwordx4 v221, s[40:43], s77 offen offset:0 sc1 lds
    buffer_load_dwordx4 v221, s[40:43], s77 offen offset:1024 sc1 lds
    s_add_u32 s77, s77, 2048
    s_mov_b32 m0, s74
    s_add_u32 s74, s74, 2080
    buffer_load_dwordx4 v221, s[40:43], s77 offen offset:0 sc1 lds
    buffer_load_dwordx4 v221, s[40:43], s77 offen offset:1024 sc1 lds
    s_add_u32 s77, s77, 2048
    s_mov_b32 m0, s74
    s_add_u32 s74, s74, 2080
    buffer_load_dwordx4 v221, s[40:43], s77 offen offset:0 sc1 lds
    buffer_load_dwordx4 v221, s[40:43], s77 offen offset:1024 sc1 lds
    s_add_u32 s77, s77, 2048
    s_mov_b32 m0, s74
    s_add_u32 s74, s74, 2080
    buffer_load_dwordx4 v221, s[40:43], s77 offen offset:0 sc1 lds
    buffer_load_dwordx4 v221, s[40:43], s77 offen offset:1024 sc1 lds
    s_add_u32 s77, s77, 2048
    s_mov_b32 m0, s74
    s_add_u32 s74, s74, 2080
    buffer_load_dwordx4 v221, s[40:43], s77 offen offset:0 sc1 lds
    buffer_load_dwordx4 v221, s[40:43], s77 offen offset:1024 sc1 lds
    s_add_u32 s77, s77, 2048
    s_mov_b32 m0, s74
    s_add_u32 s74, s74, 2080
    buffer_load_dwordx4 v221, s[40:43], s77 offen offset:0 sc1 lds
    buffer_load_dwordx4 v221, s[40:43], s77 offen offset:1024 sc1 lds
    s_add_u32 s77, s77, 2048
    s_mov_b32 m0, s74
    s_add_u32 s74, s74, 2080
    buffer_load_dwordx4 v221, s[40:43], s77 offen offset:0 sc1 lds
    buffer_load_dwordx4 v221, s[40:43], s77 offen offset:1024 sc1 lds
    s_add_u32 s77, s77, 2048
    s_mov_b32 m0, s74
    s_add_u32 s74, s74, 2080
    buffer_load_dwordx4 v221, s[40:43], s77 offen offset:0 sc1 lds
    buffer_load_dwordx4 v221, s[40:43], s77 offen offset:1024 sc1 lds
    s_add_u32 s77, s77, 2048
    s_mov_b32 m0, s74
    s_add_u32 s74, s74, 2080
    buffer_load_dwordx4 v221, s[40:43], s77 offen offset:0 sc1 lds
    buffer_load_dwordx4 v221, s[40:43], s77 offen offset:1024 sc1 lds
    s_add_u32 s77, s77, 2048
    s_mov_b32 m0, s74
    s_add_u32 s74, s74, 2080
    buffer_load_dwordx4 v221, s[40:43], s77 offen offset:0 sc1 lds
    buffer_load_dwordx4 v221, s[40:43], s77 offen offset:1024 sc1 lds
    s_add_u32 s77, s77, 2048
    s_mov_b32 m0, s74
    s_add_u32 s74, s74, 2080
    buffer_load_dwordx4 v221, s[40:43], s77 offen offset:0 sc1 lds
    buffer_load_dwordx4 v221, s[40:43], s77 offen offset:1024 sc1 lds
    s_add_u32 s77, s77, 2048
    s_mov_b32 m0, s74
    s_add_u32 s74, s74, 2080
    buffer_load_dwordx4 v221, s[40:43], s77 offen offset:0 sc1 lds
    buffer_load_dwordx4 v221, s[40:43], s77 offen offset:1024 sc1 lds
    s_add_u32 s77, s77, 2048
    s_mov_b32 m0, s74
    s_add_u32 s74, s74, 2080
    buffer_load_dwordx4 v221, s[40:43], s77 offen offset:0 sc1 lds
    buffer_load_dwordx4 v221, s[40:43], s77 offen offset:1024 sc1 lds
    s_add_u32 s77, s77, 2048
    s_mov_b32 m0, s74
    s_add_u32 s74, s74, 2080
    buffer_load_dwordx4 v221, s[40:43], s77 offen offset:0 sc1 lds
    buffer_load_dwordx4 v221, s[40:43], s77 offen offset:1024 sc1 lds
    s_add_u32 s77, s77, 2048
    s_waitcnt vmcnt(16)
    s_mov_b64 exec, 1
    ds_add_u32 v6, v7 offset:28
    s_mov_b64 exec, -1
    s_mov_b32 m0, s74
    s_add_u32 s74, s74, 2080
    buffer_load_dwordx4 v221, s[40:43], s77 offen offset:0 sc1 lds
    buffer_load_dwordx4 v221, s[40:43], s77 offen offset:1024 sc1 lds
    s_add_u32 s77, s77, 2048
    s_mov_b32 m0, s74
    s_add_u32 s74, s74, 2080
    buffer_load_dwordx4 v221, s[40:43], s77 offen offset:0 sc1 lds
    buffer_load_dwordx4 v221, s[40:43], s77 offen offset:1024 sc1 lds
    s_add_u32 s77, s77, 2048
    s_mov_b32 m0, s74
    s_add_u32 s74, s74, 2080
    buffer_load_dwordx4 v221, s[40:43], s77 offen offset:0 sc1 lds
    buffer_load_dwordx4 v221, s[40:43], s77 offen offset:1024 sc1 lds
    s_add_u32 s77, s77, 2048
    s_mov_b32 m0, s74
    s_add_u32 s74, s74, 2080
    buffer_load_dwordx4 v221, s[40:43], s77 offen offset:0 sc1 lds
    buffer_load_dwordx4 v221, s[40:43], s77 offen offset:1024 sc1 lds
    s_add_u32 s77, s77, 2048
    s_mov_b32 m0, s74
    s_add_u32 s74, s74, 2080
    buffer_load_dwordx4 v221, s[40:43], s77 offen offset:0 sc1 lds
    buffer_load_dwordx4 v221, s[40:43], s77 offen offset:1024 sc1 lds
    s_add_u32 s77, s77, 2048
    s_mov_b32 m0, s74
    s_add_u32 s74, s74, 2080
    buffer_load_dwordx4 v221, s[40:43], s77 offen offset:0 sc1 lds
    buffer_load_dwordx4 v221, s[40:43], s77 offen offset:1024 sc1 lds
    s_add_u32 s77, s77, 2048
    s_mov_b32 m0, s74
    s_add_u32 s74, s74, 2080
    buffer_load_dwordx4 v221, s[40:43], s77 offen offset:0 sc1 lds
    buffer_load_dwordx4 v221, s[40:43], s77 offen offset:1024 sc1 lds
    s_add_u32 s77, s77, 2048
    s_mov_b32 m0, s74
    s_add_u32 s74, s74, 2080
    buffer_load_dwordx4 v221, s[40:43], s77 offen offset:0 sc1 lds
    buffer_load_dwordx4 v221, s[40:43], s77 offen offset:1024 sc1 lds
    s_add_u32 s77, s77, 2048
    s_waitcnt vmcnt(16)
    s_mov_b64 exec, 1
    ds_add_u32 v6, v7 offset:28
    s_mov_b64 exec, -1
    s_waitcnt vmcnt(0)
    s_mov_b64 exec, 1
    ds_add_u32 v6, v7 offset:28
    s_mov_b64 exec, -1
    s_mov_b32 s46, 0x2000000
L_lp_47:
    ds_read_b32 v5, v6 offset:88
    s_waitcnt lgkmcnt(0)
    v_readfirstlane_b32 s73, v5
    s_cmp_ge_u32 s73, 4
    s_cbranch_scc1 L_lpd_48
    s_sub_u32 s46, s46, 1
    s_cbranch_scc1 L_lpd_48
    s_sleep 1
    s_branch L_lp_47
L_lpd_48:
    s_cmp_lg_u32 s2, 0
    s_cbranch_scc1 L_ffn
    v_mov_b32 v29, 0x30000
    s_mov_b64 exec, 1
    buffer_store_dword v16, v29, s[40:43], 0 offen sc1
    s_mov_b64 exec, -1
L_ffn:
    s_setprio 3
    s_mul_i32 s76, s72, 448
    s_lshl_b32 s74, s36, 6
    s_add_u32 s76, s76, s74
    s_add_u32 s61, s76, 1835008
    s_and_b32 s74, s71, 7
    s_mul_i32 s73, s74, 229376
    s_add_u32 s76, s76, s73
    s_add_u32 s73, s74, 0
    s_and_b32 s73, s73, 7
    s_mul_i32 s73, s73, 4224
    v_add_u32 v232, s73, v217
    v_add_u32 v233, s73, v218
    s_add_u32 s73, s74, 1
    s_and_b32 s73, s73, 7
    s_mul_i32 s73, s73, 4224
    v_add_u32 v234, s73, v217
    v_add_u32 v235, s73, v218
    s_add_u32 s73, s74, 2
    s_and_b32 s73, s73, 7
    s_mul_i32 s73, s73, 4224
    v_add_u32 v236, s73, v217
    v_add_u32 v237, s73, v218
    s_add_u32 s73, s74, 3
    s_and_b32 s73, s73, 7
    s_mul_i32 s73, s73, 4224
    v_add_u32 v238, s73, v217
    v_add_u32 v239, s73, v218
    s_add_u32 s73, s74, 4
    s_and_b32 s73, s73, 7
    s_mul_i32 s73, s73, 4224
    v_add_u32 v240, s73, v217
    v_add_u32 v241, s73, v218
    s_add_u32 s73, s74, 5
    s_and_b32 s73, s73, 7
    s_mul_i32 s73, s73, 4224
    v_add_u32 v242, s73, v217
    v_add_u32 v243, s73, v218
    s_add_u32 s73, s74, 6
    s_and_b32 s73, s73, 7
    s_mul_i32 s73, s73, 4224
    v_add_u32 v244, s73, v217
    v_add_u32 v245, s73, v218
    s_add_u32 s73, s74, 7
    s_and_b32 s73, s73, 7
    s_mul_i32 s73, s73, 4224
    v_add_u32 v246, s73, v217
    v_add_u32 v247, s73, v218
    s_mul_i32 s38, s45, 458752
    s_lshl_b32 s73, s72, 7
    s_add_u32 s38, s38, s73
    s_and_b32 s73, s71, 7
    s_min_u32 s73, s73, 6
    s_lshl_b32 s73, s73, 16
    s_add_u32 s38, s38, s73
    v_lshrrev_b32 v225, 2, v1
    v_lshlrev_b32 v225, 10, v225
    v_lshl_add_u32 v225, v215, 8, v225
    s_mov_b32 s46, 0x2000000
L_lp_49:
    ds_read_b32 v5, v6 offset:0
    s_waitcnt lgkmcnt(0)
    v_readfirstlane_b32 s73, v5
    s_cmp_ge_u32 s73, 9
    s_cbranch_scc1 L_lpd_50
    s_sub_u32 s46, s46, 1
    s_cbranch_scc1 L_lpd_50
    s_sleep 1
    s_branch L_lp_49
L_lpd_50:
    ds_read_b32 v4, v6 offset:24
    v_mov_b64 v[208:209], -1
    v_mov_b64 v[210:211], -1
    s_waitcnt lgkmcnt(0)
    v_readfirstlane_b32 s7, v4
    s_setprio 0
    s_cmp_eq_u32 s70, 7
    s_cbranch_scc1 L_ffn1_w7
    s_add_u32 m0, s37, 0
    s_nop 0
    buffer_load_dwordx4 v220, s[24:27], s76 offen lds
    s_add_u32 s76, s76, 28672
    s_add_u32 m0, s37, 1024
    s_nop 0
    buffer_load_dwordx4 v220, s[24:27], s76 offen lds
    s_add_u32 s76, s76, 28672
    s_add_u32 m0, s37, 2048
    s_nop 0
    buffer_load_dwordx4 v220, s[24:27], s76 offen lds
    s_add_u32 s76, s76, 28672
    s_add_u32 m0, s37, 3072
    s_nop 0
    buffer_load_dwordx4 v220, s[24:27], s76 offen lds
    s_add_u32 s76, s76, 28672
    s_add_u32 m0, s37, 4096
    s_nop 0
    buffer_load_dwordx4 v220, s[24:27], s76 offen lds
    s_add_u32 s76, s76, 28672
    s_add_u32 m0, s37, 5120
    s_nop 0
    buffer_load_dwordx4 v220, s[24:27], s76 offen lds
    s_add_u32 s76, s76, 28672
    ds_read_b128 v[96:99], v232 offset:0
    ds_read_b128 v[100:103], v233 offset:0
    s_waitcnt vmcnt(4)
    ds_read_b64_tr_b16 v[72:73], v222 offset:0
    ds_read_b64_tr_b16 v[74:75], v222 offset:512
    ds_read_b64_tr_b16 v[76:77], v223 offset:0
    ds_read_b64_tr_b16 v[78:79], v223 offset:512
    s_waitcnt lgkmcnt(0)
    v_mfma_f32_32x32x16_bf16 v[8:23], v[72:75], v[96:99], 0
    s_add_u32 m0, s37, 0
    s_nop 0
    buffer_load_dwordx4 v220, s[24:27], s76 offen lds
    s_add_u32 s76, s76, 28672
    s_add_u32 m0, s37, 1024
    s_nop 0
    buffer_load_dwordx4 v220, s[24:27], s76 offen lds
    s_add_u32 s76, s76, 28672
    s_cmp_ge_u32 s76, s61
    s_cselect_b32 s73, 1835008, 0
    s_sub_u32 s76, s76, s73
    ds_read_b128 v[104:107], v232 offset:1056
    ds_read_b128 v[108:111], v233 offset:1056
    v_mfma_f32_32x32x16_bf16 v[24:39], v[76:79], v[96:99], 0
    s_waitcnt vmcnt(4)
    ds_read_b64_tr_b16 v[80:81], v222 offset:2048
    ds_read_b64_tr_b16 v[82:83], v222 offset:2560
    v_mfma_f32_32x32x16_bf16 v[40:55], v[72:75], v[100:103], 0
    ds_read_b64_tr_b16 v[84:85], v223 offset:2048
    ds_read_b64_tr_b16 v[86:87], v223 offset:2560
    v_mfma_f32_32x32x16_bf16 v[56:71], v[76:79], v[100:103], 0
    s_waitcnt lgkmcnt(0)
    v_mfma_f32_32x32x16_bf16 v[8:23], v[80:83], v[104:107], v[8:23]
    s_add_u32 m0, s37, 2048
    s_nop 0
    buffer_load_dwordx4 v220, s[24:27], s76 offen lds
    s_add_u32 s76, s76, 28672
    s_add_u32 m0, s37, 3072
    s_nop 0
    buffer_load_dwordx4 v220, s[24:27], s76 offen lds
    s_add_u32 s76, s76, 28672
    ds_read_b128 v[112:115], v232 offset:2112
    ds_read_b128 v[116:119], v233 offset:2112
    v_mfma_f32_32x32x16_bf16 v[24:39], v[84:87], v[104:107], v[24:39]
    s_waitcnt vmcnt(4)
    ds_read_b64_tr_b16 v[88:89], v222 offset:4096
    ds_read_b64_tr_b16 v[90:91], v222 offset:4608
    v_mfma_f32_32x32x16_bf16 v[40:55], v[80:83], v[108:111], v[40:55]
    ds_read_b64_tr_b16 v[92:93], v223 offset:4096
    ds_read_b64_tr_b16 v[94:95], v223 offset:4608
    v_mfma_f32_32x32x16_bf16 v[56:71], v[84:87], v[108:111], v[56:71]
    s_waitcnt lgkmcnt(0)
    v_mfma_f32_32x32x16_bf16 v[8:23], v[88:91], v[112:115], v[8:23]
    s_add_u32 m0, s37, 4096
    s_nop 0
    buffer_load_dwordx4 v220, s[24:27], s76 offen lds
    s_add_u32 s76, s76, 28672
    s_add_u32 m0, s37, 5120
    s_nop 0
    buffer_load_dwordx4 v220, s[24:27], s76 offen lds
    s_add_u32 s76, s76, 28672
    ds_read_b128 v[96:99], v232 offset:3168
    ds_read_b128 v[100:103], v233 offset:3168
    v_mfma_f32_32x32x16_bf16 v[24:39], v[92:95], v[112:115], v[24:39]
    s_waitcnt vmcnt(4)
    ds_read_b64_tr_b16 v[72:73], v222 offset:0
    ds_read_b64_tr_b16 v[74:75], v222 offset:512
    v_mfma_f32_32x32x16_bf16 v[40:55], v[88:91], v[116:119], v[40:55]
    ds_read_b64_tr_b16 v[76:77], v223 offset:0
    ds_read_b64_tr_b16 v[78:79], v223 offset:512
    v_mfma_f32_32x32x16_bf16 v[56:71], v[92:95], v[116:119], v[56:71]
    s_waitcnt lgkmcnt(0)
    v_mfma_f32_32x32x16_bf16 v[8:23], v[72:75], v[96:99], v[8:23]
    s_add_u32 m0, s37, 0
    s_nop 0
    buffer_load_dwordx4 v220, s[24:27], s76 offen lds
    s_add_u32 s76, s76, 28672
    s_add_u32 m0, s37, 1024
    s_nop 0
    buffer_load_dwordx4 v220, s[24:27], s76 offen lds
    s_add_u32 s76, s76, 28672
    ds_read_b128 v[104:107], v234 offset:0
    ds_read_b128 v[108:111], v235 offset:0
    v_mfma_f32_32x32x16_bf16 v[24:39], v[76:79], v[96:99], v[24:39]
    s_waitcnt vmcnt(4)
    ds_read_b64_tr_b16 v[80:81], v222 offset:2048
    ds_read_b64_tr_b16 v[82:83], v222 offset:2560
    v_mfma_f32_32x32x16_bf16 v[40:55], v[72:75], v[100:103], v[40:55]
    ds_read_b64_tr_b16 v[84:85], v223 offset:2048
    ds_read_b64_tr_b16 v[86:87], v223 offset:2560
    v_mfma_f32_32x32x16_bf16 v[56:71], v[76:79], v[100:103], v[56:71]
    s_waitcnt lgkmcnt(0)
    v_mfma_f32_32x32x16_bf16 v[8:23], v[80:83], v[104:107], v[8:23]
    s_add_u32 m0, s37, 2048
    s_nop 0
    buffer_load_dwordx4 v220, s[24:27], s76 offen lds
    s_add_u32 s76, s76, 28672
    s_add_u32 m0, s37, 3072
    s_nop 0
    buffer_load_dwordx4 v220, s[24:27], s76 offen lds
    s_add_u32 s76, s76, 28672
    s_cmp_ge_u32 s76, s61
    s_cselect_b32 s73, 1835008, 0
    s_sub_u32 s76, s76, s73
    ds_read_b128 v[112:115], v234 offset:1056
    ds_read_b128 v[116:119], v235 offset:1056
    v_mfma_f32_32x32x16_bf16 v[24:39], v[84:87], v[104:107], v[24:39]
    s_waitcnt vmcnt(4)
    ds_read_b64_tr_b16 v[88:89], v222 offset:4096
    ds_read_b64_tr_b16 v[90:91], v222 offset:4608
    v_mfma_f32_32x32x16_bf16 v[40:55], v[80:83], v[108:111], v[40:55]
    ds_read_b64_tr_b16 v[92:93], v223 offset:4096
    ds_read_b64_tr_b16 v[94:95], v223 offset:4608
    v_mfma_f32_32x32x16_bf16 v[56:71], v[84:87], v[108:111], v[56:71]
    s_waitcnt lgkmcnt(0)
    v_mfma_f32_32x32x16_bf16 v[8:23], v[88:91], v[112:115], v[8:23]
    s_add_u32 m0, s37, 4096
    s_nop 0
    buffer_load_dwordx4 v220, s[24:27], s76 offen lds
    s_add_u32 s76, s76, 28672
    s_add_u32 m0, s37, 5120
    s_nop 0
    buffer_load_dwordx4 v220, s[24:27], s76 offen lds
    s_add_u32 s76, s76, 28672
    ds_read_b128 v[96:99], v234 offset:2112
    ds_read_b128 v[100:103], v235 offset:2112
    v_mfma_f32_32x32x16_bf16 v[24:39], v[92:95], v[112:115], v[24:39]
    s_waitcnt vmcnt(4)
    ds_read_b64_tr_b16 v[72:73], v222 offset:0
    ds_read_b64_tr_b16 v[74:75], v222 offset:512
    v_mfma_f32_32x32x16_bf16 v[40:55], v[88:91], v[116:119], v[40:55]
    ds_read_b64_tr_b16 v[76:77], v223 offset:0
    ds_read_b64_tr_b16 v[78:79], v223 offset:512
    v_mfma_f32_32x32x16_bf16 v[56:71], v[92:95], v[116:119], v[56:71]
    s_waitcnt lgkmcnt(0)
    v_mfma_f32_32x32x16_bf16 v[8:23], v[72:75], v[96:99], v[8:23]
    s_add_u32 m0, s37, 0
    s_nop 0
    buffer_load_dwordx4 v220, s[24:27], s76 offen lds
    s_add_u32 s76, s76, 28672
    s_add_u32 m0, s37, 1024
    s_nop 0
    buffer_load_dwordx4 v220, s[24:27], s76 offen lds
    s_add_u32 s76, s76, 28672
    ds_read_b128 v[104:107], v234 offset:3168
    ds_read_b128 v[108:111], v235 offset:3168
    v_mfma_f32_32x32x16_bf16 v[24:39], v[76:79], v[96:99], v[24:39]
    s_waitcnt vmcnt(4)
    ds_read_b64_tr_b16 v[80:81], v222 offset:2048
    ds_read_b64_tr_b16 v[82:83], v222 offset:2560
    v_mfma_f32_32x32x16_bf16 v[40:55], v[72:75], v[100:103], v[40:55]
    ds_read_b64_tr_b16 v[84:85], v223 offset:2048
    ds_read_b64_tr_b16 v[86:87], v223 offset:2560
    v_mfma_f32_32x32x16_bf16 v[56:71], v[76:79], v[100:103], v[56:71]
    s_waitcnt lgkmcnt(0)
    v_mfma_f32_32x32x16_bf16 v[8:23], v[80:83], v[104:107], v[8:23]
    s_add_u32 m0, s37, 2048
    s_nop 0
    buffer_load_dwordx4 v220, s[24:27], s76 offen lds
    s_add_u32 s76, s76, 28672
    s_add_u32 m0, s37, 3072
    s_nop 0
    buffer_load_dwordx4 v220, s[24:27], s76 offen lds
    s_add_u32 s76, s76, 28672
    ds_read_b128 v[112:115], v236 offset:0
    ds_read_b128 v[116:119], v237 offset:0
    v_mfma_f32_32x32x16_bf16 v[24:39], v[84:87], v[104:107], v[24:39]
    s_waitcnt vmcnt(4)
    ds_read_b64_tr_b16 v[88:89], v222 offset:4096
    ds_read_b64_tr_b16 v[90:91], v222 offset:4608
    v_mfma_f32_32x32x16_bf16 v[40:55], v[80:83], v[108:111], v[40:55]
    ds_read_b64_tr_b16 v[92:93], v223 offset:4096
    ds_read_b64_tr_b16 v[94:95], v223 offset:4608
    v_mfma_f32_32x32x16_bf16 v[56:71], v[84:87], v[108:111], v[56:71]
    s_waitcnt lgkmcnt(0)
    v_mfma_f32_32x32x16_bf16 v[8:23], v[88:91], v[112:115], v[8:23]
    s_add_u32 m0, s37, 4096
    s_nop 0
    buffer_load_dwordx4 v220, s[24:27], s76 offen lds
    s_add_u32 s76, s76, 28672
    s_add_u32 m0, s37, 5120
    s_nop 0
    buffer_load_dwordx4 v220, s[24:27], s76 offen lds
    s_add_u32 s76, s76, 28672
    s_cmp_ge_u32 s76, s61
    s_cselect_b32 s73, 1835008, 0
    s_sub_u32 s76, s76, s73
    ds_read_b128 v[96:99], v236 offset:1056
    ds_read_b128 v[100:103], v237 offset:1056
    v_mfma_f32_32x32x16_bf16 v[24:39], v[92:95], v[112:115], v[24:39]
    s_waitcnt vmcnt(4)
    ds_read_b64_tr_b16 v[72:73], v222 offset:0
    ds_read_b64_tr_b16 v[74:75], v222 offset:512
    v_mfma_f32_32x32x16_bf16 v[40:55], v[88:91], v[116:119], v[40:55]
    ds_read_b64_tr_b16 v[76:77], v223 offset:0
    ds_read_b64_tr_b16 v[78:79], v223 offset:512
    v_mfma_f32_32x32x16_bf16 v[56:71], v[92:95], v[116:119], v[56:71]
    s_waitcnt lgkmcnt(0)
    v_mfma_f32_32x32x16_bf16 v[8:23], v[72:75], v[96:99], v[8:23]
    s_add_u32 m0, s37, 0
    s_nop 0
    buffer_load_dwordx4 v220, s[24:27], s76 offen lds
    s_add_u32 s76, s76, 28672
    s_add_u32 m0, s37, 1024
    s_nop 0
    buffer_load_dwordx4 v220, s[24:27], s76 offen lds
    s_add_u32 s76, s76, 28672
    ds_read_b128 v[104:107], v236 offset:2112
    ds_read_b128 v[108:111], v237 offset:2112
    v_mfma_f32_32x32x16_bf16 v[24:39], v[76:79], v[96:99], v[24:39]
    s_waitcnt vmcnt(4)
    ds_read_b64_tr_b16 v[80:81], v222 offset:2048
    ds_read_b64_tr_b16 v[82:83], v222 offset:2560
    v_mfma_f32_32x32x16_bf16 v[40:55], v[72:75], v[100:103], v[40:55]
    ds_read_b64_tr_b16 v[84:85], v223 offset:2048
    ds_read_b64_tr_b16 v[86:87], v223 offset:2560
    v_mfma_f32_32x32x16_bf16 v[56:71], v[76:79], v[100:103], v[56:71]
    s_waitcnt lgkmcnt(0)
    v_mfma_f32_32x32x16_bf16 v[8:23], v[80:83], v[104:107], v[8:23]
    s_add_u32 m0, s37, 2048
    s_nop 0
    buffer_load_dwordx4 v220, s[24:27], s76 offen lds
    s_add_u32 s76, s76, 28672
    s_add_u32 m0, s37, 3072
    s_nop 0
    buffer_load_dwordx4 v220, s[24:27], s76 offen lds
    s_add_u32 s76, s76, 28672
    ds_read_b128 v[112:115], v236 offset:3168
    ds_read_b128 v[116:119], v237 offset:3168
    v_mfma_f32_32x32x16_bf16 v[24:39], v[84:87], v[104:107], v[24:39]
    s_waitcnt vmcnt(4)
    ds_read_b64_tr_b16 v[88:89], v222 offset:4096
    ds_read_b64_tr_b16 v[90:91], v222 offset:4608
    v_mfma_f32_32x32x16_bf16 v[40:55], v[80:83], v[108:111], v[40:55]
    ds_read_b64_tr_b16 v[92:93], v223 offset:4096
    ds_read_b64_tr_b16 v[94:95], v223 offset:4608
    v_mfma_f32_32x32x16_bf16 v[56:71], v[84:87], v[108:111], v[56:71]
    s_waitcnt lgkmcnt(0)
    v_mfma_f32_32x32x16_bf16 v[8:23], v[88:91], v[112:115], v[8:23]
    s_add_u32 m0, s37, 4096
    s_nop 0
    buffer_load_dwordx4 v220, s[24:27], s76 offen lds
    s_add_u32 s76, s76, 28672
    s_add_u32 m0, s37, 5120
    s_nop 0
    buffer_load_dwordx4 v220, s[24:27], s76 offen lds
    s_add_u32 s76, s76, 28672
    ds_read_b128 v[96:99], v238 offset:0
    ds_read_b128 v[100:103], v239 offset:0
    v_mfma_f32_32x32x16_bf16 v[24:39], v[92:95], v[112:115], v[24:39]
    s_waitcnt vmcnt(4)
    ds_read_b64_tr_b16 v[72:73], v222 offset:0
    ds_read_b64_tr_b16 v[74:75], v222 offset:512
    v_mfma_f32_32x32x16_bf16 v[40:55], v[88:91], v[116:119], v[40:55]
    ds_read_b64_tr_b16 v[76:77], v223 offset:0
    ds_read_b64_tr_b16 v[78:79], v223 offset:512
    v_mfma_f32_32x32x16_bf16 v[56:71], v[92:95], v[116:119], v[56:71]
    s_waitcnt lgkmcnt(0)
    v_mfma_f32_32x32x16_bf16 v[8:23], v[72:75], v[96:99], v[8:23]
    s_add_u32 m0, s37, 0
    s_nop 0
    buffer_load_dwordx4 v220, s[24:27], s76 offen lds
    s_add_u32 s76, s76, 28672
    s_add_u32 m0, s37, 1024
    s_nop 0
    buffer_load_dwordx4 v220, s[24:27], s76 offen lds
    s_add_u32 s76, s76, 28672
    s_cmp_ge_u32 s76, s61
    s_cselect_b32 s73, 1835008, 0
    s_sub_u32 s76, s76, s73
    ds_read_b128 v[104:107], v238 offset:1056
    ds_read_b128 v[108:111], v239 offset:1056
    v_mfma_f32_32x32x16_bf16 v[24:39], v[76:79], v[96:99], v[24:39]
    s_waitcnt vmcnt(4)
    ds_read_b64_tr_b16 v[80:81], v222 offset:2048
    ds_read_b64_tr_b16 v[82:83], v222 offset:2560
    v_mfma_f32_32x32x16_bf16 v[40:55], v[72:75], v[100:103], v[40:55]
    ds_read_b64_tr_b16 v[84:85], v223 offset:2048
    ds_read_b64_tr_b16 v[86:87], v223 offset:2560
    v_mfma_f32_32x32x16_bf16 v[56:71], v[76:79], v[100:103], v[56:71]
    s_waitcnt lgkmcnt(0)
    v_mfma_f32_32x32x16_bf16 v[8:23], v[80:83], v[104:107], v[8:23]
    s_add_u32 m0, s37, 2048
    s_nop 0
    buffer_load_dwordx4 v220, s[24:27], s76 offen lds
    s_add_u32 s76, s76, 28672
    s_add_u32 m0, s37, 3072
    s_nop 0
    buffer_load_dwordx4 v220, s[24:27], s76 offen lds
    s_add_u32 s76, s76, 28672
    ds_read_b128 v[112:115], v238 offset:2112
    ds_read_b128 v[116:119], v239 offset:2112
    v_mfma_f32_32x32x16_bf16 v[24:39], v[84:87], v[104:107], v[24:39]
    s_waitcnt vmcnt(4)
    ds_read_b64_tr_b16 v[88:89], v222 offset:4096
    ds_read_b64_tr_b16 v[90:91], v222 offset:4608
    v_mfma_f32_32x32x16_bf16 v[40:55], v[80:83], v[108:111], v[40:55]
    ds_read_b64_tr_b16 v[92:93], v223 offset:4096
    ds_read_b64_tr_b16 v[94:95], v223 offset:4608
    v_mfma_f32_32x32x16_bf16 v[56:71], v[84:87], v[108:111], v[56:71]
    s_waitcnt lgkmcnt(0)
    v_mfma_f32_32x32x16_bf16 v[8:23], v[88:91], v[112:115], v[8:23]
    s_add_u32 m0, s37, 4096
    s_nop 0
    buffer_load_dwordx4 v220, s[24:27], s76 offen lds
    s_add_u32 s76, s76, 28672
    s_add_u32 m0, s37, 5120
    s_nop 0
    buffer_load_dwordx4 v220, s[24:27], s76 offen lds
    s_add_u32 s76, s76, 28672
    ds_read_b128 v[96:99], v238 offset:3168
    ds_read_b128 v[100:103], v239 offset:3168
    v_mfma_f32_32x32x16_bf16 v[24:39], v[92:95], v[112:115], v[24:39]
    s_waitcnt vmcnt(4)
    ds_read_b64_tr_b16 v[72:73], v222 offset:0
    ds_read_b64_tr_b16 v[74:75], v222 offset:512
    v_mfma_f32_32x32x16_bf16 v[40:55], v[88:91], v[116:119], v[40:55]
    ds_read_b64_tr_b16 v[76:77], v223 offset:0
    ds_read_b64_tr_b16 v[78:79], v223 offset:512
    v_mfma_f32_32x32x16_bf16 v[56:71], v[92:95], v[116:119], v[56:71]
    buffer_store_dwordx4 v[208:211], v221, s[40:43], s6 offen offset:0 sc1
    s_waitcnt lgkmcnt(0)
    v_mfma_f32_32x32x16_bf16 v[8:23], v[72:75], v[96:99], v[8:23]
    s_add_u32 m0, s37, 0
    s_nop 0
    buffer_load_dwordx4 v220, s[24:27], s76 offen lds
    s_add_u32 s76, s76, 28672
    s_add_u32 m0, s37, 1024
    s_nop 0
    buffer_load_dwordx4 v220, s[24:27], s76 offen lds
    s_add_u32 s76, s76, 28672
    ds_read_b128 v[104:107], v240 offset:0
    ds_read_b128 v[108:111], v241 offset:0
    v_mfma_f32_32x32x16_bf16 v[24:39], v[76:79], v[96:99], v[24:39]
    s_waitcnt vmcnt(5)
    ds_read_b64_tr_b16 v[80:81], v222 offset:2048
    ds_read_b64_tr_b16 v[82:83], v222 offset:2560
    v_mfma_f32_32x32x16_bf16 v[40:55], v[72:75], v[100:103], v[40:55]
    ds_read_b64_tr_b16 v[84:85], v223 offset:2048
    ds_read_b64_tr_b16 v[86:87], v223 offset:2560
    v_mfma_f32_32x32x16_bf16 v[56:71], v[76:79], v[100:103], v[56:71]
    s_waitcnt lgkmcnt(0)
    v_mfma_f32_32x32x16_bf16 v[8:23], v[80:83], v[104:107], v[8:23]
    s_add_u32 m0, s37, 2048
    s_nop 0
    buffer_load_dwordx4 v220, s[24:27], s76 offen lds
    s_add_u32 s76, s76, 28672
    s_add_u32 m0, s37, 3072
    s_nop 0
    buffer_load_dwordx4 v220, s[24:27], s76 offen lds
    s_add_u32 s76, s76, 28672
    s_cmp_ge_u32 s76, s61
    s_cselect_b32 s73, 1835008, 0
    s_sub_u32 s76, s76, s73
    ds_read_b128 v[112:115], v240 offset:1056
    ds_read_b128 v[116:119], v241 offset:1056
    v_mfma_f32_32x32x16_bf16 v[24:39], v[84:87], v[104:107], v[24:39]
    s_waitcnt vmcnt(5)
    ds_read_b64_tr_b16 v[88:89], v222 offset:4096
    ds_read_b64_tr_b16 v[90:91], v222 offset:4608
    v_mfma_f32_32x32x16_bf16 v[40:55], v[80:83], v[108:111], v[40:55]
    ds_read_b64_tr_b16 v[92:93], v223 offset:4096
    ds_read_b64_tr_b16 v[94:95], v223 offset:4608
    v_mfma_f32_32x32x16_bf16 v[56:71], v[84:87], v[108:111], v[56:71]
    s_waitcnt lgkmcnt(0)
    v_mfma_f32_32x32x16_bf16 v[8:23], v[88:91], v[112:115], v[8:23]
    s_add_u32 m0, s37, 4096
    s_nop 0
    buffer_load_dwordx4 v220, s[24:27], s76 offen lds
    s_add_u32 s76, s76, 28672
    s_add_u32 m0, s37, 5120
    s_nop 0
    buffer_load_dwordx4 v220, s[24:27], s76 offen lds
    s_add_u32 s76, s76, 28672
    ds_read_b128 v[96:99], v240 offset:2112
    ds_read_b128 v[100:103], v241 offset:2112
    v_mfma_f32_32x32x16_bf16 v[24:39], v[92:95], v[112:115], v[24:39]
    s_waitcnt vmcnt(4)
    ds_read_b64_tr_b16 v[72:73], v222 offset:0
    ds_read_b64_tr_b16 v[74:75], v222 offset:512
    v_mfma_f32_32x32x16_bf16 v[40:55], v[88:91], v[116:119], v[40:55]
    ds_read_b64_tr_b16 v[76:77], v223 offset:0
    ds_read_b64_tr_b16 v[78:79], v223 offset:512
    v_mfma_f32_32x32x16_bf16 v[56:71], v[92:95], v[116:119], v[56:71]
    s_waitcnt lgkmcnt(0)
    v_mfma_f32_32x32x16_bf16 v[8:23], v[72:75], v[96:99], v[8:23]
    s_add_u32 m0, s37, 0
    s_nop 0
    buffer_load_dwordx4 v220, s[24:27], s76 offen lds
    s_add_u32 s76, s76, 28672
    s_add_u32 m0, s37, 1024
    s_nop 0
    buffer_load_dwordx4 v220, s[24:27], s76 offen lds
    s_add_u32 s76, s76, 28672
    ds_read_b128 v[104:107], v240 offset:3168
    ds_read_b128 v[108:111], v241 offset:3168
    v_mfma_f32_32x32x16_bf16 v[24:39], v[76:79], v[96:99], v[24:39]
    s_waitcnt vmcnt(4)
    ds_read_b64_tr_b16 v[80:81], v222 offset:2048
    ds_read_b64_tr_b16 v[82:83], v222 offset:2560
    v_mfma_f32_32x32x16_bf16 v[40:55], v[72:75], v[100:103], v[40:55]
    ds_read_b64_tr_b16 v[84:85], v223 offset:2048
    ds_read_b64_tr_b16 v[86:87], v223 offset:2560
    v_mfma_f32_32x32x16_bf16 v[56:71], v[76:79], v[100:103], v[56:71]
    s_waitcnt lgkmcnt(0)
    v_mfma_f32_32x32x16_bf16 v[8:23], v[80:83], v[104:107], v[8:23]
    s_add_u32 m0, s37, 2048
    s_nop 0
    buffer_load_dwordx4 v220, s[24:27], s76 offen lds
    s_add_u32 s76, s76, 28672
    s_add_u32 m0, s37, 3072
    s_nop 0
    buffer_load_dwordx4 v220, s[24:27], s76 offen lds
    s_add_u32 s76, s76, 28672
    ds_read_b128 v[112:115], v242 offset:0
    ds_read_b128 v[116:119], v243 offset:0
    v_mfma_f32_32x32x16_bf16 v[24:39], v[84:87], v[104:107], v[24:39]
    s_waitcnt vmcnt(4)
    ds_read_b64_tr_b16 v[88:89], v222 offset:4096
    ds_read_b64_tr_b16 v[90:91], v222 offset:4608
    v_mfma_f32_32x32x16_bf16 v[40:55], v[80:83], v[108:111], v[40:55]
    ds_read_b64_tr_b16 v[92:93], v223 offset:4096
    ds_read_b64_tr_b16 v[94:95], v223 offset:4608
    v_mfma_f32_32x32x16_bf16 v[56:71], v[84:87], v[108:111], v[56:71]
    s_waitcnt lgkmcnt(0)
    v_mfma_f32_32x32x16_bf16 v[8:23], v[88:91], v[112:115], v[8:23]
    s_add_u32 m0, s37, 4096
    s_nop 0
    buffer_load_dwordx4 v220, s[24:27], s76 offen lds
    s_add_u32 s76, s76, 28672
    s_add_u32 m0, s37, 5120
    s_nop 0
    buffer_load_dwordx4 v220, s[24:27], s76 offen lds
    s_add_u32 s76, s76, 28672
    s_cmp_ge_u32 s76, s61
    s_cselect_b32 s73, 1835008, 0
    s_sub_u32 s76, s76, s73
    ds_read_b128 v[96:99], v242 offset:1056
    ds_read_b128 v[100:103], v243 offset:1056
    v_mfma_f32_32x32x16_bf16 v[24:39], v[92:95], v[112:115], v[24:39]
    s_waitcnt vmcnt(4)
    ds_read_b64_tr_b16 v[72:73], v222 offset:0
    ds_read_b64_tr_b16 v[74:75], v222 offset:512
    v_mfma_f32_32x32x16_bf16 v[40:55], v[88:91], v[116:119], v[40:55]
    ds_read_b64_tr_b16 v[76:77], v223 offset:0
    ds_read_b64_tr_b16 v[78:79], v223 offset:512
    v_mfma_f32_32x32x16_bf16 v[56:71], v[92:95], v[116:119], v[56:71]
    buffer_store_dwordx4 v[208:211], v221, s[40:43], s6 offen offset:2048 sc1
    s_waitcnt lgkmcnt(0)
    v_mfma_f32_32x32x16_bf16 v[8:23], v[72:75], v[96:99], v[8:23]
    s_add_u32 m0, s37, 0
    s_nop 0
    buffer_load_dwordx4 v220, s[24:27], s76 offen lds
    s_add_u32 s76, s76, 28672
    s_add_u32 m0, s37, 1024
    s_nop 0
    buffer_load_dwordx4 v220, s[24:27], s76 offen lds
    s_add_u32 s76, s76, 28672
    ds_read_b128 v[104:107], v242 offset:2112
    ds_read_b128 v[108:111], v243 offset:2112
    v_mfma_f32_32x32x16_bf16 v[24:39], v[76:79], v[96:99], v[24:39]
    s_waitcnt vmcnt(5)
    ds_read_b64_tr_b16 v[80:81], v222 offset:2048
    ds_read_b64_tr_b16 v[82:83], v222 offset:2560
    v_mfma_f32_32x32x16_bf16 v[40:55], v[72:75], v[100:103], v[40:55]
    ds_read_b64_tr_b16 v[84:85], v223 offset:2048
    ds_read_b64_tr_b16 v[86:87], v223 offset:2560
    v_mfma_f32_32x32x16_bf16 v[56:71], v[76:79], v[100:103], v[56:71]
    s_waitcnt lgkmcnt(0)
    v_mfma_f32_32x32x16_bf16 v[8:23], v[80:83], v[104:107], v[8:23]
    s_add_u32 m0, s37, 2048
    s_nop 0
    buffer_load_dwordx4 v220, s[24:27], s76 offen lds
    s_add_u32 s76, s76, 28672
    s_add_u32 m0, s37, 3072
    s_nop 0
    buffer_load_dwordx4 v220, s[24:27], s76 offen lds
    s_add_u32 s76, s76, 28672
    ds_read_b128 v[112:115], v242 offset:3168
    ds_read_b128 v[116:119], v243 offset:3168
    v_mfma_f32_32x32x16_bf16 v[24:39], v[84:87], v[104:107], v[24:39]
    s_waitcnt vmcnt(5)
    ds_read_b64_tr_b16 v[88:89], v222 offset:4096
    ds_read_b64_tr_b16 v[90:91], v222 offset:4608
    v_mfma_f32_32x32x16_bf16 v[40:55], v[80:83], v[108:111], v[40:55]
    ds_read_b64_tr_b16 v[92:93], v223 offset:4096
    ds_read_b64_tr_b16 v[94:95], v223 offset:4608
    v_mfma_f32_32x32x16_bf16 v[56:71], v[84:87], v[108:111], v[56:71]
    s_waitcnt lgkmcnt(0)
    v_mfma_f32_32x32x16_bf16 v[8:23], v[88:91], v[112:115], v[8:23]
    s_add_u32 m0, s37, 4096
    s_nop 0
    buffer_load_dwordx4 v220, s[24:27], s76 offen lds
    s_add_u32 s76, s76, 28672
    s_add_u32 m0, s37, 5120
    s_nop 0
    buffer_load_dwordx4 v220, s[24:27], s76 offen lds
    s_add_u32 s76, s76, 28672
    ds_read_b128 v[96:99], v244 offset:0
    ds_read_b128 v[100:103], v245 offset:0
    v_mfma_f32_32x32x16_bf16 v[24:39], v[92:95], v[112:115], v[24:39]
    s_waitcnt vmcnt(4)
    ds_read_b64_tr_b16 v[72:73], v222 offset:0
    ds_read_b64_tr_b16 v[74:75], v222 offset:512
    v_mfma_f32_32x32x16_bf16 v[40:55], v[88:91], v[116:119], v[40:55]
    ds_read_b64_tr_b16 v[76:77], v223 offset:0
    ds_read_b64_tr_b16 v[78:79], v223 offset:512
    v_mfma_f32_32x32x16_bf16 v[56:71], v[92:95], v[116:119], v[56:71]
    s_waitcnt lgkmcnt(0)
    v_mfma_f32_32x32x16_bf16 v[8:23], v[72:75], v[96:99], v[8:23]
    s_add_u32 m0, s37, 0
    s_nop 0
    buffer_load_dwordx4 v220, s[24:27], s76 offen lds
    s_add_u32 s76, s76, 28672
    s_add_u32 m0, s37, 1024
    s_nop 0
    buffer_load_dwordx4 v220, s[24:27], s76 offen lds
    s_add_u32 s76, s76, 28672
    s_cmp_ge_u32 s76, s61
    s_cselect_b32 s73, 1835008, 0
    s_sub_u32 s76, s76, s73
    ds_read_b128 v[104:107], v244 offset:1056
    ds_read_b128 v[108:111], v245 offset:1056
    v_mfma_f32_32x32x16_bf16 v[24:39], v[76:79], v[96:99], v[24:39]
    s_waitcnt vmcnt(4)
    ds_read_b64_tr_b16 v[80:81], v222 offset:2048
    ds_read_b64_tr_b16 v[82:83], v222 offset:2560
    v_mfma_f32_32x32x16_bf16 v[40:55], v[72:75], v[100:103], v[40:55]
    ds_read_b64_tr_b16 v[84:85], v223 offset:2048
    ds_read_b64_tr_b16 v[86:87], v223 offset:2560
    v_mfma_f32_32x32x16_bf16 v[56:71], v[76:79], v[100:103], v[56:71]
    s_waitcnt lgkmcnt(0)
    v_mfma_f32_32x32x16_bf16 v[8:23], v[80:83], v[104:107], v[8:23]
    s_add_u32 m0, s37, 2048
    s_nop 0
    buffer_load_dwordx4 v220, s[24:27], s76 offen lds
    s_add_u32 s76, s76, 28672
    s_add_u32 m0, s37, 3072
    s_nop 0
    buffer_load_dwordx4 v220, s[24:27], s76 offen lds
    s_add_u32 s76, s76, 28672
    ds_read_b128 v[112:115], v244 offset:2112
    ds_read_b128 v[116:119], v245 offset:2112
    v_mfma_f32_32x32x16_bf16 v[24:39], v[84:87], v[104:107], v[24:39]
    s_waitcnt vmcnt(4)
    ds_read_b64_tr_b16 v[88:89], v222 offset:4096
    ds_read_b64_tr_b16 v[90:91], v222 offset:4608
    v_mfma_f32_32x32x16_bf16 v[40:55], v[80:83], v[108:111], v[40:55]
    ds_read_b64_tr_b16 v[92:93], v223 offset:4096
    ds_read_b64_tr_b16 v[94:95], v223 offset:4608
    v_mfma_f32_32x32x16_bf16 v[56:71], v[84:87], v[108:111], v[56:71]
    s_waitcnt lgkmcnt(0)
    v_mfma_f32_32x32x16_bf16 v[8:23], v[88:91], v[112:115], v[8:23]
    s_add_u32 m0, s37, 4096
    s_nop 0
    buffer_load_dwordx4 v220, s[24:27], s76 offen lds
    s_add_u32 s76, s76, 28672
    s_add_u32 m0, s37, 5120
    s_nop 0
    buffer_load_dwordx4 v220, s[24:27], s76 offen lds
    s_add_u32 s76, s76, 28672
    ds_read_b128 v[96:99], v244 offset:3168
    ds_read_b128 v[100:103], v245 offset:3168
    v_mfma_f32_32x32x16_bf16 v[24:39], v[92:95], v[112:115], v[24:39]
    s_waitcnt vmcnt(4)
    ds_read_b64_tr_b16 v[72:73], v222 offset:0
    ds_read_b64_tr_b16 v[74:75], v222 offset:512
    v_mfma_f32_32x32x16_bf16 v[40:55], v[88:91], v[116:119], v[40:55]
    ds_read_b64_tr_b16 v[76:77], v223 offset:0
    ds_read_b64_tr_b16 v[78:79], v223 offset:512
    v_mfma_f32_32x32x16_bf16 v[56:71], v[92:95], v[116:119], v[56:71]
    s_waitcnt lgkmcnt(0)
    v_mfma_f32_32x32x16_bf16 v[8:23], v[72:75], v[96:99], v[8:23]
    s_add_u32 m0, s37, 0
    s_nop 0
    buffer_load_dwordx4 v220, s[24:27], s76 offen lds
    s_add_u32 s76, s76, 28672
    s_add_u32 m0, s37, 1024
    s_nop 0
    buffer_load_dwordx4 v220, s[24:27], s76 offen lds
    s_add_u32 s76, s76, 28672
    ds_read_b128 v[104:107], v246 offset:0
    ds_read_b128 v[108:111], v247 offset:0
    v_mfma_f32_32x32x16_bf16 v[24:39], v[76:79], v[96:99], v[24:39]
    s_waitcnt vmcnt(4)
    ds_read_b64_tr_b16 v[80:81], v222 offset:2048
    ds_read_b64_tr_b16 v[82:83], v222 offset:2560
    v_mfma_f32_32x32x16_bf16 v[40:55], v[72:75], v[100:103], v[40:55]
    ds_read_b64_tr_b16 v[84:85], v223 offset:2048
    ds_read_b64_tr_b16 v[86:87], v223 offset:2560
    v_mfma_f32_32x32x16_bf16 v[56:71], v[76:79], v[100:103], v[56:71]
    s_waitcnt lgkmcnt(0)
    v_mfma_f32_32x32x16_bf16 v[8:23], v[80:83], v[104:107], v[8:23]
    s_add_u32 m0, s37, 2048
    s_nop 0
    buffer_load_dwordx4 v220, s[24:27], s76 offen lds
    s_add_u32 s76, s76, 28672
    s_add_u32 m0, s37, 3072
    s_nop 0
    buffer_load_dwordx4 v220, s[24:27], s76 offen lds
    s_add_u32 s76, s76, 28672
    s_cmp_ge_u32 s76, s61
    s_cselect_b32 s73, 1835008, 0
    s_sub_u32 s76, s76, s73
    ds_read_b128 v[112:115], v246 offset:1056
    ds_read_b128 v[116:119], v247 offset:1056
    v_mfma_f32_32x32x16_bf16 v[24:39], v[84:87], v[104:107], v[24:39]
    s_waitcnt vmcnt(4)
    ds_read_b64_tr_b16 v[88:89], v222 offset:4096
    ds_read_b64_tr_b16 v[90:91], v222 offset:4608
    v_mfma_f32_32x32x16_bf16 v[40:55], v[80:83], v[108:111], v[40:55]
    ds_read_b64_tr_b16 v[92:93], v223 offset:4096
    ds_read_b64_tr_b16 v[94:95], v223 offset:4608
    v_mfma_f32_32x32x16_bf16 v[56:71], v[84:87], v[108:111], v[56:71]
    s_waitcnt lgkmcnt(0)
    v_mfma_f32_32x32x16_bf16 v[8:23], v[88:91], v[112:115], v[8:23]
    ds_read_b128 v[96:99], v246 offset:2112
    ds_read_b128 v[100:103], v247 offset:2112
    v_mfma_f32_32x32x16_bf16 v[24:39], v[92:95], v[112:115], v[24:39]
    s_waitcnt vmcnt(2)
    ds_read_b64_tr_b16 v[72:73], v222 offset:0
    ds_read_b64_tr_b16 v[74:75], v222 offset:512
    v_mfma_f32_32x32x16_bf16 v[40:55], v[88:91], v[116:119], v[40:55]
    ds_read_b64_tr_b16 v[76:77], v223 offset:0
    ds_read_b64_tr_b16 v[78:79], v223 offset:512
    v_mfma_f32_32x32x16_bf16 v[56:71], v[92:95], v[116:119], v[56:71]
    s_waitcnt lgkmcnt(0)
    v_mfma_f32_32x32x16_bf16 v[8:23], v[72:75], v[96:99], v[8:23]
    ds_read_b128 v[104:107], v246 offset:3168
    ds_read_b128 v[108:111], v247 offset:3168
    v_mfma_f32_32x32x16_bf16 v[24:39], v[76:79], v[96:99], v[24:39]
    s_waitcnt vmcnt(0)
    ds_read_b64_tr_b16 v[80:81], v222 offset:2048
    ds_read_b64_tr_b16 v[82:83], v222 offset:2560
    v_mfma_f32_32x32x16_bf16 v[40:55], v[72:75], v[100:103], v[40:55]
    ds_read_b64_tr_b16 v[84:85], v223 offset:2048
    ds_read_b64_tr_b16 v[86:87], v223 offset:2560
    v_mfma_f32_32x32x16_bf16 v[56:71], v[76:79], v[100:103], v[56:71]
    s_waitcnt lgkmcnt(0)
    v_mfma_f32_32x32x16_bf16 v[8:23], v[80:83], v[104:107], v[8:23]
    v_mfma_f32_32x32x16_bf16 v[24:39], v[84:87], v[104:107], v[24:39]
    v_mfma_f32_32x32x16_bf16 v[40:55], v[80:83], v[108:111], v[40:55]
    v_mfma_f32_32x32x16_bf16 v[56:71], v[84:87], v[108:111], v[56:71]
    s_mov_b64 exec, 1
    ds_add_u32 v6, v7 offset:36
    s_mov_b64 exec, -1
    s_setprio 3
    s_mul_i32 s73, s71, 112
    s_mul_i32 s74, s72, 14
    s_add_u32 s73, s73, s74
    s_lshl_b32 s74, s36, 1
    s_add_u32 s73, s73, s74
    s_lshl_b32 s73, s73, 11
    s_add_u32 s76, s73, 4194304
    s_add_u32 s77, s76, 4096
    v_cvt_pk_bf16_f32 v8, v8, v9
    v_cvt_pk_bf16_f32 v9, v10, v11
    v_cvt_pk_bf16_f32 v10, v12, v13
    v_cvt_pk_bf16_f32 v11, v14, v15
    v_cvt_pk_bf16_f32 v12, v16, v17
    v_cvt_pk_bf16_f32 v13, v18, v19
    v_cvt_pk_bf16_f32 v14, v20, v21
    v_cvt_pk_bf16_f32 v15, v22, v23
    v_pk_max_i16 v8, v8, 0
    v_pk_max_i16 v9, v9, 0
    v_pk_max_i16 v10, v10, 0
    v_pk_max_i16 v11, v11, 0
    v_pk_max_i16 v12, v12, 0
    v_pk_max_i16 v13, v13, 0
    v_pk_max_i16 v14, v14, 0
    v_pk_max_i16 v15, v15, 0
    v_cvt_pk_bf16_f32 v40, v40, v41
    v_cvt_pk_bf16_f32 v41, v42, v43
    v_cvt_pk_bf16_f32 v42, v44, v45
    v_cvt_pk_bf16_f32 v43, v46, v47
    v_cvt_pk_bf16_f32 v44, v48, v49
    v_cvt_pk_bf16_f32 v45, v50, v51
    v_cvt_pk_bf16_f32 v46, v52, v53
    v_cvt_pk_bf16_f32 v47, v54, v55
    v_pk_max_i16 v40, v40, 0
    v_pk_max_i16 v41, v41, 0
    v_pk_max_i16 v42, v42, 0
    v_pk_max_i16 v43, v43, 0
    v_pk_max_i16 v44, v44, 0
    v_pk_max_i16 v45, v45, 0
    v_pk_max_i16 v46, v46, 0
    v_pk_max_i16 v47, v47, 0
    v_cvt_pk_bf16_f32 v24, v24, v25
    v_cvt_pk_bf16_f32 v25, v26, v27
    v_cvt_pk_bf16_f32 v26, v28, v29
    v_cvt_pk_bf16_f32 v27, v30, v31
    v_cvt_pk_bf16_f32 v28, v32, v33
    v_cvt_pk_bf16_f32 v29, v34, v35
    v_cvt_pk_bf16_f32 v30, v36, v37
    v_cvt_pk_bf16_f32 v31, v38, v39
    v_pk_max_i16 v24, v24, 0
    v_pk_max_i16 v25, v25, 0
    v_pk_max_i16 v26, v26, 0
    v_pk_max_i16 v27, v27, 0
    v_pk_max_i16 v28, v28, 0
    v_pk_max_i16 v29, v29, 0
    v_pk_max_i16 v30, v30, 0
    v_pk_max_i16 v31, v31, 0
    v_cvt_pk_bf16_f32 v56, v56, v57
    v_cvt_pk_bf16_f32 v57, v58, v59
    v_cvt_pk_bf16_f32 v58, v60, v61
    v_cvt_pk_bf16_f32 v59, v62, v63
    v_cvt_pk_bf16_f32 v60, v64, v65
    v_cvt_pk_bf16_f32 v61, v66, v67
    v_cvt_pk_bf16_f32 v62, v68, v69
    v_cvt_pk_bf16_f32 v63, v70, v71
    v_pk_max_i16 v56, v56, 0
    v_pk_max_i16 v57, v57, 0
    v_pk_max_i16 v58, v58, 0
    v_pk_max_i16 v59, v59, 0
    v_pk_max_i16 v60, v60, 0
    v_pk_max_i16 v61, v61, 0
    v_pk_max_i16 v62, v62, 0
    v_pk_max_i16 v63, v63, 0
    s_setprio 0
    buffer_store_dwordx4 v[8:11], v221, s[40:43], s76 offen offset:0 sc1
    buffer_store_dwordx4 v[12:15], v221, s[40:43], s76 offen offset:2048 sc1
    buffer_store_dwordx4 v[40:43], v221, s[40:43], s76 offen offset:1024 sc1
    buffer_store_dwordx4 v[44:47], v221, s[40:43], s76 offen offset:3072 sc1
    buffer_store_dwordx4 v[24:27], v221, s[40:43], s77 offen offset:0 sc1
    buffer_store_dwordx4 v[28:31], v221, s[40:43], s77 offen offset:2048 sc1
    buffer_store_dwordx4 v[56:59], v221, s[40:43], s77 offen offset:1024 sc1
    buffer_store_dwordx4 v[60:63], v221, s[40:43], s77 offen offset:3072 sc1
    s_mov_b32 s46, 0x2000000
L_lp_51:
    ds_read_b32 v5, v6 offset:80
    s_waitcnt lgkmcnt(0)
    v_readfirstlane_b32 s73, v5
    s_cmp_ge_u32 s73, 4
    s_cbranch_scc1 L_lpd_52
    s_sub_u32 s46, s46, 1
    s_cbranch_scc1 L_lpd_52
    s_sleep 2
    s_branch L_lp_51
L_lpd_52:
    s_lshl_b32 s39, s45, 11
    s_add_u32 s39, s39, 75776
    s_mul_i32 s60, s45, 2080
    s_mov_b32 m0, s60
    s_add_u32 s60, s60, 6240
    buffer_load_dwordx4 v221, s[40:43], s39 offen offset:0 sc1 lds
    buffer_load_dwordx4 v221, s[40:43], s39 offen offset:1024 sc1 lds
    s_add_u32 s39, s39, 6144
    s_mov_b32 m0, s60
    s_add_u32 s60, s60, 6240
    buffer_load_dwordx4 v221, s[40:43], s39 offen offset:0 sc1 lds
    buffer_load_dwordx4 v221, s[40:43], s39 offen offset:1024 sc1 lds
    s_add_u32 s39, s39, 6144
    s_mov_b32 m0, s60
    s_add_u32 s60, s60, 6240
    buffer_load_dwordx4 v221, s[40:43], s39 offen offset:0 sc1 lds
    buffer_load_dwordx4 v221, s[40:43], s39 offen offset:1024 sc1 lds
    s_add_u32 s39, s39, 6144
    s_mov_b32 m0, s60
    s_add_u32 s60, s60, 6240
    buffer_load_dwordx4 v221, s[40:43], s39 offen offset:0 sc1 lds
    buffer_load_dwordx4 v221, s[40:43], s39 offen offset:1024 sc1 lds
    s_add_u32 s39, s39, 6144
    s_mov_b32 m0, s60
    s_add_u32 s60, s60, 6240
    buffer_load_dwordx4 v221, s[40:43], s39 offen offset:0 sc1 lds
    buffer_load_dwordx4 v221, s[40:43], s39 offen offset:1024 sc1 lds
    s_add_u32 s39, s39, 6144
    s_branch L_ffn_join
L_ffn1_w7:
    s_setprio 0
    s_add_u32 m0, s37, 0
    s_nop 0
    buffer_load_dwordx4 v220, s[24:27], s76 offen lds
    s_add_u32 s76, s76, 57344
    s_add_u32 m0, s37, 1024
    s_nop 0
    buffer_load_dwordx4 v220, s[24:27], s76 offen lds
    s_add_u32 s76, s76, 57344
    s_add_u32 m0, s37, 2048
    s_nop 0
    buffer_load_dwordx4 v220, s[24:27], s76 offen lds
    s_add_u32 s76, s76, 57344
    s_add_u32 m0, s37, 3072
    s_nop 0
    buffer_load_dwordx4 v220, s[24:27], s76 offen lds
    s_add_u32 s76, s76, 57344
    s_cmp_ge_u32 s76, s61
    s_cselect_b32 s73, 1835008, 0
    s_sub_u32 s76, s76, s73
    s_add_u32 m0, s37, 4096
    s_nop 0
    buffer_load_dwordx4 v220, s[24:27], s76 offen lds
    s_add_u32 s76, s76, 57344
    s_add_u32 m0, s37, 5120
    s_nop 0
    buffer_load_dwordx4 v220, s[24:27], s76 offen lds
    s_add_u32 s76, s76, 57344
    s_add_u32 m0, s37, 6144
    s_nop 0
    buffer_load_dwordx4 v220, s[24:27], s76 offen lds
    s_add_u32 s76, s76, 57344
    s_add_u32 m0, s37, 7168
    s_nop 0
    buffer_load_dwordx4 v220, s[24:27], s76 offen lds
    s_add_u32 s76, s76, 57344
    s_cmp_ge_u32 s76, s61
    s_cselect_b32 s73, 1835008, 0
    s_sub_u32 s76, s76, s73
    ds_read_b128 v[88:91], v232 offset:0
    ds_read_b128 v[92:95], v233 offset:0
    s_waitcnt vmcnt(7)
    ds_read_b64_tr_b16 v[72:73], v222 offset:0
    ds_read_b64_tr_b16 v[74:75], v222 offset:256
    s_waitcnt lgkmcnt(0)
    s_add_u32 m0, s37, 0
    s_nop 0
    buffer_load_dwordx4 v220, s[24:27], s76 offen lds
    s_add_u32 s76, s76, 57344
    s_waitcnt vmcnt(7)
    v_mfma_f32_32x32x16_bf16 v[8:23], v[72:75], v[88:91], 0
    ds_read_b128 v[96:99], v232 offset:1056
    ds_read_b64_tr_b16 v[80:81], v222 offset:1024
    v_mfma_f32_32x32x16_bf16 v[40:55], v[72:75], v[92:95], 0
    ds_read_b128 v[100:103], v233 offset:1056
    ds_read_b64_tr_b16 v[82:83], v222 offset:1280
    s_waitcnt lgkmcnt(0)
    s_add_u32 m0, s37, 1024
    s_nop 0
    buffer_load_dwordx4 v220, s[24:27], s76 offen lds
    s_add_u32 s76, s76, 57344
    s_waitcnt vmcnt(7)
    v_mfma_f32_32x32x16_bf16 v[8:23], v[80:83], v[96:99], v[8:23]
    ds_read_b128 v[88:91], v232 offset:2112
    ds_read_b64_tr_b16 v[72:73], v222 offset:2048
    v_mfma_f32_32x32x16_bf16 v[40:55], v[80:83], v[100:103], v[40:55]
    ds_read_b128 v[92:95], v233 offset:2112
    ds_read_b64_tr_b16 v[74:75], v222 offset:2304
    s_waitcnt lgkmcnt(0)
    s_add_u32 m0, s37, 2048
    s_nop 0
    buffer_load_dwordx4 v220, s[24:27], s76 offen lds
    s_add_u32 s76, s76, 57344
    s_waitcnt vmcnt(7)
    v_mfma_f32_32x32x16_bf16 v[8:23], v[72:75], v[88:91], v[8:23]
    ds_read_b128 v[96:99], v232 offset:3168
    ds_read_b64_tr_b16 v[80:81], v222 offset:3072
    v_mfma_f32_32x32x16_bf16 v[40:55], v[72:75], v[92:95], v[40:55]
    ds_read_b128 v[100:103], v233 offset:3168
    ds_read_b64_tr_b16 v[82:83], v222 offset:3328
    s_waitcnt lgkmcnt(0)
    s_add_u32 m0, s37, 3072
    s_nop 0
    buffer_load_dwordx4 v220, s[24:27], s76 offen lds
    s_add_u32 s76, s76, 57344
    s_cmp_ge_u32 s76, s61
    s_cselect_b32 s73, 1835008, 0
    s_sub_u32 s76, s76, s73
    s_waitcnt vmcnt(7)
    v_mfma_f32_32x32x16_bf16 v[8:23], v[80:83], v[96:99], v[8:23]
    ds_read_b128 v[88:91], v234 offset:0
    ds_read_b64_tr_b16 v[72:73], v222 offset:4096
    v_mfma_f32_32x32x16_bf16 v[40:55], v[80:83], v[100:103], v[40:55]
    ds_read_b128 v[92:95], v235 offset:0
    ds_read_b64_tr_b16 v[74:75], v222 offset:4352
    s_waitcnt lgkmcnt(0)
    s_add_u32 m0, s37, 4096
    s_nop 0
    buffer_load_dwordx4 v220, s[24:27], s76 offen lds
    s_add_u32 s76, s76, 57344
    s_waitcnt vmcnt(7)
    v_mfma_f32_32x32x16_bf16 v[8:23], v[72:75], v[88:91], v[8:23]
    ds_read_b128 v[96:99], v234 offset:1056
    ds_read_b64_tr_b16 v[80:81], v222 offset:5120
    v_mfma_f32_32x32x16_bf16 v[40:55], v[72:75], v[92:95], v[40:55]
    ds_read_b128 v[100:103], v235 offset:1056
    ds_read_b64_tr_b16 v[82:83], v222 offset:5376
    s_waitcnt lgkmcnt(0)
    s_add_u32 m0, s37, 5120
    s_nop 0
    buffer_load_dwordx4 v220, s[24:27], s76 offen lds
    s_add_u32 s76, s76, 57344
    s_waitcnt vmcnt(7)
    v_mfma_f32_32x32x16_bf16 v[8:23], v[80:83], v[96:99], v[8:23]
    ds_read_b128 v[88:91], v234 offset:2112
    ds_read_b64_tr_b16 v[72:73], v222 offset:6144
    v_mfma_f32_32x32x16_bf16 v[40:55], v[80:83], v[100:103], v[40:55]
    ds_read_b128 v[92:95], v235 offset:2112
    ds_read_b64_tr_b16 v[74:75], v222 offset:6400
    s_waitcnt lgkmcnt(0)
    s_add_u32 m0, s37, 6144
    s_nop 0
    buffer_load_dwordx4 v220, s[24:27], s76 offen lds
    s_add_u32 s76, s76, 57344
    s_waitcnt vmcnt(7)
    v_mfma_f32_32x32x16_bf16 v[8:23], v[72:75], v[88:91], v[8:23]
    ds_read_b128 v[96:99], v234 offset:3168
    ds_read_b64_tr_b16 v[80:81], v222 offset:7168
    v_mfma_f32_32x32x16_bf16 v[40:55], v[72:75], v[92:95], v[40:55]
    ds_read_b128 v[100:103], v235 offset:3168
    ds_read_b64_tr_b16 v[82:83], v222 offset:7424
    s_waitcnt lgkmcnt(0)
    s_add_u32 m0, s37, 7168
    s_nop 0
    buffer_load_dwordx4 v220, s[24:27], s76 offen lds
    s_add_u32 s76, s76, 57344
    s_cmp_ge_u32 s76, s61
    s_cselect_b32 s73, 1835008, 0
    s_sub_u32 s76, s76, s73
    s_waitcnt vmcnt(7)
    v_mfma_f32_32x32x16_bf16 v[8:23], v[80:83], v[96:99], v[8:23]
    ds_read_b128 v[88:91], v236 offset:0
    ds_read_b64_tr_b16 v[72:73], v222 offset:0
    v_mfma_f32_32x32x16_bf16 v[40:55], v[80:83], v[100:103], v[40:55]
    ds_read_b128 v[92:95], v237 offset:0
    ds_read_b64_tr_b16 v[74:75], v222 offset:256
    s_waitcnt lgkmcnt(0)
    s_add_u32 m0, s37, 0
    s_nop 0
    buffer_load_dwordx4 v220, s[24:27], s76 offen lds
    s_add_u32 s76, s76, 57344
    s_waitcnt vmcnt(7)
    v_mfma_f32_32x32x16_bf16 v[8:23], v[72:75], v[88:91], v[8:23]
    ds_read_b128 v[96:99], v236 offset:1056
    ds_read_b64_tr_b16 v[80:81], v222 offset:1024
    v_mfma_f32_32x32x16_bf16 v[40:55], v[72:75], v[92:95], v[40:55]
    ds_read_b128 v[100:103], v237 offset:1056
    ds_read_b64_tr_b16 v[82:83], v222 offset:1280
    s_waitcnt lgkmcnt(0)
    s_add_u32 m0, s37, 1024
    s_nop 0
    buffer_load_dwordx4 v220, s[24:27], s76 offen lds
    s_add_u32 s76, s76, 57344
    s_waitcnt vmcnt(7)
    v_mfma_f32_32x32x16_bf16 v[8:23], v[80:83], v[96:99], v[8:23]
    ds_read_b128 v[88:91], v236 offset:2112
    ds_read_b64_tr_b16 v[72:73], v222 offset:2048
    v_mfma_f32_32x32x16_bf16 v[40:55], v[80:83], v[100:103], v[40:55]
    ds_read_b128 v[92:95], v237 offset:2112
    ds_read_b64_tr_b16 v[74:75], v222 offset:2304
    s_waitcnt lgkmcnt(0)
    s_add_u32 m0, s37, 2048
    s_nop 0
    buffer_load_dwordx4 v220, s[24:27], s76 offen lds
    s_add_u32 s76, s76, 57344
    s_waitcnt vmcnt(7)
    v_mfma_f32_32x32x16_bf16 v[8:23], v[72:75], v[88:91], v[8:23]
    ds_read_b128 v[96:99], v236 offset:3168
    ds_read_b64_tr_b16 v[80:81], v222 offset:3072
    v_mfma_f32_32x32x16_bf16 v[40:55], v[72:75], v[92:95], v[40:55]
    ds_read_b128 v[100:103], v237 offset:3168
    ds_read_b64_tr_b16 v[82:83], v222 offset:3328
    s_waitcnt lgkmcnt(0)
    s_add_u32 m0, s37, 3072
    s_nop 0
    buffer_load_dwordx4 v220, s[24:27], s76 offen lds
    s_add_u32 s76, s76, 57344
    s_cmp_ge_u32 s76, s61
    s_cselect_b32 s73, 1835008, 0
    s_sub_u32 s76, s76, s73
    s_waitcnt vmcnt(7)
    v_mfma_f32_32x32x16_bf16 v[8:23], v[80:83], v[96:99], v[8:23]
    ds_read_b128 v[88:91], v238 offset:0
    ds_read_b64_tr_b16 v[72:73], v222 offset:4096
    v_mfma_f32_32x32x16_bf16 v[40:55], v[80:83], v[100:103], v[40:55]
    ds_read_b128 v[92:95], v239 offset:0
    ds_read_b64_tr_b16 v[74:75], v222 offset:4352
    s_waitcnt lgkmcnt(0)
    s_add_u32 m0, s37, 4096
    s_nop 0
    buffer_load_dwordx4 v220, s[24:27], s76 offen lds
    s_add_u32 s76, s76, 57344
    s_waitcnt vmcnt(7)
    v_mfma_f32_32x32x16_bf16 v[8:23], v[72:75], v[88:91], v[8:23]
    ds_read_b128 v[96:99], v238 offset:1056
    ds_read_b64_tr_b16 v[80:81], v222 offset:5120
    v_mfma_f32_32x32x16_bf16 v[40:55], v[72:75], v[92:95], v[40:55]
    ds_read_b128 v[100:103], v239 offset:1056
    ds_read_b64_tr_b16 v[82:83], v222 offset:5376
    s_waitcnt lgkmcnt(0)
    s_add_u32 m0, s37, 5120
    s_nop 0
    buffer_load_dwordx4 v220, s[24:27], s76 offen lds
    s_add_u32 s76, s76, 57344
    s_waitcnt vmcnt(7)
    v_mfma_f32_32x32x16_bf16 v[8:23], v[80:83], v[96:99], v[8:23]
    ds_read_b128 v[88:91], v238 offset:2112
    ds_read_b64_tr_b16 v[72:73], v222 offset:6144
    v_mfma_f32_32x32x16_bf16 v[40:55], v[80:83], v[100:103], v[40:55]
    ds_read_b128 v[92:95], v239 offset:2112
    ds_read_b64_tr_b16 v[74:75], v222 offset:6400
    s_waitcnt lgkmcnt(0)
    s_add_u32 m0, s37, 6144
    s_nop 0
    buffer_load_dwordx4 v220, s[24:27], s76 offen lds
    s_add_u32 s76, s76, 57344
    s_waitcnt vmcnt(7)
    v_mfma_f32_32x32x16_bf16 v[8:23], v[72:75], v[88:91], v[8:23]
    ds_read_b128 v[96:99], v238 offset:3168
    ds_read_b64_tr_b16 v[80:81], v222 offset:7168
    v_mfma_f32_32x32x16_bf16 v[40:55], v[72:75], v[92:95], v[40:55]
    ds_read_b128 v[100:103], v239 offset:3168
    ds_read_b64_tr_b16 v[82:83], v222 offset:7424
    buffer_store_dwordx4 v[208:211], v221, s[40:43], s6 offen offset:0 sc1
    s_waitcnt lgkmcnt(0)
    s_add_u32 m0, s37, 7168
    s_nop 0
    buffer_load_dwordx4 v220, s[24:27], s76 offen lds
    s_add_u32 s76, s76, 57344
    s_cmp_ge_u32 s76, s61
    s_cselect_b32 s73, 1835008, 0
    s_sub_u32 s76, s76, s73
    s_waitcnt vmcnt(8)
    v_mfma_f32_32x32x16_bf16 v[8:23], v[80:83], v[96:99], v[8:23]
    ds_read_b128 v[88:91], v240 offset:0
    ds_read_b64_tr_b16 v[72:73], v222 offset:0
    v_mfma_f32_32x32x16_bf16 v[40:55], v[80:83], v[100:103], v[40:55]
    ds_read_b128 v[92:95], v241 offset:0
    ds_read_b64_tr_b16 v[74:75], v222 offset:256
    s_waitcnt lgkmcnt(0)
    s_add_u32 m0, s37, 0
    s_nop 0
    buffer_load_dwordx4 v220, s[24:27], s76 offen lds
    s_add_u32 s76, s76, 57344
    s_waitcnt vmcnt(8)
    v_mfma_f32_32x32x16_bf16 v[8:23], v[72:75], v[88:91], v[8:23]
    ds_read_b128 v[96:99], v240 offset:1056
    ds_read_b64_tr_b16 v[80:81], v222 offset:1024
    v_mfma_f32_32x32x16_bf16 v[40:55], v[72:75], v[92:95], v[40:55]
    ds_read_b128 v[100:103], v241 offset:1056
    ds_read_b64_tr_b16 v[82:83], v222 offset:1280
    s_waitcnt lgkmcnt(0)
    s_add_u32 m0, s37, 1024
    s_nop 0
    buffer_load_dwordx4 v220, s[24:27], s76 offen lds
    s_add_u32 s76, s76, 57344
    s_waitcnt vmcnt(8)
    v_mfma_f32_32x32x16_bf16 v[8:23], v[80:83], v[96:99], v[8:23]
    ds_read_b128 v[88:91], v240 offset:2112
    ds_read_b64_tr_b16 v[72:73], v222 offset:2048
    v_mfma_f32_32x32x16_bf16 v[40:55], v[80:83], v[100:103], v[40:55]
    ds_read_b128 v[92:95], v241 offset:2112
    ds_read_b64_tr_b16 v[74:75], v222 offset:2304
    s_waitcnt lgkmcnt(0)
    s_add_u32 m0, s37, 2048
    s_nop 0
    buffer_load_dwordx4 v220, s[24:27], s76 offen lds
    s_add_u32 s76, s76, 57344
    s_waitcnt vmcnt(8)
    v_mfma_f32_32x32x16_bf16 v[8:23], v[72:75], v[88:91], v[8:23]
    ds_read_b128 v[96:99], v240 offset:3168
    ds_read_b64_tr_b16 v[80:81], v222 offset:3072
    v_mfma_f32_32x32x16_bf16 v[40:55], v[72:75], v[92:95], v[40:55]
    ds_read_b128 v[100:103], v241 offset:3168
    ds_read_b64_tr_b16 v[82:83], v222 offset:3328
    s_waitcnt lgkmcnt(0)
    s_add_u32 m0, s37, 3072
    s_nop 0
    buffer_load_dwordx4 v220, s[24:27], s76 offen lds
    s_add_u32 s76, s76, 57344
    s_cmp_ge_u32 s76, s61
    s_cselect_b32 s73, 1835008, 0
    s_sub_u32 s76, s76, s73
    s_waitcnt vmcnt(8)
    v_mfma_f32_32x32x16_bf16 v[8:23], v[80:83], v[96:99], v[8:23]
    ds_read_b128 v[88:91], v242 offset:0
    ds_read_b64_tr_b16 v[72:73], v222 offset:4096
    v_mfma_f32_32x32x16_bf16 v[40:55], v[80:83], v[100:103], v[40:55]
    ds_read_b128 v[92:95], v243 offset:0
    ds_read_b64_tr_b16 v[74:75], v222 offset:4352
    s_waitcnt lgkmcnt(0)
    s_add_u32 m0, s37, 4096
    s_nop 0
    buffer_load_dwordx4 v220, s[24:27], s76 offen lds
    s_add_u32 s76, s76, 57344
    s_waitcnt vmcnt(8)
    v_mfma_f32_32x32x16_bf16 v[8:23], v[72:75], v[88:91], v[8:23]
    ds_read_b128 v[96:99], v242 offset:1056
    ds_read_b64_tr_b16 v[80:81], v222 offset:5120
    v_mfma_f32_32x32x16_bf16 v[40:55], v[72:75], v[92:95], v[40:55]
    ds_read_b128 v[100:103], v243 offset:1056
    ds_read_b64_tr_b16 v[82:83], v222 offset:5376
    buffer_store_dwordx4 v[208:211], v221, s[40:43], s6 offen offset:2048 sc1
    s_waitcnt lgkmcnt(0)
    s_add_u32 m0, s37, 5120
    s_nop 0
    buffer_load_dwordx4 v220, s[24:27], s76 offen lds
    s_add_u32 s76, s76, 57344
    s_waitcnt vmcnt(9)
    v_mfma_f32_32x32x16_bf16 v[8:23], v[80:83], v[96:99], v[8:23]
    ds_read_b128 v[88:91], v242 offset:2112
    ds_read_b64_tr_b16 v[72:73], v222 offset:6144
    v_mfma_f32_32x32x16_bf16 v[40:55], v[80:83], v[100:103], v[40:55]
    ds_read_b128 v[92:95], v243 offset:2112
    ds_read_b64_tr_b16 v[74:75], v222 offset:6400
    s_waitcnt lgkmcnt(0)
    s_add_u32 m0, s37, 6144
    s_nop 0
    buffer_load_dwordx4 v220, s[24:27], s76 offen lds
    s_add_u32 s76, s76, 57344
    s_waitcnt vmcnt(8)
    v_mfma_f32_32x32x16_bf16 v[8:23], v[72:75], v[88:91], v[8:23]
    ds_read_b128 v[96:99], v242 offset:3168
    ds_read_b64_tr_b16 v[80:81], v222 offset:7168
    v_mfma_f32_32x32x16_bf16 v[40:55], v[72:75], v[92:95], v[40:55]
    ds_read_b128 v[100:103], v243 offset:3168
    ds_read_b64_tr_b16 v[82:83], v222 offset:7424
    s_waitcnt lgkmcnt(0)
    s_add_u32 m0, s37, 7168
    s_nop 0
    buffer_load_dwordx4 v220, s[24:27], s76 offen lds
    s_add_u32 s76, s76, 57344
    s_cmp_ge_u32 s76, s61
    s_cselect_b32 s73, 1835008, 0
    s_sub_u32 s76, s76, s73
    s_waitcnt vmcnt(8)
    v_mfma_f32_32x32x16_bf16 v[8:23], v[80:83], v[96:99], v[8:23]
    ds_read_b128 v[88:91], v244 offset:0
    ds_read_b64_tr_b16 v[72:73], v222 offset:0
    v_mfma_f32_32x32x16_bf16 v[40:55], v[80:83], v[100:103], v[40:55]
    ds_read_b128 v[92:95], v245 offset:0
    ds_read_b64_tr_b16 v[74:75], v222 offset:256
    s_waitcnt lgkmcnt(0)
    s_waitcnt vmcnt(7)
    v_mfma_f32_32x32x16_bf16 v[8:23], v[72:75], v[88:91], v[8:23]
    ds_read_b128 v[96:99], v244 offset:1056
    ds_read_b64_tr_b16 v[80:81], v222 offset:1024
    v_mfma_f32_32x32x16_bf16 v[40:55], v[72:75], v[92:95], v[40:55]
    ds_read_b128 v[100:103], v245 offset:1056
    ds_read_b64_tr_b16 v[82:83], v222 offset:1280
    s_waitcnt lgkmcnt(0)
    s_waitcnt vmcnt(6)
    v_mfma_f32_32x32x16_bf16 v[8:23], v[80:83], v[96:99], v[8:23]
    ds_read_b128 v[88:91], v244 offset:2112
    ds_read_b64_tr_b16 v[72:73], v222 offset:2048
    v_mfma_f32_32x32x16_bf16 v[40:55], v[80:83], v[100:103], v[40:55]
    ds_read_b128 v[92:95], v245 offset:2112
    ds_read_b64_tr_b16 v[74:75], v222 offset:2304
    s_waitcnt lgkmcnt(0)
    s_waitcnt vmcnt(5)
    v_mfma_f32_32x32x16_bf16 v[8:23], v[72:75], v[88:91], v[8:23]
    ds_read_b128 v[96:99], v244 offset:3168
    ds_read_b64_tr_b16 v[80:81], v222 offset:3072
    v_mfma_f32_32x32x16_bf16 v[40:55], v[72:75], v[92:95], v[40:55]
    ds_read_b128 v[100:103], v245 offset:3168
    ds_read_b64_tr_b16 v[82:83], v222 offset:3328
    s_waitcnt lgkmcnt(0)
    s_waitcnt vmcnt(4)
    v_mfma_f32_32x32x16_bf16 v[8:23], v[80:83], v[96:99], v[8:23]
    ds_read_b128 v[88:91], v246 offset:0
    ds_read_b64_tr_b16 v[72:73], v222 offset:4096
    v_mfma_f32_32x32x16_bf16 v[40:55], v[80:83], v[100:103], v[40:55]
    ds_read_b128 v[92:95], v247 offset:0
    ds_read_b64_tr_b16 v[74:75], v222 offset:4352
    s_waitcnt lgkmcnt(0)
    s_waitcnt vmcnt(2)
    v_mfma_f32_32x32x16_bf16 v[8:23], v[72:75], v[88:91], v[8:23]
    ds_read_b128 v[96:99], v246 offset:1056
    ds_read_b64_tr_b16 v[80:81], v222 offset:5120
    v_mfma_f32_32x32x16_bf16 v[40:55], v[72:75], v[92:95], v[40:55]
    ds_read_b128 v[100:103], v247 offset:1056
    ds_read_b64_tr_b16 v[82:83], v222 offset:5376
    s_waitcnt lgkmcnt(0)
    s_waitcnt vmcnt(1)
    v_mfma_f32_32x32x16_bf16 v[8:23], v[80:83], v[96:99], v[8:23]
    ds_read_b128 v[88:91], v246 offset:2112
    ds_read_b64_tr_b16 v[72:73], v222 offset:6144
    v_mfma_f32_32x32x16_bf16 v[40:55], v[80:83], v[100:103], v[40:55]
    ds_read_b128 v[92:95], v247 offset:2112
    ds_read_b64_tr_b16 v[74:75], v222 offset:6400
    s_waitcnt lgkmcnt(0)
    s_waitcnt vmcnt(0)
    v_mfma_f32_32x32x16_bf16 v[8:23], v[72:75], v[88:91], v[8:23]
    ds_read_b128 v[96:99], v246 offset:3168
    ds_read_b64_tr_b16 v[80:81], v222 offset:7168
    v_mfma_f32_32x32x16_bf16 v[40:55], v[72:75], v[92:95], v[40:55]
    ds_read_b128 v[100:103], v247 offset:3168
    ds_read_b64_tr_b16 v[82:83], v222 offset:7424
    s_waitcnt lgkmcnt(0)
    v_mfma_f32_32x32x16_bf16 v[8:23], v[80:83], v[96:99], v[8:23]
    v_mfma_f32_32x32x16_bf16 v[40:55], v[80:83], v[100:103], v[40:55]
    s_mov_b64 exec, 1
    ds_add_u32 v6, v7 offset:36
    s_mov_b64 exec, -1
    s_setprio 3
    s_mul_i32 s73, s71, 112
    s_mul_i32 s74, s72, 14
    s_add_u32 s73, s73, s74
    s_lshl_b32 s74, s36, 1
    s_add_u32 s73, s73, s74
    s_lshl_b32 s73, s73, 11
    s_add_u32 s76, s73, 4194304
    s_add_u32 s77, s76, 4096
    v_cvt_pk_bf16_f32 v8, v8, v9
    v_cvt_pk_bf16_f32 v9, v10, v11
    v_cvt_pk_bf16_f32 v10, v12, v13
    v_cvt_pk_bf16_f32 v11, v14, v15
    v_cvt_pk_bf16_f32 v12, v16, v17
    v_cvt_pk_bf16_f32 v13, v18, v19
    v_cvt_pk_bf16_f32 v14, v20, v21
    v_cvt_pk_bf16_f32 v15, v22, v23
    v_pk_max_i16 v8, v8, 0
    v_pk_max_i16 v9, v9, 0
    v_pk_max_i16 v10, v10, 0
    v_pk_max_i16 v11, v11, 0
    v_pk_max_i16 v12, v12, 0
    v_pk_max_i16 v13, v13, 0
    v_pk_max_i16 v14, v14, 0
    v_pk_max_i16 v15, v15, 0
    v_cvt_pk_bf16_f32 v40, v40, v41
    v_cvt_pk_bf16_f32 v41, v42, v43
    v_cvt_pk_bf16_f32 v42, v44, v45
    v_cvt_pk_bf16_f32 v43, v46, v47
    v_cvt_pk_bf16_f32 v44, v48, v49
    v_cvt_pk_bf16_f32 v45, v50, v51
    v_cvt_pk_bf16_f32 v46, v52, v53
    v_cvt_pk_bf16_f32 v47, v54, v55
    v_pk_max_i16 v40, v40, 0
    v_pk_max_i16 v41, v41, 0
    v_pk_max_i16 v42, v42, 0
    v_pk_max_i16 v43, v43, 0
    v_pk_max_i16 v44, v44, 0
    v_pk_max_i16 v45, v45, 0
    v_pk_max_i16 v46, v46, 0
    v_pk_max_i16 v47, v47, 0
    s_setprio 0
    buffer_store_dwordx4 v[8:11], v221, s[40:43], s76 offen offset:0 sc1
    buffer_store_dwordx4 v[12:15], v221, s[40:43], s76 offen offset:2048 sc1
    buffer_store_dwordx4 v[40:43], v221, s[40:43], s76 offen offset:1024 sc1
    buffer_store_dwordx4 v[44:47], v221, s[40:43], s76 offen offset:3072 sc1
L_ffn_join:
    s_setprio 3
    s_lshl_b32 s75, s72, 7
    s_lshl_b32 s74, s45, 2
    s_add_u32 s75, s75, s74
    s_add_u32 s75, s75, s47
    v_mov_b32 v72, 0
    v_mov_b32 v73, s7
    v_add_u32 v224, 66560, v224
    s_lshl_b32 s37, s45, 14
    s_add_u32 s37, s37, 91520
    v_lshl_add_u32 v216, v212, 9, v216
    s_and_b32 s74, s45, 1
    s_lshl_b32 s74, s74, 6
    v_xor_b32 v222, s74, v216
    v_add_u32 v222, s37, v222
    v_xor_b32 v223, 64, v222
    s_lshr_b32 s74, s45, 1
    s_lshl_b32 s74, s74, 10
    v_add_u32 v0, s74, v221
    v_xor_b32 v2, 0x400, v0
    v_bfe_u32 v122, v1, 2, 3
    v_lshlrev_b32 v122, 7, v122
    v_lshl_add_u32 v122, v215, 2, v122
    v_lshlrev_b32 v123, 9, v1
    s_mov_b32 s38, s75
    s_setprio 0
    s_waitcnt vmcnt(0)
    s_mov_b64 exec, 1
    buffer_store_dword v73, v72, s[40:43], s38 offen sc1
    s_mov_b64 exec, -1
    s_mov_b64 exec, 1
    ds_add_u32 v6, v7 offset:84
    s_mov_b64 exec, -1
    s_mul_i32 s76, s45, 458752
    s_lshl_b32 s73, s72, 7
    s_add_u32 s76, s76, s73
    s_mov_b32 s61, s76
    s_cmp_eq_u32 s70, 7
    s_cbranch_scc1 L_no_e1
    s_lshr_b32 s74, s2, 3
    s_and_b32 s75, s72, 1
    s_lshl_b32 s75, s75, 7
    s_cmp_eq_u32 s70, 6
    s_cbranch_scc1 L_t_wo
    s_lshl_b32 s74, s74, 1
    s_add_u32 s74, s74, s45
    s_mul_i32 s74, s74, 28672
    s_add_u32 s74, s74, s75
    buffer_load_dword v124, v225, s[28:31], s74 offen
    s_add_u32 s74, s74, 12288
    buffer_load_dword v124, v225, s[28:31], s74 offen
    s_branch L_no_e1
L_t_wo:
    s_lshl_b32 s74, s74, 14
    s_add_u32 s74, s74, s75
    buffer_load_dword v124, v225, s[20:23], s74 offen
L_no_e1:
    s_mov_b32 s46, 0x2000000
L_lp_53:
    ds_read_b32 v5, v6 offset:36
    s_waitcnt lgkmcnt(0)
    v_readfirstlane_b32 s73, v5
    s_cmp_ge_u32 s73, 4
    s_cbranch_scc1 L_lpd_54
    s_sub_u32 s46, s46, 1
    s_cbranch_scc1 L_lpd_54
    s_sleep 4
    s_branch L_lp_53
L_lpd_54:
    s_lshl_b32 s77, s45, 11
    s_add_u32 s77, s77, 106496
    s_mul_i32 s74, s45, 2080
    s_add_u32 s74, s74, 66560
    s_mov_b32 m0, s74
    s_add_u32 s74, s74, 8320
    buffer_load_dwordx4 v221, s[40:43], s77 offen offset:0 sc1 lds
    buffer_load_dwordx4 v221, s[40:43], s77 offen offset:1024 sc1 lds
    s_add_u32 s77, s77, 8192
    s_mov_b32 m0, s74
    s_add_u32 s74, s74, 8320
    buffer_load_dwordx4 v221, s[40:43], s77 offen offset:0 sc1 lds
    buffer_load_dwordx4 v221, s[40:43], s77 offen offset:1024 sc1 lds
    s_add_u32 s77, s77, 8192
    s_mov_b32 m0, s74
    s_add_u32 s74, s74, 8320
    buffer_load_dwordx4 v221, s[40:43], s77 offen offset:0 sc1 lds
    buffer_load_dwordx4 v221, s[40:43], s77 offen offset:1024 sc1 lds
    s_add_u32 s77, s77, 8192
    s_mov_b32 exec_lo, 0xfff
    s_mov_b32 exec_hi, 0xfff
    ds_write_b128 v224, v[228:231] offset:2048
    s_mov_b64 exec, -1
    s_lshr_b32 s75, s72, 1
    s_xor_b32 s64, s75, 0
    s_mul_i32 s64, s64, 14336
    s_xor_b32 s65, s75, 1
    s_mul_i32 s65, s65, 14336
    s_xor_b32 s66, s75, 2
    s_mul_i32 s66, s66, 14336
    s_xor_b32 s67, s75, 3
    s_mul_i32 s67, s67, 14336
    s_mul_i32 s73, s71, 112
    s_mul_i32 s74, s45, 28
    s_add_u32 s73, s73, s74
    s_lshl_b32 s73, s73, 11
    s_add_u32 s62, s73, 4194304
    s_lshl_b32 s73, s45, 3
    s_and_b32 s74, s72, 4
    s_add_u32 s74, s74, s73
    s_lshl_b32 s4, 15, s74
    s_lshl_b32 s5, 0xff, s73
    s_lshl_b32 s76, s64, 3
    s_add_u32 s76, s76, s61
    s_add_u32 s77, s64, s62
    s_add_u32 m0, s37, 0
    s_nop 0
    buffer_load_dwordx4 v219, s[28:31], s76 offen lds
    s_add_u32 s76, s76, 8192
    s_add_u32 m0, s37, 1024
    s_nop 0
    buffer_load_dwordx4 v219, s[28:31], s76 offen lds
    s_add_u32 s76, s76, 8192
    s_add_u32 m0, s37, 2048
    s_nop 0
    buffer_load_dwordx4 v219, s[28:31], s76 offen lds
    s_add_u32 s76, s76, 8192
    s_add_u32 m0, s37, 3072
    s_nop 0
    buffer_load_dwordx4 v219, s[28:31], s76 offen lds
    s_add_u32 s76, s76, 8192
    s_add_u32 m0, s37, 4096
    s_nop 0
    buffer_load_dwordx4 v219, s[28:31], s76 offen lds
    s_add_u32 s76, s76, 8192
    s_add_u32 m0, s37, 5120
    s_nop 0
    buffer_load_dwordx4 v219, s[28:31], s76 offen lds
    s_add_u32 s76, s76, 8192
    s_add_u32 m0, s37, 6144
    s_nop 0
    buffer_load_dwordx4 v219, s[28:31], s76 offen lds
    s_add_u32 s76, s76, 8192
    s_add_u32 m0, s37, 7168
    s_nop 0
    buffer_load_dwordx4 v219, s[28:31], s76 offen lds
    s_add_u32 s76, s76, 8192
    s_add_u32 m0, s37, 8192
    s_nop 0
    buffer_load_dwordx4 v219, s[28:31], s76 offen lds
    s_add_u32 s76, s76, 8192
    s_add_u32 m0, s37, 9216
    s_nop 0
    buffer_load_dwordx4 v219, s[28:31], s76 offen lds
    s_add_u32 s76, s76, 8192
    s_add_u32 m0, s37, 10240
    s_nop 0
    buffer_load_dwordx4 v219, s[28:31], s76 offen lds
    s_add_u32 s76, s76, 8192
    s_add_u32 m0, s37, 11264
    s_nop 0
    buffer_load_dwordx4 v219, s[28:31], s76 offen lds
    s_add_u32 s76, s76, 8192
    s_add_u32 m0, s37, 12288
    s_nop 0
    buffer_load_dwordx4 v219, s[28:31], s76 offen lds
    s_add_u32 s76, s76, 8192
    s_add_u32 m0, s37, 13312
    s_nop 0
    buffer_load_dwordx4 v219, s[28:31], s76 offen lds
    s_add_u32 s76, s76, 8192
    s_lshl_b32 s76, s65, 3
    s_add_u32 s76, s76, s61
    s_add_u32 m0, s37, 14336
    s_nop 0
    buffer_load_dwordx4 v219, s[28:31], s76 offen lds
    s_add_u32 s76, s76, 8192
    s_add_u32 m0, s37, 15360
    s_nop 0
    buffer_load_dwordx4 v219, s[28:31], s76 offen lds
    s_add_u32 s76, s76, 8192
    s_waitcnt vmcnt(16)
    s_mov_b64 exec, 1
    ds_add_u32 v6, v7 offset:40
    s_mov_b64 exec, -1
    s_waitcnt vmcnt(14)
    ds_read_b64_tr_b16 v[72:73], v222 offset:0
    ds_read_b64_tr_b16 v[74:75], v222 offset:1024
    ds_read_b64_tr_b16 v[76:77], v223 offset:0
    ds_read_b64_tr_b16 v[78:79], v223 offset:1024
    s_waitcnt vmcnt(12)
    ds_read_b64_tr_b16 v[80:81], v222 offset:2048
    ds_read_b64_tr_b16 v[82:83], v222 offset:3072
    ds_read_b64_tr_b16 v[84:85], v223 offset:2048
    ds_read_b64_tr_b16 v[86:87], v223 offset:3072
    s_mov_b32 s46, 0x200000
L_fp_55:
    buffer_load_dword v124, v122, s[40:43], s47 offen sc1
    s_waitcnt vmcnt(0)
    v_cmp_ne_u32 vcc, s7, v124
    s_and_b32 s73, vcc_lo, s4
    s_cbranch_scc0 L_fpd_56
    s_sub_u32 s46, s46, 1
    s_cbranch_scc1 L_fpd_56
    s_sleep 4
    s_branch L_fp_55
L_fpd_56:
    s_setprio 0
    buffer_load_dwordx4 v[96:99], v0, s[40:43], s77 offen sc1
    buffer_load_dwordx4 v[100:103], v2, s[40:43], s77 offen sc1
    s_add_u32 s77, s77, 2048
    buffer_load_dwordx4 v[104:107], v0, s[40:43], s77 offen sc1
    buffer_load_dwordx4 v[108:111], v2, s[40:43], s77 offen sc1
    s_add_u32 s77, s77, 2048
    buffer_load_dwordx4 v[112:115], v0, s[40:43], s77 offen sc1
    buffer_load_dwordx4 v[116:119], v2, s[40:43], s77 offen sc1
    s_add_u32 s77, s77, 2048
    buffer_load_dwordx4 v[232:235], v0, s[40:43], s77 offen sc1
    buffer_load_dwordx4 v[236:239], v2, s[40:43], s77 offen sc1
    s_add_u32 s77, s77, 2048
    buffer_load_dwordx4 v[240:243], v0, s[40:43], s77 offen sc1
    buffer_load_dwordx4 v[244:247], v2, s[40:43], s77 offen sc1
    s_add_u32 s77, s77, 2048
    buffer_load_dwordx4 v[248:251], v0, s[40:43], s77 offen sc1
    buffer_load_dwordx4 v[252:255], v2, s[40:43], s77 offen sc1
    s_add_u32 s77, s77, 2048
    buffer_load_dwordx4 v[192:195], v0, s[40:43], s77 offen sc1
    buffer_load_dwordx4 v[196:199], v2, s[40:43], s77 offen sc1
    s_add_u32 s77, s77, 2048
    s_add_u32 s77, s65, s62
    s_waitcnt vmcnt(12) lgkmcnt(4)
    v_mfma_f32_32x32x16_bf16 v[8:23], v[72:75], v[96:99], 0
    s_add_u32 m0, s37, 0
    s_nop 0
    buffer_load_dwordx4 v219, s[28:31], s76 offen lds
    s_add_u32 s76, s76, 8192
    ds_read_b64_tr_b16 v[88:89], v222 offset:4096
    s_waitcnt lgkmcnt(0)
    v_mfma_f32_32x32x16_bf16 v[24:39], v[76:79], v[96:99], 0
    buffer_load_dwordx4 v[200:203], v0, s[40:43], s77 offen sc1
    ds_read_b64_tr_b16 v[90:91], v222 offset:5120
    s_waitcnt lgkmcnt(0)
    v_mfma_f32_32x32x16_bf16 v[40:55], v[72:75], v[100:103], 0
    s_add_u32 m0, s37, 1024
    s_nop 0
    buffer_load_dwordx4 v219, s[28:31], s76 offen lds
    s_add_u32 s76, s76, 8192
    ds_read_b64_tr_b16 v[92:93], v223 offset:4096
    s_waitcnt lgkmcnt(0)
    v_mfma_f32_32x32x16_bf16 v[56:71], v[76:79], v[100:103], 0
    buffer_load_dwordx4 v[204:207], v2, s[40:43], s77 offen sc1
    s_add_u32 s77, s77, 2048
    ds_read_b64_tr_b16 v[94:95], v223 offset:5120
    s_waitcnt lgkmcnt(0)
    s_waitcnt vmcnt(14)
    v_mfma_f32_32x32x16_bf16 v[8:23], v[80:83], v[104:107], v[8:23]
    s_add_u32 m0, s37, 2048
    s_nop 0
    buffer_load_dwordx4 v219, s[28:31], s76 offen lds
    s_add_u32 s76, s76, 8192
    ds_read_b64_tr_b16 v[72:73], v222 offset:6144
    s_waitcnt lgkmcnt(0)
    v_mfma_f32_32x32x16_bf16 v[24:39], v[84:87], v[104:107], v[24:39]
    buffer_load_dwordx4 v[96:99], v0, s[40:43], s77 offen sc1
    ds_read_b64_tr_b16 v[74:75], v222 offset:7168
    s_waitcnt lgkmcnt(0)
    v_mfma_f32_32x32x16_bf16 v[40:55], v[80:83], v[108:111], v[40:55]
    s_add_u32 m0, s37, 3072
    s_nop 0
    buffer_load_dwordx4 v219, s[28:31], s76 offen lds
    s_add_u32 s76, s76, 8192
    ds_read_b64_tr_b16 v[76:77], v223 offset:6144
    s_waitcnt lgkmcnt(0)
    v_mfma_f32_32x32x16_bf16 v[56:71], v[84:87], v[108:111], v[56:71]
    buffer_load_dwordx4 v[100:103], v2, s[40:43], s77 offen sc1
    s_add_u32 s77, s77, 2048
    ds_read_b64_tr_b16 v[78:79], v223 offset:7168
    s_waitcnt lgkmcnt(0)
    s_waitcnt vmcnt(16)
    v_mfma_f32_32x32x16_bf16 v[8:23], v[88:91], v[112:115], v[8:23]
    s_add_u32 m0, s37, 4096
    s_nop 0
    buffer_load_dwordx4 v219, s[28:31], s76 offen lds
    s_add_u32 s76, s76, 8192
    ds_read_b64_tr_b16 v[80:81], v222 offset:8192
    s_waitcnt lgkmcnt(0)
    v_mfma_f32_32x32x16_bf16 v[24:39], v[92:95], v[112:115], v[24:39]
    buffer_load_dwordx4 v[104:107], v0, s[40:43], s77 offen sc1
    ds_read_b64_tr_b16 v[82:83], v222 offset:9216
    s_waitcnt lgkmcnt(0)
    v_mfma_f32_32x32x16_bf16 v[40:55], v[88:91], v[116:119], v[40:55]
    s_add_u32 m0, s37, 5120
    s_nop 0
    buffer_load_dwordx4 v219, s[28:31], s76 offen lds
    s_add_u32 s76, s76, 8192
    ds_read_b64_tr_b16 v[84:85], v223 offset:8192
    s_waitcnt lgkmcnt(0)
    v_mfma_f32_32x32x16_bf16 v[56:71], v[92:95], v[116:119], v[56:71]
    buffer_load_dwordx4 v[108:111], v2, s[40:43], s77 offen sc1
    s_add_u32 s77, s77, 2048
    ds_read_b64_tr_b16 v[86:87], v223 offset:9216
    s_waitcnt lgkmcnt(0)
    s_waitcnt vmcnt(18)
    v_mfma_f32_32x32x16_bf16 v[8:23], v[72:75], v[232:235], v[8:23]
    s_add_u32 m0, s37, 6144
    s_nop 0
    buffer_load_dwordx4 v219, s[28:31], s76 offen lds
    s_add_u32 s76, s76, 8192
    ds_read_b64_tr_b16 v[88:89], v222 offset:10240
    s_waitcnt lgkmcnt(0)
    v_mfma_f32_32x32x16_bf16 v[24:39], v[76:79], v[232:235], v[24:39]
    buffer_load_dwordx4 v[112:115], v0, s[40:43], s77 offen sc1
    ds_read_b64_tr_b16 v[90:91], v222 offset:11264
    s_waitcnt lgkmcnt(0)
    v_mfma_f32_32x32x16_bf16 v[40:55], v[72:75], v[236:239], v[40:55]
    s_add_u32 m0, s37, 7168
    s_nop 0
    buffer_load_dwordx4 v219, s[28:31], s76 offen lds
    s_add_u32 s76, s76, 8192
    ds_read_b64_tr_b16 v[92:93], v223 offset:10240
    s_waitcnt lgkmcnt(0)
    v_mfma_f32_32x32x16_bf16 v[56:71], v[76:79], v[236:239], v[56:71]
    buffer_load_dwordx4 v[116:119], v2, s[40:43], s77 offen sc1
    s_add_u32 s77, s77, 2048
    ds_read_b64_tr_b16 v[94:95], v223 offset:11264
    s_waitcnt lgkmcnt(0)
    buffer_load_dword v124, v122, s[40:43], s47 offen sc1
    s_waitcnt vmcnt(21)
    v_mfma_f32_32x32x16_bf16 v[8:23], v[80:83], v[240:243], v[8:23]
    s_add_u32 m0, s37, 8192
    s_nop 0
    buffer_load_dwordx4 v219, s[28:31], s76 offen lds
    s_add_u32 s76, s76, 8192
    ds_read_b64_tr_b16 v[72:73], v222 offset:12288
    s_waitcnt lgkmcnt(0)
    v_mfma_f32_32x32x16_bf16 v[24:39], v[84:87], v[240:243], v[24:39]
    buffer_load_dwordx4 v[232:235], v0, s[40:43], s77 offen sc1
    ds_read_b64_tr_b16 v[74:75], v222 offset:13312
    s_waitcnt lgkmcnt(0)
    v_mfma_f32_32x32x16_bf16 v[40:55], v[80:83], v[244:247], v[40:55]
    s_add_u32 m0, s37, 9216
    s_nop 0
    buffer_load_dwordx4 v219, s[28:31], s76 offen lds
    s_add_u32 s76, s76, 8192
    ds_read_b64_tr_b16 v[76:77], v223 offset:12288
    s_waitcnt lgkmcnt(0)
    v_mfma_f32_32x32x16_bf16 v[56:71], v[84:87], v[244:247], v[56:71]
    buffer_load_dwordx4 v[236:239], v2, s[40:43], s77 offen sc1
    s_add_u32 s77, s77, 2048
    ds_read_b64_tr_b16 v[78:79], v223 offset:13312
    s_waitcnt lgkmcnt(0)
    s_waitcnt vmcnt(23)
    v_mfma_f32_32x32x16_bf16 v[8:23], v[88:91], v[248:251], v[8:23]
    s_add_u32 m0, s37, 10240
    s_nop 0
    buffer_load_dwordx4 v219, s[28:31], s76 offen lds
    s_add_u32 s76, s76, 8192
    ds_read_b64_tr_b16 v[80:81], v222 offset:14336
    s_waitcnt lgkmcnt(0)
    v_mfma_f32_32x32x16_bf16 v[24:39], v[92:95], v[248:251], v[24:39]
    buffer_load_dwordx4 v[240:243], v0, s[40:43], s77 offen sc1
    ds_read_b64_tr_b16 v[82:83], v222 offset:15360
    s_waitcnt lgkmcnt(0)
    v_mfma_f32_32x32x16_bf16 v[40:55], v[88:91], v[252:255], v[40:55]
    s_add_u32 m0, s37, 11264
    s_nop 0
    buffer_load_dwordx4 v219, s[28:31], s76 offen lds
    s_add_u32 s76, s76, 8192
    s_lshl_b32 s76, s66, 3
    s_add_u32 s76, s76, s61
    ds_read_b64_tr_b16 v[84:85], v223 offset:14336
    s_waitcnt lgkmcnt(0)
    v_mfma_f32_32x32x16_bf16 v[56:71], v[92:95], v[252:255], v[56:71]
    buffer_load_dwordx4 v[244:247], v2, s[40:43], s77 offen sc1
    s_add_u32 s77, s77, 2048
    ds_read_b64_tr_b16 v[86:87], v223 offset:15360
    s_waitcnt lgkmcnt(0)
    s_waitcnt vmcnt(25)
    s_waitcnt vmcnt(22)
    v_mfma_f32_32x32x16_bf16 v[8:23], v[72:75], v[192:195], v[8:23]
    s_add_u32 m0, s37, 12288
    s_nop 0
    buffer_load_dwordx4 v219, s[28:31], s76 offen lds
    s_add_u32 s76, s76, 8192
    ds_read_b64_tr_b16 v[88:89], v222 offset:0
    s_waitcnt lgkmcnt(0)
    v_mfma_f32_32x32x16_bf16 v[24:39], v[76:79], v[192:195], v[24:39]
    buffer_load_dwordx4 v[248:251], v0, s[40:43], s77 offen sc1
    ds_read_b64_tr_b16 v[90:91], v222 offset:1024
    s_waitcnt lgkmcnt(0)
    v_mfma_f32_32x32x16_bf16 v[40:55], v[72:75], v[196:199], v[40:55]
    s_add_u32 m0, s37, 13312
    s_nop 0
    buffer_load_dwordx4 v219, s[28:31], s76 offen lds
    s_add_u32 s76, s76, 8192
    ds_read_b64_tr_b16 v[92:93], v223 offset:0
    s_waitcnt lgkmcnt(0)
    v_mfma_f32_32x32x16_bf16 v[56:71], v[76:79], v[196:199], v[56:71]
    buffer_load_dwordx4 v[252:255], v2, s[40:43], s77 offen sc1
    s_add_u32 s77, s77, 2048
    s_add_u32 s77, s66, s62
    ds_read_b64_tr_b16 v[94:95], v223 offset:1024
    s_waitcnt lgkmcnt(0)
    s_waitcnt vmcnt(12)
    s_setprio 3
    v_cmp_ne_u32 vcc, s7, v124
    s_and_b32 s73, vcc_lo, s5
    s_cbranch_scc1 L_slow_h
L_back_h:
    s_setprio 0
    v_mfma_f32_32x32x16_bf16 v[8:23], v[80:83], v[200:203], v[8:23]
    s_add_u32 m0, s37, 14336
    s_nop 0
    buffer_load_dwordx4 v219, s[28:31], s76 offen lds
    s_add_u32 s76, s76, 8192
    ds_read_b64_tr_b16 v[72:73], v222 offset:2048
    s_waitcnt lgkmcnt(0)
    v_mfma_f32_32x32x16_bf16 v[24:39], v[84:87], v[200:203], v[24:39]
    buffer_load_dwordx4 v[192:195], v0, s[40:43], s77 offen sc1
    ds_read_b64_tr_b16 v[74:75], v222 offset:3072
    s_waitcnt lgkmcnt(0)
    v_mfma_f32_32x32x16_bf16 v[40:55], v[80:83], v[204:207], v[40:55]
    s_add_u32 m0, s37, 15360
    s_nop 0
    buffer_load_dwordx4 v219, s[28:31], s76 offen lds
    s_add_u32 s76, s76, 8192
    ds_read_b64_tr_b16 v[76:77], v223 offset:2048
    s_waitcnt lgkmcnt(0)
    v_mfma_f32_32x32x16_bf16 v[56:71], v[84:87], v[204:207], v[56:71]
    buffer_load_dwordx4 v[196:199], v2, s[40:43], s77 offen sc1
    s_add_u32 s77, s77, 2048
    ds_read_b64_tr_b16 v[78:79], v223 offset:3072
    s_waitcnt lgkmcnt(0)
    v_mfma_f32_32x32x16_bf16 v[8:23], v[88:91], v[96:99], v[8:23]
    s_add_u32 m0, s37, 0
    s_nop 0
    buffer_load_dwordx4 v219, s[28:31], s76 offen lds
    s_add_u32 s76, s76, 8192
    ds_read_b64_tr_b16 v[80:81], v222 offset:4096
    s_waitcnt lgkmcnt(0)
    v_mfma_f32_32x32x16_bf16 v[24:39], v[92:95], v[96:99], v[24:39]
    buffer_load_dwordx4 v[200:203], v0, s[40:43], s77 offen sc1
    ds_read_b64_tr_b16 v[82:83], v222 offset:5120
    s_waitcnt lgkmcnt(0)
    v_mfma_f32_32x32x16_bf16 v[40:55], v[88:91], v[100:103], v[40:55]
    s_add_u32 m0, s37, 1024
    s_nop 0
    buffer_load_dwordx4 v219, s[28:31], s76 offen lds
    s_add_u32 s76, s76, 8192
    ds_read_b64_tr_b16 v[84:85], v223 offset:4096
    s_waitcnt lgkmcnt(0)
    v_mfma_f32_32x32x16_bf16 v[56:71], v[92:95], v[100:103], v[56:71]
    buffer_load_dwordx4 v[204:207], v2, s[40:43], s77 offen sc1
    s_add_u32 s77, s77, 2048
    ds_read_b64_tr_b16 v[86:87], v223 offset:5120
    s_waitcnt lgkmcnt(0)
    v_mfma_f32_32x32x16_bf16 v[8:23], v[72:75], v[104:107], v[8:23]
    s_add_u32 m0, s37, 2048
    s_nop 0
    buffer_load_dwordx4 v219, s[28:31], s76 offen lds
    s_add_u32 s76, s76, 8192
    ds_read_b64_tr_b16 v[88:89], v222 offset:6144
    s_waitcnt lgkmcnt(0)
    v_mfma_f32_32x32x16_bf16 v[24:39], v[76:79], v[104:107], v[24:39]
    buffer_load_dwordx4 v[96:99], v0, s[40:43], s77 offen sc1
    ds_read_b64_tr_b16 v[90:91], v222 offset:7168
    s_waitcnt lgkmcnt(0)
    v_mfma_f32_32x32x16_bf16 v[40:55], v[72:75], v[108:111], v[40:55]
    s_add_u32 m0, s37, 3072
    s_nop 0
    buffer_load_dwordx4 v219, s[28:31], s76 offen lds
    s_add_u32 s76, s76, 8192
    ds_read_b64_tr_b16 v[92:93], v223 offset:6144
    s_waitcnt lgkmcnt(0)
    v_mfma_f32_32x32x16_bf16 v[56:71], v[76:79], v[108:111], v[56:71]
    buffer_load_dwordx4 v[100:103], v2, s[40:43], s77 offen sc1
    s_add_u32 s77, s77, 2048
    ds_read_b64_tr_b16 v[94:95], v223 offset:7168
    s_waitcnt lgkmcnt(0)
    s_waitcnt vmcnt(21)
    v_mfma_f32_32x32x16_bf16 v[8:23], v[80:83], v[112:115], v[8:23]
    s_add_u32 m0, s37, 4096
    s_nop 0
    buffer_load_dwordx4 v219, s[28:31], s76 offen lds
    s_add_u32 s76, s76, 8192
    ds_read_b64_tr_b16 v[72:73], v222 offset:8192
    s_waitcnt lgkmcnt(0)
    v_mfma_f32_32x32x16_bf16 v[24:39], v[84:87], v[112:115], v[24:39]
    buffer_load_dwordx4 v[104:107], v0, s[40:43], s77 offen sc1
    ds_read_b64_tr_b16 v[74:75], v222 offset:9216
    s_waitcnt lgkmcnt(0)
    v_mfma_f32_32x32x16_bf16 v[40:55], v[80:83], v[116:119], v[40:55]
    s_add_u32 m0, s37, 5120
    s_nop 0
    buffer_load_dwordx4 v219, s[28:31], s76 offen lds
    s_add_u32 s76, s76, 8192
    ds_read_b64_tr_b16 v[76:77], v223 offset:8192
    s_waitcnt lgkmcnt(0)
    v_mfma_f32_32x32x16_bf16 v[56:71], v[84:87], v[116:119], v[56:71]
    buffer_load_dwordx4 v[108:111], v2, s[40:43], s77 offen sc1
    s_add_u32 s77, s77, 2048
    ds_read_b64_tr_b16 v[78:79], v223 offset:9216
    s_waitcnt lgkmcnt(0)
    s_waitcnt vmcnt(24)
    s_waitcnt vmcnt(21)
    v_mfma_f32_32x32x16_bf16 v[8:23], v[88:91], v[232:235], v[8:23]
    s_add_u32 m0, s37, 6144
    s_nop 0
    buffer_load_dwordx4 v219, s[28:31], s76 offen lds
    s_add_u32 s76, s76, 8192
    ds_read_b64_tr_b16 v[80:81], v222 offset:10240
    s_waitcnt lgkmcnt(0)
    v_mfma_f32_32x32x16_bf16 v[24:39], v[92:95], v[232:235], v[24:39]
    buffer_load_dwordx4 v[112:115], v0, s[40:43], s77 offen sc1
    ds_read_b64_tr_b16 v[82:83], v222 offset:11264
    s_waitcnt lgkmcnt(0)
    v_mfma_f32_32x32x16_bf16 v[40:55], v[88:91], v[236:239], v[40:55]
    s_add_u32 m0, s37, 7168
    s_nop 0
    buffer_load_dwordx4 v219, s[28:31], s76 offen lds
    s_add_u32 s76, s76, 8192
    ds_read_b64_tr_b16 v[84:85], v223 offset:10240
    s_waitcnt lgkmcnt(0)
    v_mfma_f32_32x32x16_bf16 v[56:71], v[92:95], v[236:239], v[56:71]
    buffer_load_dwordx4 v[116:119], v2, s[40:43], s77 offen sc1
    s_add_u32 s77, s77, 2048
    ds_read_b64_tr_b16 v[86:87], v223 offset:11264
    s_waitcnt lgkmcnt(0)
    s_waitcnt vmcnt(24)
    s_waitcnt vmcnt(21)
    v_mfma_f32_32x32x16_bf16 v[8:23], v[72:75], v[240:243], v[8:23]
    s_add_u32 m0, s37, 8192
    s_nop 0
    buffer_load_dwordx4 v219, s[28:31], s76 offen lds
    s_add_u32 s76, s76, 8192
    ds_read_b64_tr_b16 v[88:89], v222 offset:12288
    s_waitcnt lgkmcnt(0)
    v_mfma_f32_32x32x16_bf16 v[24:39], v[76:79], v[240:243], v[24:39]
    buffer_load_dwordx4 v[232:235], v0, s[40:43], s77 offen sc1
    ds_read_b64_tr_b16 v[90:91], v222 offset:13312
    s_waitcnt lgkmcnt(0)
    v_mfma_f32_32x32x16_bf16 v[40:55], v[72:75], v[244:247], v[40:55]
    s_add_u32 m0, s37, 9216
    s_nop 0
    buffer_load_dwordx4 v219, s[28:31], s76 offen lds
    s_add_u32 s76, s76, 8192
    s_lshl_b32 s76, s67, 3
    s_add_u32 s76, s76, s61
    ds_read_b64_tr_b16 v[92:93], v223 offset:12288
    s_waitcnt lgkmcnt(0)
    v_mfma_f32_32x32x16_bf16 v[56:71], v[76:79], v[244:247], v[56:71]
    buffer_load_dwordx4 v[236:239], v2, s[40:43], s77 offen sc1
    s_add_u32 s77, s77, 2048
    ds_read_b64_tr_b16 v[94:95], v223 offset:13312
    s_waitcnt lgkmcnt(0)
    s_waitcnt vmcnt(24)
    s_waitcnt vmcnt(21)
    v_mfma_f32_32x32x16_bf16 v[8:23], v[80:83], v[248:251], v[8:23]
    s_add_u32 m0, s37, 10240
    s_nop 0
    buffer_load_dwordx4 v219, s[28:31], s76 offen lds
    s_add_u32 s76, s76, 8192
    ds_read_b64_tr_b16 v[72:73], v222 offset:14336
    s_waitcnt lgkmcnt(0)
    v_mfma_f32_32x32x16_bf16 v[24:39], v[84:87], v[248:251], v[24:39]
    buffer_load_dwordx4 v[240:243], v0, s[40:43], s77 offen sc1
    ds_read_b64_tr_b16 v[74:75], v222 offset:15360
    s_waitcnt lgkmcnt(0)
    v_mfma_f32_32x32x16_bf16 v[40:55], v[80:83], v[252:255], v[40:55]
    s_add_u32 m0, s37, 11264
    s_nop 0
    buffer_load_dwordx4 v219, s[28:31], s76 offen lds
    s_add_u32 s76, s76, 8192
    ds_read_b64_tr_b16 v[76:77], v223 offset:14336
    s_waitcnt lgkmcnt(0)
    v_mfma_f32_32x32x16_bf16 v[56:71], v[84:87], v[252:255], v[56:71]
    buffer_load_dwordx4 v[244:247], v2, s[40:43], s77 offen sc1
    s_add_u32 s77, s77, 2048
    s_add_u32 s77, s67, s62
    ds_read_b64_tr_b16 v[78:79], v223 offset:15360
    s_waitcnt lgkmcnt(0)
    s_waitcnt vmcnt(24)
    s_waitcnt vmcnt(21)
    v_mfma_f32_32x32x16_bf16 v[8:23], v[88:91], v[192:195], v[8:23]
    s_add_u32 m0, s37, 12288
    s_nop 0
    buffer_load_dwordx4 v219, s[28:31], s76 offen lds
    s_add_u32 s76, s76, 8192
    ds_read_b64_tr_b16 v[80:81], v222 offset:0
    s_waitcnt lgkmcnt(0)
    v_mfma_f32_32x32x16_bf16 v[24:39], v[92:95], v[192:195], v[24:39]
    buffer_load_dwordx4 v[248:251], v0, s[40:43], s77 offen sc1
    ds_read_b64_tr_b16 v[82:83], v222 offset:1024
    s_waitcnt lgkmcnt(0)
    v_mfma_f32_32x32x16_bf16 v[40:55], v[88:91], v[196:199], v[40:55]
    s_add_u32 m0, s37, 13312
    s_nop 0
    buffer_load_dwordx4 v219, s[28:31], s76 offen lds
    s_add_u32 s76, s76, 8192
    ds_read_b64_tr_b16 v[84:85], v223 offset:0
    s_waitcnt lgkmcnt(0)
    v_mfma_f32_32x32x16_bf16 v[56:71], v[92:95], v[196:199], v[56:71]
    buffer_load_dwordx4 v[252:255], v2, s[40:43], s77 offen sc1
    s_add_u32 s77, s77, 2048
    ds_read_b64_tr_b16 v[86:87], v223 offset:1024
    s_waitcnt lgkmcnt(0)
    s_waitcnt vmcnt(24)
    s_waitcnt vmcnt(21)
    v_mfma_f32_32x32x16_bf16 v[8:23], v[72:75], v[200:203], v[8:23]
    s_add_u32 m0, s37, 14336
    s_nop 0
    buffer_load_dwordx4 v219, s[28:31], s76 offen lds
    s_add_u32 s76, s76, 8192
    ds_read_b64_tr_b16 v[88:89], v222 offset:2048
    s_waitcnt lgkmcnt(0)
    v_mfma_f32_32x32x16_bf16 v[24:39], v[76:79], v[200:203], v[24:39]
    buffer_load_dwordx4 v[192:195], v0, s[40:43], s77 offen sc1
    ds_read_b64_tr_b16 v[90:91], v222 offset:3072
    s_waitcnt lgkmcnt(0)
    v_mfma_f32_32x32x16_bf16 v[40:55], v[72:75], v[204:207], v[40:55]
    s_add_u32 m0, s37, 15360
    s_nop 0
    buffer_load_dwordx4 v219, s[28:31], s76 offen lds
    s_add_u32 s76, s76, 8192
    ds_read_b64_tr_b16 v[92:93], v223 offset:2048
    s_waitcnt lgkmcnt(0)
    v_mfma_f32_32x32x16_bf16 v[56:71], v[76:79], v[204:207], v[56:71]
    buffer_load_dwordx4 v[196:199], v2, s[40:43], s77 offen sc1
    s_add_u32 s77, s77, 2048
    ds_read_b64_tr_b16 v[94:95], v223 offset:3072
    s_waitcnt lgkmcnt(0)
    s_waitcnt vmcnt(24)
    s_waitcnt vmcnt(21)
    v_mfma_f32_32x32x16_bf16 v[8:23], v[80:83], v[96:99], v[8:23]
    s_add_u32 m0, s37, 0
    s_nop 0
    buffer_load_dwordx4 v219, s[28:31], s76 offen lds
    s_add_u32 s76, s76, 8192
    ds_read_b64_tr_b16 v[72:73], v222 offset:4096
    s_waitcnt lgkmcnt(0)
    v_mfma_f32_32x32x16_bf16 v[24:39], v[84:87], v[96:99], v[24:39]
    buffer_load_dwordx4 v[200:203], v0, s[40:43], s77 offen sc1
    ds_read_b64_tr_b16 v[74:75], v222 offset:5120
    s_waitcnt lgkmcnt(0)
    v_mfma_f32_32x32x16_bf16 v[40:55], v[80:83], v[100:103], v[40:55]
    s_add_u32 m0, s37, 1024
    s_nop 0
    buffer_load_dwordx4 v219, s[28:31], s76 offen lds
    s_add_u32 s76, s76, 8192
    ds_read_b64_tr_b16 v[76:77], v223 offset:4096
    s_waitcnt lgkmcnt(0)
    v_mfma_f32_32x32x16_bf16 v[56:71], v[84:87], v[100:103], v[56:71]
    buffer_load_dwordx4 v[204:207], v2, s[40:43], s77 offen sc1
    s_add_u32 s77, s77, 2048
    ds_read_b64_tr_b16 v[78:79], v223 offset:5120
    s_waitcnt lgkmcnt(0)
    s_setprio 3
    s_mov_b32 s46, 0x2000000
L_lp_57:
    ds_read_b32 v5, v6 offset:44
    s_waitcnt lgkmcnt(0)
    v_readfirstlane_b32 s73, v5
    s_cmp_ge_u32 s73, 4
    s_cbranch_scc1 L_lpd_58
    s_sub_u32 s46, s46, 1
    s_cbranch_scc1 L_lpd_58
    s_sleep 8
    s_branch L_lp_57
L_lpd_58:
    s_setprio 0
    s_lshl_b32 s39, s45, 17
    s_lshl_b32 s60, s72, 7
    s_add_u32 s39, s39, s60
    s_lshl_b32 s60, s45, 14
    s_lshl_b32 s74, s71, 11
    s_and_b32 s74, s74, 0x3fff
    s_add_u32 m0, s60, s74
    s_lshl_b32 s73, s74, 3
    s_add_u32 s73, s73, s39
    buffer_load_dwordx4 v219, s[20:23], s73 offen lds
    s_add_u32 s74, s74, 1024
    s_and_b32 s74, s74, 0x3fff
    s_add_u32 m0, s60, s74
    s_lshl_b32 s73, s74, 3
    s_add_u32 s73, s73, s39
    buffer_load_dwordx4 v219, s[20:23], s73 offen lds
    s_add_u32 s74, s74, 1024
    s_and_b32 s74, s74, 0x3fff
    s_add_u32 m0, s60, s74
    s_lshl_b32 s73, s74, 3
    s_add_u32 s73, s73, s39
    buffer_load_dwordx4 v219, s[20:23], s73 offen lds
    s_add_u32 s74, s74, 1024
    s_and_b32 s74, s74, 0x3fff
    s_add_u32 m0, s60, s74
    s_lshl_b32 s73, s74, 3
    s_add_u32 s73, s73, s39
    buffer_load_dwordx4 v219, s[20:23], s73 offen lds
    s_add_u32 s74, s74, 1024
    s_and_b32 s74, s74, 0x3fff
    s_add_u32 m0, s60, s74
    s_lshl_b32 s73, s74, 3
    s_add_u32 s73, s73, s39
    buffer_load_dwordx4 v219, s[20:23], s73 offen lds
    s_add_u32 s74, s74, 1024
    s_and_b32 s74, s74, 0x3fff
    s_add_u32 m0, s60, s74
    s_lshl_b32 s73, s74, 3
    s_add_u32 s73, s73, s39
    buffer_load_dwordx4 v219, s[20:23], s73 offen lds
    s_add_u32 s74, s74, 1024
    s_and_b32 s74, s74, 0x3fff
    s_add_u32 m0, s60, s74
    s_lshl_b32 s73, s74, 3
    s_add_u32 s73, s73, s39
    buffer_load_dwordx4 v219, s[20:23], s73 offen lds
    s_add_u32 s74, s74, 1024
    s_and_b32 s74, s74, 0x3fff
    s_add_u32 m0, s60, s74
    s_lshl_b32 s73, s74, 3
    s_add_u32 s73, s73, s39
    buffer_load_dwordx4 v219, s[20:23], s73 offen lds
    s_add_u32 s74, s74, 1024
    s_and_b32 s74, s74, 0x3fff
    s_add_u32 m0, s60, s74
    s_lshl_b32 s73, s74, 3
    s_add_u32 s73, s73, s39
    buffer_load_dwordx4 v219, s[20:23], s73 offen lds
    s_add_u32 s74, s74, 1024
    s_and_b32 s74, s74, 0x3fff
    s_add_u32 m0, s60, s74
    s_lshl_b32 s73, s74, 3
    s_add_u32 s73, s73, s39
    buffer_load_dwordx4 v219, s[20:23], s73 offen lds
    s_add_u32 s74, s74, 1024
    s_and_b32 s74, s74, 0x3fff
    s_add_u32 m0, s60, s74
    s_lshl_b32 s73, s74, 3
    s_add_u32 s73, s73, s39
    buffer_load_dwordx4 v219, s[20:23], s73 offen lds
    s_add_u32 s74, s74, 1024
    s_and_b32 s74, s74, 0x3fff
    s_add_u32 m0, s60, s74
    s_lshl_b32 s73, s74, 3
    s_add_u32 s73, s73, s39
    buffer_load_dwordx4 v219, s[20:23], s73 offen lds
    s_add_u32 s74, s74, 1024
    s_and_b32 s74, s74, 0x3fff
    s_add_u32 m0, s60, s74
    s_lshl_b32 s73, s74, 3
    s_add_u32 s73, s73, s39
    buffer_load_dwordx4 v219, s[20:23], s73 offen lds
    s_add_u32 s74, s74, 1024
    s_and_b32 s74, s74, 0x3fff
    s_add_u32 m0, s60, s74
    s_lshl_b32 s73, s74, 3
    s_add_u32 s73, s73, s39
    buffer_load_dwordx4 v219, s[20:23], s73 offen lds
    s_add_u32 s74, s74, 1024
    s_and_b32 s74, s74, 0x3fff
    s_add_u32 m0, s60, s74
    s_lshl_b32 s73, s74, 3
    s_add_u32 s73, s73, s39
    buffer_load_dwordx4 v219, s[20:23], s73 offen lds
    s_add_u32 s74, s74, 1024
    s_and_b32 s74, s74, 0x3fff
    s_add_u32 m0, s60, s74
    s_lshl_b32 s73, s74, 3
    s_add_u32 s73, s73, s39
    buffer_load_dwordx4 v219, s[20:23], s73 offen lds
    s_add_u32 s74, s74, 1024
    s_setprio 0
    s_waitcnt vmcnt(40)
    s_waitcnt vmcnt(37)
    v_mfma_f32_32x32x16_bf16 v[8:23], v[88:91], v[104:107], v[8:23]
    s_add_u32 m0, s37, 2048
    s_nop 0
    buffer_load_dwordx4 v219, s[28:31], s76 offen lds
    s_add_u32 s76, s76, 8192
    ds_read_b64_tr_b16 v[80:81], v222 offset:6144
    s_waitcnt lgkmcnt(0)
    v_mfma_f32_32x32x16_bf16 v[24:39], v[92:95], v[104:107], v[24:39]
    buffer_load_dwordx4 v[96:99], v0, s[40:43], s77 offen sc1
    ds_read_b64_tr_b16 v[82:83], v222 offset:7168
    s_waitcnt lgkmcnt(0)
    v_mfma_f32_32x32x16_bf16 v[40:55], v[88:91], v[108:111], v[40:55]
    s_add_u32 m0, s37, 3072
    s_nop 0
    buffer_load_dwordx4 v219, s[28:31], s76 offen lds
    s_add_u32 s76, s76, 8192
    ds_read_b64_tr_b16 v[84:85], v223 offset:6144
    s_waitcnt lgkmcnt(0)
    v_mfma_f32_32x32x16_bf16 v[56:71], v[92:95], v[108:111], v[56:71]
    buffer_load_dwordx4 v[100:103], v2, s[40:43], s77 offen sc1
    s_add_u32 s77, s77, 2048
    ds_read_b64_tr_b16 v[86:87], v223 offset:7168
    s_waitcnt lgkmcnt(0)
    s_waitcnt vmcnt(40)
    s_waitcnt vmcnt(37)
    v_mfma_f32_32x32x16_bf16 v[8:23], v[72:75], v[112:115], v[8:23]
    s_add_u32 m0, s37, 4096
    s_nop 0
    buffer_load_dwordx4 v219, s[28:31], s76 offen lds
    s_add_u32 s76, s76, 8192
    ds_read_b64_tr_b16 v[88:89], v222 offset:8192
    s_waitcnt lgkmcnt(0)
    v_mfma_f32_32x32x16_bf16 v[24:39], v[76:79], v[112:115], v[24:39]
    buffer_load_dwordx4 v[104:107], v0, s[40:43], s77 offen sc1
    ds_read_b64_tr_b16 v[90:91], v222 offset:9216
    s_waitcnt lgkmcnt(0)
    v_mfma_f32_32x32x16_bf16 v[40:55], v[72:75], v[116:119], v[40:55]
    s_add_u32 m0, s37, 5120
    s_nop 0
    buffer_load_dwordx4 v219, s[28:31], s76 offen lds
    s_add_u32 s76, s76, 8192
    ds_read_b64_tr_b16 v[92:93], v223 offset:8192
    s_waitcnt lgkmcnt(0)
    v_mfma_f32_32x32x16_bf16 v[56:71], v[76:79], v[116:119], v[56:71]
    buffer_load_dwordx4 v[108:111], v2, s[40:43], s77 offen sc1
    s_add_u32 s77, s77, 2048
    ds_read_b64_tr_b16 v[94:95], v223 offset:9216
    s_waitcnt lgkmcnt(0)
    s_waitcnt vmcnt(40)
    s_waitcnt vmcnt(37)
    v_mfma_f32_32x32x16_bf16 v[8:23], v[80:83], v[232:235], v[8:23]
    s_add_u32 m0, s37, 6144
    s_nop 0
    buffer_load_dwordx4 v219, s[28:31], s76 offen lds
    s_add_u32 s76, s76, 8192
    ds_read_b64_tr_b16 v[72:73], v222 offset:10240
    s_waitcnt lgkmcnt(0)
    v_mfma_f32_32x32x16_bf16 v[24:39], v[84:87], v[232:235], v[24:39]
    buffer_load_dwordx4 v[112:115], v0, s[40:43], s77 offen sc1
    ds_read_b64_tr_b16 v[74:75], v222 offset:11264
    s_waitcnt lgkmcnt(0)
    v_mfma_f32_32x32x16_bf16 v[40:55], v[80:83], v[236:239], v[40:55]
    s_add_u32 m0, s37, 7168
    s_nop 0
    buffer_load_dwordx4 v219, s[28:31], s76 offen lds
    s_add_u32 s76, s76, 8192
    ds_read_b64_tr_b16 v[76:77], v223 offset:10240
    s_waitcnt lgkmcnt(0)
    v_mfma_f32_32x32x16_bf16 v[56:71], v[84:87], v[236:239], v[56:71]
    buffer_load_dwordx4 v[116:119], v2, s[40:43], s77 offen sc1
    s_add_u32 s77, s77, 2048
    ds_read_b64_tr_b16 v[78:79], v223 offset:11264
    s_waitcnt lgkmcnt(0)
    s_waitcnt vmcnt(12)
    s_mov_b64 exec, 1
    ds_add_u32 v6, v7 offset:48
    s_mov_b64 exec, -1
    v_mfma_f32_32x32x16_bf16 v[8:23], v[88:91], v[240:243], v[8:23]
    ds_read_b64_tr_b16 v[80:81], v222 offset:12288
    s_waitcnt lgkmcnt(0)
    v_mfma_f32_32x32x16_bf16 v[24:39], v[92:95], v[240:243], v[24:39]
    buffer_load_dwordx4 v[232:235], v0, s[40:43], s77 offen sc1
    ds_read_b64_tr_b16 v[82:83], v222 offset:13312
    s_waitcnt lgkmcnt(0)
    v_mfma_f32_32x32x16_bf16 v[40:55], v[88:91], v[244:247], v[40:55]
    ds_read_b64_tr_b16 v[84:85], v223 offset:12288
    s_waitcnt lgkmcnt(0)
    v_mfma_f32_32x32x16_bf16 v[56:71], v[92:95], v[244:247], v[56:71]
    buffer_load_dwordx4 v[236:239], v2, s[40:43], s77 offen sc1
    s_add_u32 s77, s77, 2048
    ds_read_b64_tr_b16 v[86:87], v223 offset:13312
    s_waitcnt lgkmcnt(0)
    s_waitcnt lgkmcnt(0)
    s_setprio 3
    s_waitcnt vmcnt(0)
    v_add_u32 v208, s37, v221
    s_xor_b32 s73, s45, 1
    s_lshl_b32 s73, s73, 14
    s_add_u32 s73, s73, 91520
    v_add_u32 v209, s73, v221
    s_xor_b32 s73, s45, 2
    s_lshl_b32 s73, s73, 14
    s_add_u32 s73, s73, 95616
    v_add_u32 v210, s73, v221
    s_xor_b32 s73, s45, 3
    s_lshl_b32 s73, s73, 14
    s_add_u32 s73, s73, 99712
    v_add_u32 v211, s73, v221
    s_lshl_b32 s73, s45, 2
    v_add_u32 v212, s73, v6
    s_mov_b32 s74, 0xbfb8aa3b
    s_mov_b32 s46, 0x2000000
L_lp_59:
    ds_read_b32 v5, v6 offset:52
    s_waitcnt lgkmcnt(0)
    v_readfirstlane_b32 s73, v5
    s_cmp_ge_u32 s73, 4
    s_cbranch_scc1 L_lpd_60
    s_sub_u32 s46, s46, 1
    s_cbranch_scc1 L_lpd_60
    s_sleep 1
    s_branch L_lp_59
L_lpd_60:
    s_setprio 3
    v_mfma_f32_32x32x16_bf16 v[8:23], v[72:75], v[248:251], v[8:23]
    ds_read_b64_tr_b16 v[88:89], v222 offset:14336
    v_mfma_f32_32x32x16_bf16 v[24:39], v[76:79], v[248:251], v[24:39]
    ds_read_b64_tr_b16 v[90:91], v222 offset:15360
    v_mfma_f32_32x32x16_bf16 v[40:55], v[72:75], v[252:255], v[40:55]
    ds_read_b64_tr_b16 v[92:93], v223 offset:14336
    v_mfma_f32_32x32x16_bf16 v[56:71], v[76:79], v[252:255], v[56:71]
    ds_read_b64_tr_b16 v[94:95], v223 offset:15360
    v_mfma_f32_32x32x16_bf16 v[8:23], v[80:83], v[192:195], v[8:23]
    ds_read_b64_tr_b16 v[72:73], v222 offset:0
    v_mfma_f32_32x32x16_bf16 v[24:39], v[84:87], v[192:195], v[24:39]
    ds_read_b64_tr_b16 v[74:75], v222 offset:1024
    v_mfma_f32_32x32x16_bf16 v[40:55], v[80:83], v[196:199], v[40:55]
    ds_read_b64_tr_b16 v[76:77], v223 offset:0
    v_mfma_f32_32x32x16_bf16 v[56:71], v[84:87], v[196:199], v[56:71]
    ds_read_b64_tr_b16 v[78:79], v223 offset:1024
    s_waitcnt lgkmcnt(4)
    v_mfma_f32_32x32x16_bf16 v[8:23], v[88:91], v[200:203], v[8:23]
    ds_read_b64_tr_b16 v[80:81], v222 offset:2048
    v_mfma_f32_32x32x16_bf16 v[24:39], v[92:95], v[200:203], v[24:39]
    ds_read_b64_tr_b16 v[82:83], v222 offset:3072
    v_mfma_f32_32x32x16_bf16 v[40:55], v[88:91], v[204:207], v[40:55]
    ds_read_b64_tr_b16 v[84:85], v223 offset:2048
    v_mfma_f32_32x32x16_bf16 v[56:71], v[92:95], v[204:207], v[56:71]
    ds_read_b64_tr_b16 v[86:87], v223 offset:3072
    s_waitcnt lgkmcnt(4)
    v_mfma_f32_32x32x16_bf16 v[8:23], v[72:75], v[96:99], v[8:23]
    ds_read_b64_tr_b16 v[88:89], v222 offset:4096
    v_mfma_f32_32x32x16_bf16 v[24:39], v[76:79], v[96:99], v[24:39]
    ds_read_b64_tr_b16 v[90:91], v222 offset:5120
    v_mfma_f32_32x32x16_bf16 v[40:55], v[72:75], v[100:103], v[40:55]
    ds_read_b64_tr_b16 v[92:93], v223 offset:4096
    v_mfma_f32_32x32x16_bf16 v[56:71], v[76:79], v[100:103], v[56:71]
    ds_read_b64_tr_b16 v[94:95], v223 offset:5120
    s_waitcnt lgkmcnt(4)
    v_mfma_f32_32x32x16_bf16 v[8:23], v[80:83], v[104:107], v[8:23]
    ds_read_b64_tr_b16 v[72:73], v222 offset:6144
    v_mfma_f32_32x32x16_bf16 v[24:39], v[84:87], v[104:107], v[24:39]
    ds_read_b64_tr_b16 v[74:75], v222 offset:7168
    v_mfma_f32_32x32x16_bf16 v[40:55], v[80:83], v[108:111], v[40:55]
    ds_read_b64_tr_b16 v[76:77], v223 offset:6144
    v_mfma_f32_32x32x16_bf16 v[56:71], v[84:87], v[108:111], v[56:71]
    ds_read_b64_tr_b16 v[78:79], v223 offset:7168
    s_waitcnt lgkmcnt(4)
    v_mfma_f32_32x32x16_bf16 v[8:23], v[88:91], v[112:115], v[8:23]
    v_mfma_f32_32x32x16_bf16 v[24:39], v[92:95], v[112:115], v[24:39]
    v_mfma_f32_32x32x16_bf16 v[40:55], v[88:91], v[116:119], v[40:55]
    v_mfma_f32_32x32x16_bf16 v[56:71], v[92:95], v[116:119], v[56:71]
    s_waitcnt lgkmcnt(0)
    v_mfma_f32_32x32x16_bf16 v[8:23], v[72:75], v[232:235], v[8:23]
    v_mfma_f32_32x32x16_bf16 v[24:39], v[76:79], v[232:235], v[24:39]
    v_mfma_f32_32x32x16_bf16 v[40:55], v[72:75], v[236:239], v[40:55]
    v_mfma_f32_32x32x16_bf16 v[56:71], v[76:79], v[236:239], v[56:71]
    s_setprio 3
    s_nop 9
    s_setprio 0
    ds_write_b128 v208, v[24:27] offset:0
    ds_write_b128 v208, v[28:31] offset:1024
    ds_write_b128 v208, v[32:35] offset:2048
    ds_write_b128 v208, v[36:39] offset:3072
    ds_write_b128 v208, v[40:43] offset:4096
    ds_write_b128 v208, v[44:47] offset:5120
    ds_write_b128 v208, v[48:51] offset:6144
    ds_write_b128 v208, v[52:55] offset:7168
    ds_write_b128 v208, v[56:59] offset:8192
    ds_write_b128 v208, v[60:63] offset:9216
    ds_write_b128 v208, v[64:67] offset:10240
    ds_write_b128 v208, v[68:71] offset:11264
    s_mov_b64 exec, 1
    ds_add_u32 v6, v7 offset:56
    s_mov_b64 exec, -1
    s_setprio 3
    s_mov_b32 s46, 0x2000000
L_lp_61:
    ds_read_b32 v5, v6 offset:56
    s_waitcnt lgkmcnt(0)
    v_readfirstlane_b32 s73, v5
    s_cmp_ge_u32 s73, 4
    s_cbranch_scc1 L_lpd_62
    s_sub_u32 s46, s46, 1
    s_cbranch_scc1 L_lpd_62
    s_branch L_lp_61
L_lpd_62:
    ds_read_b128 v[24:27], v209 offset:0
    ds_read_b128 v[28:31], v209 offset:1024
    ds_read_b128 v[32:35], v209 offset:2048
    ds_read_b128 v[36:39], v209 offset:3072
    ds_read_b128 v[40:43], v210 offset:0
    ds_read_b128 v[44:47], v210 offset:1024
    ds_read_b128 v[48:51], v210 offset:2048
    ds_read_b128 v[52:55], v210 offset:3072
    ds_read_b128 v[56:59], v211 offset:0
    ds_read_b128 v[60:63], v211 offset:1024
    ds_read_b128 v[64:67], v211 offset:2048
    ds_read_b128 v[68:71], v211 offset:3072
    s_waitcnt lgkmcnt(8)
    v_pk_add_f32 v[8:9], v[8:9], v[24:25]
    v_pk_add_f32 v[10:11], v[10:11], v[26:27]
    v_pk_add_f32 v[12:13], v[12:13], v[28:29]
    v_pk_add_f32 v[14:15], v[14:15], v[30:31]
    v_pk_add_f32 v[16:17], v[16:17], v[32:33]
    v_pk_add_f32 v[18:19], v[18:19], v[34:35]
    v_pk_add_f32 v[20:21], v[20:21], v[36:37]
    v_pk_add_f32 v[22:23], v[22:23], v[38:39]
    s_waitcnt lgkmcnt(4)
    v_pk_add_f32 v[8:9], v[8:9], v[40:41]
    v_pk_add_f32 v[10:11], v[10:11], v[42:43]
    v_pk_add_f32 v[12:13], v[12:13], v[44:45]
    v_pk_add_f32 v[14:15], v[14:15], v[46:47]
    v_pk_add_f32 v[16:17], v[16:17], v[48:49]
    v_pk_add_f32 v[18:19], v[18:19], v[50:51]
    v_pk_add_f32 v[20:21], v[20:21], v[52:53]
    v_pk_add_f32 v[22:23], v[22:23], v[54:55]
    s_waitcnt lgkmcnt(0)
    v_pk_add_f32 v[8:9], v[8:9], v[56:57]
    v_pk_add_f32 v[10:11], v[10:11], v[58:59]
    v_pk_add_f32 v[12:13], v[12:13], v[60:61]
    v_pk_add_f32 v[14:15], v[14:15], v[62:63]
    v_pk_add_f32 v[16:17], v[16:17], v[64:65]
    v_pk_add_f32 v[18:19], v[18:19], v[66:67]
    v_pk_add_f32 v[20:21], v[20:21], v[68:69]
    v_pk_add_f32 v[22:23], v[22:23], v[70:71]
    v_mul_f32 v24, s74, v8
    v_mul_f32 v25, s74, v9
    v_mul_f32 v26, s74, v10
    v_mul_f32 v27, s74, v11
    v_mul_f32 v28, s74, v12
    v_mul_f32 v29, s74, v13
    v_mul_f32 v30, s74, v14
    v_mul_f32 v31, s74, v15
    v_mul_f32 v32, s74, v16
    v_mul_f32 v33, s74, v17
    v_mul_f32 v34, s74, v18
    v_mul_f32 v35, s74, v19
    v_mul_f32 v36, s74, v20
    v_mul_f32 v37, s74, v21
    v_mul_f32 v38, s74, v22
    v_mul_f32 v39, s74, v23
    v_exp_f32 v24, v24
    v_exp_f32 v25, v25
    v_exp_f32 v26, v26
    v_exp_f32 v27, v27
    v_exp_f32 v28, v28
    v_exp_f32 v29, v29
    v_exp_f32 v30, v30
    v_exp_f32 v31, v31
    v_exp_f32 v32, v32
    v_exp_f32 v33, v33
    v_exp_f32 v34, v34
    v_exp_f32 v35, v35
    v_exp_f32 v36, v36
    v_exp_f32 v37, v37
    v_exp_f32 v38, v38
    v_exp_f32 v39, v39
    v_add_f32 v24, 1.0, v24
    v_add_f32 v25, 1.0, v25
    v_add_f32 v26, 1.0, v26
    v_add_f32 v27, 1.0, v27
    v_add_f32 v28, 1.0, v28
    v_add_f32 v29, 1.0, v29
    v_add_f32 v30, 1.0, v30
    v_add_f32 v31, 1.0, v31
    v_add_f32 v32, 1.0, v32
    v_add_f32 v33, 1.0, v33
    v_add_f32 v34, 1.0, v34
    v_add_f32 v35, 1.0, v35
    v_add_f32 v36, 1.0, v36
    v_add_f32 v37, 1.0, v37
    v_add_f32 v38, 1.0, v38
    v_add_f32 v39, 1.0, v39
    v_rcp_f32 v24, v24
    v_rcp_f32 v25, v25
    v_rcp_f32 v26, v26
    v_rcp_f32 v27, v27
    v_rcp_f32 v28, v28
    v_rcp_f32 v29, v29
    v_rcp_f32 v30, v30
    v_rcp_f32 v31, v31
    v_rcp_f32 v32, v32
    v_rcp_f32 v33, v33
    v_rcp_f32 v34, v34
    v_rcp_f32 v35, v35
    v_rcp_f32 v36, v36
    v_rcp_f32 v37, v37
    v_rcp_f32 v38, v38
    v_rcp_f32 v39, v39
    v_mul_f32 v8, v8, v24
    v_mul_f32 v9, v9, v25
    v_mul_f32 v10, v10, v26
    v_mul_f32 v11, v11, v27
    v_mul_f32 v12, v12, v28
    v_mul_f32 v13, v13, v29
    v_mul_f32 v14, v14, v30
    v_mul_f32 v15, v15, v31
    v_mul_f32 v16, v16, v32
    v_mul_f32 v17, v17, v33
    v_mul_f32 v18, v18, v34
    v_mul_f32 v19, v19, v35
    v_mul_f32 v20, v20, v36
    v_mul_f32 v21, v21, v37
    v_mul_f32 v22, v22, v38
    v_mul_f32 v23, v23, v39
    v_cvt_pk_bf16_f32 v8, v8, v9
    v_cvt_pk_bf16_f32 v9, v10, v11
    v_cvt_pk_bf16_f32 v10, v12, v13
    v_cvt_pk_bf16_f32 v11, v14, v15
    v_cvt_pk_bf16_f32 v12, v16, v17
    v_cvt_pk_bf16_f32 v13, v18, v19
    v_cvt_pk_bf16_f32 v14, v20, v21
    v_cvt_pk_bf16_f32 v15, v22, v23
    ds_write_b128 v208, v[8:11] offset:12288
    ds_write_b128 v208, v[12:15] offset:13312
    s_mov_b64 exec, 1
    ds_add_u32 v212, v7 offset:100
    s_mov_b64 exec, -1
L_end:
    s_endpgm
L_slow_h:
    s_mov_b32 s46, 0x200000
L_slow_hx:
    buffer_load_dword v124, v122, s[40:43], s47 offen sc1
    s_waitcnt vmcnt(0)
    v_cmp_ne_u32 vcc, s7, v124
    s_and_b32 s73, vcc_lo, s5
    s_cbranch_scc0 L_back_h
    s_sub_u32 s46, s46, 1
    s_cbranch_scc1 L_back_h
    s_sleep 4
    s_branch L_slow_hx
L_code_end:
.section .rodata,"a"
.p2align 6
.amdhsa_kernel recurrent_scan__grouped_kv_mqa__dense_activation_relu__prompt_kernel
  .amdhsa_next_free_vgpr 256
  .amdhsa_next_free_sgpr 102
  .amdhsa_accum_offset 256
  .amdhsa_group_segment_fixed_size 0
  .amdhsa_kernarg_size 88
  .amdhsa_user_sgpr_count 2
  .amdhsa_user_sgpr_kernarg_segment_ptr 1
  .amdhsa_system_sgpr_workgroup_id_x 1
.end_amdhsa_kernel
```
